```python
import torch

def _softmax(x, axis=-1):
    return torch.softmax(x, dim=axis)

def _gelu(x):
    return torch.nn.functional.gelu(x, approximate='tanh')

def _silu(x):
    return torch.nn.functional.silu(x)

def _sigmoid(x):
    return torch.sigmoid(x)

def _layernorm(x, axis=-1, eps=1e-05):
    m = x.mean(dim=axis, keepdim=True)
    v = x.var(dim=axis, keepdim=True, unbiased=False)
    return (x - m) / torch.sqrt(v + eps)

def _scatter_add(tgt, idx, src, axis=0):
    return tgt.clone().index_add_(axis, idx, src)

def _segment_sum(src, seg, n):
    out = torch.zeros((n,) + src.shape[1:], dtype=src.dtype)
    return out.index_add_(0, seg, src)

def _pad(x, pw):
    flat = tuple((v for pair in reversed(pw) for v in pair))
    return torch.nn.functional.pad(x, flat)
kernel_name = 'adaLN_cond__grouped_kv_mqa__geglu_ffn__prompt'

def setup_inputs():

    _w = lambda a: (lambda t: t.to(torch.bfloat16) if t.is_floating_point() else t)(torch.as_tensor(a))

    def _A_setup():
        B, S, D, H = (1, 2048, 512, 32)
        Dh = D // H
        return {'x': _w((lambda *s: torch.randn(*s, dtype=torch.bfloat16) * 0.05)(B, S, D)), 'wq': _w((lambda *s: torch.randn(*s, dtype=torch.bfloat16) * 0.1)(D, H * Dh)), 'wk': _w((lambda *s: torch.randn(*s, dtype=torch.bfloat16) * 0.1)(D, Dh)), 'wv': _w((lambda *s: torch.randn(*s, dtype=torch.bfloat16) * 0.05)(D, Dh)), 'wo': _w((lambda *s: torch.randn(*s, dtype=torch.bfloat16) * 0.05)(H * Dh, D))}
    _A_in = _A_setup()

    def _B_setup():
        B, S, D, F = (1, 2048, 512, 1792)
        return {'x': _w((lambda *s: torch.randn(*s, dtype=torch.bfloat16) * 0.05)(B, S, D)), 'w_gate': _w((lambda *s: torch.randn(*s, dtype=torch.bfloat16) * 0.05)(D, F)), 'w_up': _w((lambda *s: torch.randn(*s, dtype=torch.bfloat16) * 0.05)(D, F)), 'w_down': _w((lambda *s: torch.randn(*s, dtype=torch.bfloat16) * 0.05)(F, D))}
    _B_in = _B_setup()
    return {'A_x': _A_in['x'], 'A_wq': _A_in['wq'], 'A_wk': _A_in['wk'], 'A_wv': _A_in['wv'], 'A_wo': _A_in['wo'], 'B_x': _B_in['x'], 'B_w_gate': _B_in['w_gate'], 'B_w_up': _B_in['w_up'], 'B_w_down': _B_in['w_down'], 'c': _w((lambda *s: torch.randn(*s, dtype=torch.bfloat16) * 0.1)(1, 512) * 8.0), 'w_mod': _w((lambda *s: torch.randn(*s, dtype=torch.bfloat16) * 0.1)(512, 6 * 512) * 512 ** (-0.5) * 8.0)}

def reference(A_x, A_wq, A_wk, A_wv, A_wo, B_x, B_w_gate, B_w_up, B_w_down, c, w_mod):

    def _A_ref(x, wq, wk, wv, wo):
        B, S, D = x.shape
        H = 32
        Dh = D // H
        q = (lambda x, *d: x.permute(*d))((x @ wq).reshape(B, S, H, Dh), 0, 2, 1, 3)
        k = x @ wk
        v = x @ wv
        scores = torch.einsum('bhqd,bkd->bhqk', q, k) * Dh ** (-0.5)
        p = _softmax(scores, axis=-1)
        o = torch.einsum('bhqk,bkd->bhqd', p, v)
        return (lambda x, *d: x.permute(*d))(o, 0, 2, 1, 3).reshape(B, S, H * Dh) @ wo

    def _B_ref(x, w_gate, w_up, w_down):
        return _gelu(x @ w_gate) * (x @ w_up) @ w_down
    x = A_x
    mod = (_silu(c) @ w_mod).reshape(c.shape[0], 6, 1, -1)
    sa, ca, ga, sb, cb, gb = (mod[:, 0].clone(), mod[:, 1].clone(), mod[:, 2].clone(), mod[:, 3].clone(), mod[:, 4].clone(), mod[:, 5].clone())
    h = _layernorm(x, axis=-1) * (1 + ca) + sa
    x = x + ga * _A_ref(h, A_wq, A_wk, A_wv, A_wo)
    h = _layernorm(x, axis=-1) * (1 + cb) + sb
    x = x + gb * _B_ref(h, B_w_gate, B_w_up, B_w_down)
    return x
```

```asm
; @launch grid=(256,1,1) block=(512,1,1) lds=163840
.amdgcn_target "amdgcn-amd-amdhsa--gfx950"
.text
.globl adaLN_cond__grouped_kv_mqa__geglu_ffn__prompt_kernel
.p2align 8
.type adaLN_cond__grouped_kv_mqa__geglu_ffn__prompt_kernel,@function
adaLN_cond__grouped_kv_mqa__geglu_ffn__prompt_kernel:
    s_cmp_ge_u32 s2, 256
    s_cbranch_scc1 M_END2
    s_load_dwordx4 s[16:19], s[0:1], 0
    s_load_dwordx4 s[32:35], s[0:1], 72
    s_load_dwordx2 s[30:31], s[0:1], 104
    s_load_dwordx4 s[24:27], s[0:1], 16
    s_load_dwordx2 s[28:29], s[0:1], 32
    s_load_dwordx2 s[64:65], s[0:1], 48
    s_load_dwordx2 s[68:69], s[0:1], 56
    s_load_dwordx2 s[72:73], s[0:1], 64
    s_load_dwordx2 s[56:57], s[0:1], 88
    s_getpc_b64 s[40:41]
CT_a:
    s_mov_b32 s42, (CODE_END-CT_Xa+4095)/4096
    s_lshr_b32 s43, s2, 3
    s_mul_i32 s43, s43, s42
    v_add_u32 v4, s43, v0
    v_lshlrev_b32 v4, 7, v4
    s_mov_b32 s44, CODE_END-CT_Xa-4
    v_min_u32 v4, s44, v4
    v_add_u32 v4, CT_Xa-CT_a, v4
    v_mov_b32 v5, s41
    v_add_co_u32 v4, vcc, s40, v4
    s_nop 1
    v_addc_co_u32 v5, vcc, 0, v5, vcc
    v_cmp_gt_u32 vcc, s42, v0
    s_nop 0
    s_and_saveexec_b64 s[44:45], vcc
    s_cbranch_execz CT_Xa
    global_load_dword v62, v[4:5], off
CT_Xa:
    s_mov_b64 exec, s[44:45]
    v_lshrrev_b32 v1, 6, v0
    v_and_b32 v2, 63, v0
    v_readfirstlane_b32 s3, v1
    s_and_b32 s4, s2, 7
    s_lshr_b32 s5, s2, 3
    s_lshr_b32 s6, s5, 2
    s_lshl_b32 s7, s4, 3
    s_add_u32 s7, s7, s6
    s_and_b32 s8, s5, 3
    v_lshlrev_b32 v3, 4, v2
    v_mov_b32 v15, 155648
    s_cmp_lt_u32 s3, 4
    s_cbranch_scc1 F_LO
    s_sub_u32 s9, s3, 4
    v_lshrrev_b32 v6, 3, v2
    v_and_b32 v7, 7, v2
    v_and_b32 v5, 2, v6
    v_lshlrev_b32 v5, 1, v5
    v_xor_b32 v7, v7, v5
    v_lshlrev_b32 v4, 10, v6
    v_lshl_add_u32 v4, v7, 4, v4
    v_add_u32 v14, 128, v4
    s_lshl_b32 s10, s8, 8
    s_lshl_b32 s11, s9, 13
    s_add_u32 s10, s10, s11
    s_lshl_b32 s12, s9, 10
    s_lshl_b32 s13, s6, 16
    s_mov_b32 s15, s12
    s_mov_b32 s38, 524288
    s_mov_b32 s39, 0x20000
    s_waitcnt lgkmcnt(0)
    s_mov_b32 s36, s18
    s_and_b32 s37, s19, 0xffff
F_WL:
    s_add_u32 s14, s13, s10
    s_mov_b32 m0, s15
    s_add_u32 s11, s15, 0x10000
    buffer_load_dwordx4 v4, s[36:39], s14 offen lds
    s_mov_b32 m0, s11
    s_add_u32 s13, s13, 0x8000
    buffer_load_dwordx4 v14, s[36:39], s14 offen lds
    s_and_b32 s13, s13, 0x7ffff
    s_add_u32 s15, s15, 4096
    s_cmp_lt_u32 s15, 65536
    s_cbranch_scc1 F_WL
    s_branch F_HI
F_LO:
    s_lshl_b32 s10, s7, 5
    s_lshl_b32 s11, s3, 3
    s_add_u32 s10, s10, s11
    s_lshl_b32 s11, s10, 10
    s_add_u32 s11, s11, 4096
    v_add_u32 v4, s11, v3
    v_lshlrev_b32 v14, 5, v0
    s_lshr_b32 s9, s5, 3
    s_and_b32 s12, s5, 7
    s_lshl_b32 s13, s4, 3
    s_add_u32 s12, s12, s13
    s_lshl_b32 s13, s12, 1
    s_add_u32 s13, s13, s3
    s_add_u32 s13, s13, 63
    s_cmp_eq_u32 s3, 0
    s_cselect_b32 s12, s12, s13
    s_lshl_b32 s13, s12, 5
    s_mul_i32 s14, s9, 786432
    s_add_u32 s13, s13, s14
    v_lshrrev_b32 v5, 1, v2
    v_mul_u32_u24 v10, 24576, v5
    v_and_b32 v11, 1, v2
    v_lshl_add_u32 v10, v11, 4, v10
    s_lshl_b32 s14, s9, 8
    v_lshl_add_u32 v5, v5, 3, s14
    s_waitcnt lgkmcnt(0)
    s_mov_b32 s36, s34
    s_and_b32 s37, s35, 0xffff
    s_mov_b32 s38, 3145728
    s_mov_b32 s39, 0x20000
    s_cmp_lg_u32 s3, 0
    s_cbranch_scc1 F_X
    buffer_load_dwordx4 v[16:19], v10, s[36:39], s13 offen
    s_add_u32 s13, s13, 6144
    buffer_load_dwordx4 v[20:23], v10, s[36:39], s13 offen
    s_add_u32 s13, s13, 6144
    buffer_load_dwordx4 v[24:27], v10, s[36:39], s13 offen
    s_add_u32 s13, s13, 6144
    buffer_load_dwordx4 v[28:31], v10, s[36:39], s13 offen
    global_load_dwordx2 v[32:33], v5, s[32:33]
F_X:
    s_load_dword s59, s[30:31], 55296
    s_mov_b32 s20, s30
    s_and_b32 s21, s31, 0xffff
    s_mov_b32 s22, 19922944
    s_mov_b32 s23, 0x20000
    v_lshlrev_b32 v11, 6, v11
    v_lshrrev_b32 v8, 5, v2
    v_lshl_add_u32 v11, v8, 5, v11
    v_bfe_u32 v8, v2, 4, 1
    v_lshl_add_u32 v11, v8, 4, v11
    s_mul_i32 s14, s9, 24576
    s_lshl_b32 s15, s12, 7
    s_add_u32 s14, s14, s15
    s_add_u32 s14, s14, 262144
    s_lshl_b32 s15, s6, 12
    v_lshlrev_b32 v6, 9, v2
    v_subrev_u32 v6, s15, v6
    v_and_b32 v6, 0x7fff, v6
    v_and_b32 v7, 7, v2
    v_lshl_add_u32 v6, v7, 4, v6
    s_lshl_b32 s15, s3, 7
    v_add_u32 v6, s15, v6
    v_lshlrev_b32 v12, 5, v2
    v_add_u32 v12, 147456, v12
    v_and_b32 v59, 31, v2
    v_lshlrev_b32 v59, 3, v59
    s_lshl_b32 s63, s4, 8
    s_add_u32 s63, s63, 65536
    s_getreg_b32 s58, hwreg(HW_REG_XCC_ID)
    s_and_b32 s58, s58, 7
    global_load_dwordx4 v[64:67], v4, s[16:17] offset:-4096
    global_load_dwordx4 v[68:71], v4, s[16:17] offset:-3072
    global_load_dwordx4 v[72:75], v4, s[16:17] offset:-2048
    global_load_dwordx4 v[76:79], v4, s[16:17] offset:-1024
    global_load_dwordx4 v[80:83], v4, s[16:17] offset:0
    global_load_dwordx4 v[84:87], v4, s[16:17] offset:1024
    global_load_dwordx4 v[88:91], v4, s[16:17] offset:2048
    global_load_dwordx4 v[92:95], v4, s[16:17] offset:3072
    s_waitcnt lgkmcnt(0)
    s_mul_i32 s59, s59, 1664525
    s_add_u32 s59, s59, 1013904223
    s_cmp_lg_u32 s3, 0
    s_cbranch_scc1 F_LN0
    s_waitcnt vmcnt(8)
    v_lshlrev_b32 v36, 16, v32
    v_and_b32 v37, 0xffff0000, v32
    v_lshlrev_b32 v38, 16, v33
    v_and_b32 v39, 0xffff0000, v33
    v_mul_f32 v40, 0xbfb8aa3b, v36
    v_mul_f32 v41, 0xbfb8aa3b, v37
    v_mul_f32 v42, 0xbfb8aa3b, v38
    v_mul_f32 v43, 0xbfb8aa3b, v39
    v_exp_f32 v40, v40
    v_exp_f32 v41, v41
    v_exp_f32 v42, v42
    v_exp_f32 v43, v43
    v_add_f32 v40, 1.0, v40
    v_add_f32 v41, 1.0, v41
    v_add_f32 v42, 1.0, v42
    v_add_f32 v43, 1.0, v43
    v_rcp_f32 v40, v40
    v_rcp_f32 v41, v41
    v_rcp_f32 v42, v42
    v_rcp_f32 v43, v43
    v_mul_f32 v36, v36, v40
    v_mul_f32 v37, v37, v41
    v_mul_f32 v38, v38, v42
    v_mul_f32 v39, v39, v43
    v_cvt_pk_bf16_f32 v40, v36, v37
    v_cvt_pk_bf16_f32 v41, v38, v39
    v_lshlrev_b32 v36, 16, v40
    v_and_b32 v37, 0xffff0000, v40
    v_lshlrev_b32 v38, 16, v41
    v_and_b32 v39, 0xffff0000, v41
    v_lshlrev_b32 v48, 16, v16
    v_and_b32 v49, 0xffff0000, v16
    v_lshlrev_b32 v50, 16, v17
    v_and_b32 v51, 0xffff0000, v17
    v_lshlrev_b32 v52, 16, v18
    v_and_b32 v53, 0xffff0000, v18
    v_lshlrev_b32 v54, 16, v19
    v_and_b32 v55, 0xffff0000, v19
    v_mul_f32 v40, v48, v36
    v_mul_f32 v41, v49, v36
    v_mul_f32 v42, v50, v36
    v_mul_f32 v43, v51, v36
    v_mul_f32 v44, v52, v36
    v_mul_f32 v45, v53, v36
    v_mul_f32 v46, v54, v36
    v_mul_f32 v47, v55, v36
    v_lshlrev_b32 v48, 16, v20
    v_and_b32 v49, 0xffff0000, v20
    v_lshlrev_b32 v50, 16, v21
    v_and_b32 v51, 0xffff0000, v21
    v_lshlrev_b32 v52, 16, v22
    v_and_b32 v53, 0xffff0000, v22
    v_lshlrev_b32 v54, 16, v23
    v_and_b32 v55, 0xffff0000, v23
    v_fmac_f32 v40, v48, v37
    v_fmac_f32 v41, v49, v37
    v_fmac_f32 v42, v50, v37
    v_fmac_f32 v43, v51, v37
    v_fmac_f32 v44, v52, v37
    v_fmac_f32 v45, v53, v37
    v_fmac_f32 v46, v54, v37
    v_fmac_f32 v47, v55, v37
    v_lshlrev_b32 v48, 16, v24
    v_and_b32 v49, 0xffff0000, v24
    v_lshlrev_b32 v50, 16, v25
    v_and_b32 v51, 0xffff0000, v25
    v_lshlrev_b32 v52, 16, v26
    v_and_b32 v53, 0xffff0000, v26
    v_lshlrev_b32 v54, 16, v27
    v_and_b32 v55, 0xffff0000, v27
    v_fmac_f32 v40, v48, v38
    v_fmac_f32 v41, v49, v38
    v_fmac_f32 v42, v50, v38
    v_fmac_f32 v43, v51, v38
    v_fmac_f32 v44, v52, v38
    v_fmac_f32 v45, v53, v38
    v_fmac_f32 v46, v54, v38
    v_fmac_f32 v47, v55, v38
    v_lshlrev_b32 v48, 16, v28
    v_and_b32 v49, 0xffff0000, v28
    v_lshlrev_b32 v50, 16, v29
    v_and_b32 v51, 0xffff0000, v29
    v_lshlrev_b32 v52, 16, v30
    v_and_b32 v53, 0xffff0000, v30
    v_lshlrev_b32 v54, 16, v31
    v_and_b32 v55, 0xffff0000, v31
    v_fmac_f32 v40, v48, v39
    v_fmac_f32 v41, v49, v39
    v_fmac_f32 v42, v50, v39
    v_fmac_f32 v43, v51, v39
    v_fmac_f32 v44, v52, v39
    v_fmac_f32 v45, v53, v39
    v_fmac_f32 v46, v54, v39
    v_fmac_f32 v47, v55, v39
    v_permlane32_swap_b32 v40, v44
    v_permlane32_swap_b32 v41, v45
    v_permlane32_swap_b32 v42, v46
    v_permlane32_swap_b32 v43, v47
    v_add_f32 v40, v40, v44
    v_add_f32 v41, v41, v45
    v_add_f32 v42, v42, v46
    v_add_f32 v43, v43, v47
    s_nop 0
    v_permlane16_swap_b32 v40, v42
    v_permlane16_swap_b32 v41, v43
    v_add_f32 v40, v40, v42
    v_add_f32 v41, v41, v43
    s_nop 0
    v_add_f32_dpp v40, v40, v40 row_ror:8 row_mask:0xf bank_mask:0xf
    v_add_f32_dpp v41, v41, v41 row_ror:8 row_mask:0xf bank_mask:0xf
    s_nop 0
    v_add_f32_dpp v40, v40, v40 row_ror:4 row_mask:0xf bank_mask:0xf
    v_add_f32_dpp v41, v41, v41 row_ror:4 row_mask:0xf bank_mask:0xf
    s_nop 0
    v_add_f32_dpp v40, v40, v40 row_ror:2 row_mask:0xf bank_mask:0xf
    v_add_f32_dpp v41, v41, v41 row_ror:2 row_mask:0xf bank_mask:0xf
    v_mov_b32 v42, v41
    v_mov_b32 v41, s59
    v_mov_b32 v43, s59
    s_mov_b32 exec_lo, 0x00030003
    s_mov_b32 exec_hi, 0x00030003
    buffer_store_dwordx4 v[40:43], v11, s[20:23], s14 offen sc0 sc1
    s_mov_b64 exec, -1
    ds_write_b32 v15, v41
    s_getreg_b32 s15, hwreg(HW_REG_XCC_ID)
    s_and_b32 s15, s15, 7
    v_mov_b32 v42, s15
    s_lshl_b32 s15, s4, 5
    s_add_u32 s15, s15, s5
    s_lshl_b32 s15, s15, 3
    v_mov_b32 v44, 0
    s_add_u32 s15, s15, 65536
    s_mov_b64 exec, 1
    buffer_store_dwordx2 v[42:43], v44, s[20:23], s15 offen sc0 sc1
    s_mov_b64 exec, -1
    s_waitcnt vmcnt(2)
    s_branch F_LN
F_LN0:
    s_waitcnt vmcnt(0)
F_LN:
    v_lshlrev_b32 v96, 16, v64
    v_and_b32 v97, 0xffff0000, v64
    v_lshlrev_b32 v98, 16, v65
    v_and_b32 v99, 0xffff0000, v65
    v_lshlrev_b32 v100, 16, v66
    v_and_b32 v101, 0xffff0000, v66
    v_lshlrev_b32 v102, 16, v67
    v_and_b32 v103, 0xffff0000, v67
    v_lshlrev_b32 v104, 16, v68
    v_and_b32 v105, 0xffff0000, v68
    v_lshlrev_b32 v106, 16, v69
    v_and_b32 v107, 0xffff0000, v69
    v_lshlrev_b32 v108, 16, v70
    v_and_b32 v109, 0xffff0000, v70
    v_lshlrev_b32 v110, 16, v71
    v_and_b32 v111, 0xffff0000, v71
    v_lshlrev_b32 v112, 16, v72
    v_and_b32 v113, 0xffff0000, v72
    v_lshlrev_b32 v114, 16, v73
    v_and_b32 v115, 0xffff0000, v73
    v_lshlrev_b32 v116, 16, v74
    v_and_b32 v117, 0xffff0000, v74
    v_lshlrev_b32 v118, 16, v75
    v_and_b32 v119, 0xffff0000, v75
    v_lshlrev_b32 v120, 16, v76
    v_and_b32 v121, 0xffff0000, v76
    v_lshlrev_b32 v122, 16, v77
    v_and_b32 v123, 0xffff0000, v77
    v_lshlrev_b32 v124, 16, v78
    v_and_b32 v125, 0xffff0000, v78
    v_lshlrev_b32 v126, 16, v79
    v_and_b32 v127, 0xffff0000, v79
    v_lshlrev_b32 v128, 16, v80
    v_and_b32 v129, 0xffff0000, v80
    v_lshlrev_b32 v130, 16, v81
    v_and_b32 v131, 0xffff0000, v81
    v_lshlrev_b32 v132, 16, v82
    v_and_b32 v133, 0xffff0000, v82
    v_lshlrev_b32 v134, 16, v83
    v_and_b32 v135, 0xffff0000, v83
    v_lshlrev_b32 v136, 16, v84
    v_and_b32 v137, 0xffff0000, v84
    v_lshlrev_b32 v138, 16, v85
    v_and_b32 v139, 0xffff0000, v85
    v_lshlrev_b32 v140, 16, v86
    v_and_b32 v141, 0xffff0000, v86
    v_lshlrev_b32 v142, 16, v87
    v_and_b32 v143, 0xffff0000, v87
    v_lshlrev_b32 v144, 16, v88
    v_and_b32 v145, 0xffff0000, v88
    v_lshlrev_b32 v146, 16, v89
    v_and_b32 v147, 0xffff0000, v89
    v_lshlrev_b32 v148, 16, v90
    v_and_b32 v149, 0xffff0000, v90
    v_lshlrev_b32 v150, 16, v91
    v_and_b32 v151, 0xffff0000, v91
    v_lshlrev_b32 v152, 16, v92
    v_and_b32 v153, 0xffff0000, v92
    v_lshlrev_b32 v154, 16, v93
    v_and_b32 v155, 0xffff0000, v93
    v_lshlrev_b32 v156, 16, v94
    v_and_b32 v157, 0xffff0000, v94
    v_lshlrev_b32 v158, 16, v95
    v_and_b32 v159, 0xffff0000, v95
    v_pk_add_f32 v[16:17], v[96:97], v[98:99]
    v_pk_add_f32 v[18:19], v[100:101], v[102:103]
    v_pk_add_f32 v[20:21], v[104:105], v[106:107]
    v_pk_add_f32 v[22:23], v[108:109], v[110:111]
    v_pk_add_f32 v[24:25], v[112:113], v[114:115]
    v_pk_add_f32 v[26:27], v[116:117], v[118:119]
    v_pk_add_f32 v[28:29], v[120:121], v[122:123]
    v_pk_add_f32 v[30:31], v[124:125], v[126:127]
    v_pk_add_f32 v[32:33], v[128:129], v[130:131]
    v_pk_add_f32 v[34:35], v[132:133], v[134:135]
    v_pk_add_f32 v[36:37], v[136:137], v[138:139]
    v_pk_add_f32 v[38:39], v[140:141], v[142:143]
    v_pk_add_f32 v[40:41], v[144:145], v[146:147]
    v_pk_add_f32 v[42:43], v[148:149], v[150:151]
    v_pk_add_f32 v[44:45], v[152:153], v[154:155]
    v_pk_add_f32 v[46:47], v[156:157], v[158:159]
    v_pk_add_f32 v[16:17], v[16:17], v[18:19]
    v_pk_add_f32 v[20:21], v[20:21], v[22:23]
    v_pk_add_f32 v[24:25], v[24:25], v[26:27]
    v_pk_add_f32 v[28:29], v[28:29], v[30:31]
    v_pk_add_f32 v[32:33], v[32:33], v[34:35]
    v_pk_add_f32 v[36:37], v[36:37], v[38:39]
    v_pk_add_f32 v[40:41], v[40:41], v[42:43]
    v_pk_add_f32 v[44:45], v[44:45], v[46:47]
    v_add_f32 v48, v16, v17
    v_add_f32 v49, v20, v21
    v_add_f32 v50, v24, v25
    v_add_f32 v51, v28, v29
    v_add_f32 v52, v32, v33
    v_add_f32 v53, v36, v37
    v_add_f32 v54, v40, v41
    v_add_f32 v55, v44, v45
    v_add_f32_dpp v48, v48, v48 row_shr:1 row_mask:0xf bank_mask:0xf
    v_add_f32_dpp v49, v49, v49 row_shr:1 row_mask:0xf bank_mask:0xf
    v_add_f32_dpp v50, v50, v50 row_shr:1 row_mask:0xf bank_mask:0xf
    v_add_f32_dpp v51, v51, v51 row_shr:1 row_mask:0xf bank_mask:0xf
    v_add_f32_dpp v52, v52, v52 row_shr:1 row_mask:0xf bank_mask:0xf
    v_add_f32_dpp v53, v53, v53 row_shr:1 row_mask:0xf bank_mask:0xf
    v_add_f32_dpp v54, v54, v54 row_shr:1 row_mask:0xf bank_mask:0xf
    v_add_f32_dpp v55, v55, v55 row_shr:1 row_mask:0xf bank_mask:0xf
    v_add_f32_dpp v48, v48, v48 row_shr:2 row_mask:0xf bank_mask:0xf
    v_add_f32_dpp v49, v49, v49 row_shr:2 row_mask:0xf bank_mask:0xf
    v_add_f32_dpp v50, v50, v50 row_shr:2 row_mask:0xf bank_mask:0xf
    v_add_f32_dpp v51, v51, v51 row_shr:2 row_mask:0xf bank_mask:0xf
    v_add_f32_dpp v52, v52, v52 row_shr:2 row_mask:0xf bank_mask:0xf
    v_add_f32_dpp v53, v53, v53 row_shr:2 row_mask:0xf bank_mask:0xf
    v_add_f32_dpp v54, v54, v54 row_shr:2 row_mask:0xf bank_mask:0xf
    v_add_f32_dpp v55, v55, v55 row_shr:2 row_mask:0xf bank_mask:0xf
    v_add_f32_dpp v48, v48, v48 row_shr:4 row_mask:0xf bank_mask:0xf
    v_add_f32_dpp v49, v49, v49 row_shr:4 row_mask:0xf bank_mask:0xf
    v_add_f32_dpp v50, v50, v50 row_shr:4 row_mask:0xf bank_mask:0xf
    v_add_f32_dpp v51, v51, v51 row_shr:4 row_mask:0xf bank_mask:0xf
    v_add_f32_dpp v52, v52, v52 row_shr:4 row_mask:0xf bank_mask:0xf
    v_add_f32_dpp v53, v53, v53 row_shr:4 row_mask:0xf bank_mask:0xf
    v_add_f32_dpp v54, v54, v54 row_shr:4 row_mask:0xf bank_mask:0xf
    v_add_f32_dpp v55, v55, v55 row_shr:4 row_mask:0xf bank_mask:0xf
    v_add_f32_dpp v48, v48, v48 row_shr:8 row_mask:0xf bank_mask:0xf
    v_add_f32_dpp v49, v49, v49 row_shr:8 row_mask:0xf bank_mask:0xf
    v_add_f32_dpp v50, v50, v50 row_shr:8 row_mask:0xf bank_mask:0xf
    v_add_f32_dpp v51, v51, v51 row_shr:8 row_mask:0xf bank_mask:0xf
    v_add_f32_dpp v52, v52, v52 row_shr:8 row_mask:0xf bank_mask:0xf
    v_add_f32_dpp v53, v53, v53 row_shr:8 row_mask:0xf bank_mask:0xf
    v_add_f32_dpp v54, v54, v54 row_shr:8 row_mask:0xf bank_mask:0xf
    v_add_f32_dpp v55, v55, v55 row_shr:8 row_mask:0xf bank_mask:0xf
    v_add_f32_dpp v48, v48, v48 row_bcast:15 row_mask:0xa bank_mask:0xf
    v_add_f32_dpp v49, v49, v49 row_bcast:15 row_mask:0xa bank_mask:0xf
    v_add_f32_dpp v50, v50, v50 row_bcast:15 row_mask:0xa bank_mask:0xf
    v_add_f32_dpp v51, v51, v51 row_bcast:15 row_mask:0xa bank_mask:0xf
    v_add_f32_dpp v52, v52, v52 row_bcast:15 row_mask:0xa bank_mask:0xf
    v_add_f32_dpp v53, v53, v53 row_bcast:15 row_mask:0xa bank_mask:0xf
    v_add_f32_dpp v54, v54, v54 row_bcast:15 row_mask:0xa bank_mask:0xf
    v_add_f32_dpp v55, v55, v55 row_bcast:15 row_mask:0xa bank_mask:0xf
    v_add_f32_dpp v48, v48, v48 row_bcast:31 row_mask:0xc bank_mask:0xf
    v_add_f32_dpp v49, v49, v49 row_bcast:31 row_mask:0xc bank_mask:0xf
    v_add_f32_dpp v50, v50, v50 row_bcast:31 row_mask:0xc bank_mask:0xf
    v_add_f32_dpp v51, v51, v51 row_bcast:31 row_mask:0xc bank_mask:0xf
    v_add_f32_dpp v52, v52, v52 row_bcast:31 row_mask:0xc bank_mask:0xf
    v_add_f32_dpp v53, v53, v53 row_bcast:31 row_mask:0xc bank_mask:0xf
    v_add_f32_dpp v54, v54, v54 row_bcast:31 row_mask:0xc bank_mask:0xf
    v_add_f32_dpp v55, v55, v55 row_bcast:31 row_mask:0xc bank_mask:0xf
    v_mul_f32 v48, 0xbb000000, v48
    v_mul_f32 v49, 0xbb000000, v49
    v_mul_f32 v50, 0xbb000000, v50
    v_mul_f32 v51, 0xbb000000, v51
    v_mul_f32 v52, 0xbb000000, v52
    v_mul_f32 v53, 0xbb000000, v53
    v_mul_f32 v54, 0xbb000000, v54
    v_mul_f32 v55, 0xbb000000, v55
    v_readlane_b32 s40, v48, 63
    v_readlane_b32 s42, v49, 63
    v_readlane_b32 s44, v50, 63
    v_readlane_b32 s46, v51, 63
    v_readlane_b32 s48, v52, 63
    v_readlane_b32 s50, v53, 63
    v_readlane_b32 s52, v54, 63
    v_readlane_b32 s54, v55, 63
    v_pk_add_f32 v[96:97], v[96:97], s[40:41] op_sel_hi:[1,0]
    v_pk_add_f32 v[98:99], v[98:99], s[40:41] op_sel_hi:[1,0]
    v_pk_add_f32 v[100:101], v[100:101], s[40:41] op_sel_hi:[1,0]
    v_pk_add_f32 v[102:103], v[102:103], s[40:41] op_sel_hi:[1,0]
    v_pk_add_f32 v[104:105], v[104:105], s[42:43] op_sel_hi:[1,0]
    v_pk_add_f32 v[106:107], v[106:107], s[42:43] op_sel_hi:[1,0]
    v_pk_add_f32 v[108:109], v[108:109], s[42:43] op_sel_hi:[1,0]
    v_pk_add_f32 v[110:111], v[110:111], s[42:43] op_sel_hi:[1,0]
    v_pk_add_f32 v[112:113], v[112:113], s[44:45] op_sel_hi:[1,0]
    v_pk_add_f32 v[114:115], v[114:115], s[44:45] op_sel_hi:[1,0]
    v_pk_add_f32 v[116:117], v[116:117], s[44:45] op_sel_hi:[1,0]
    v_pk_add_f32 v[118:119], v[118:119], s[44:45] op_sel_hi:[1,0]
    v_pk_add_f32 v[120:121], v[120:121], s[46:47] op_sel_hi:[1,0]
    v_pk_add_f32 v[122:123], v[122:123], s[46:47] op_sel_hi:[1,0]
    v_pk_add_f32 v[124:125], v[124:125], s[46:47] op_sel_hi:[1,0]
    v_pk_add_f32 v[126:127], v[126:127], s[46:47] op_sel_hi:[1,0]
    v_pk_add_f32 v[128:129], v[128:129], s[48:49] op_sel_hi:[1,0]
    v_pk_add_f32 v[130:131], v[130:131], s[48:49] op_sel_hi:[1,0]
    v_pk_add_f32 v[132:133], v[132:133], s[48:49] op_sel_hi:[1,0]
    v_pk_add_f32 v[134:135], v[134:135], s[48:49] op_sel_hi:[1,0]
    v_pk_add_f32 v[136:137], v[136:137], s[50:51] op_sel_hi:[1,0]
    v_pk_add_f32 v[138:139], v[138:139], s[50:51] op_sel_hi:[1,0]
    v_pk_add_f32 v[140:141], v[140:141], s[50:51] op_sel_hi:[1,0]
    v_pk_add_f32 v[142:143], v[142:143], s[50:51] op_sel_hi:[1,0]
    v_pk_add_f32 v[144:145], v[144:145], s[52:53] op_sel_hi:[1,0]
    v_pk_add_f32 v[146:147], v[146:147], s[52:53] op_sel_hi:[1,0]
    v_pk_add_f32 v[148:149], v[148:149], s[52:53] op_sel_hi:[1,0]
    v_pk_add_f32 v[150:151], v[150:151], s[52:53] op_sel_hi:[1,0]
    v_pk_add_f32 v[152:153], v[152:153], s[54:55] op_sel_hi:[1,0]
    v_pk_add_f32 v[154:155], v[154:155], s[54:55] op_sel_hi:[1,0]
    v_pk_add_f32 v[156:157], v[156:157], s[54:55] op_sel_hi:[1,0]
    v_pk_add_f32 v[158:159], v[158:159], s[54:55] op_sel_hi:[1,0]
    v_pk_mul_f32 v[16:17], v[96:97], v[96:97]
    v_pk_mul_f32 v[18:19], v[104:105], v[104:105]
    v_pk_mul_f32 v[20:21], v[112:113], v[112:113]
    v_pk_mul_f32 v[22:23], v[120:121], v[120:121]
    v_pk_mul_f32 v[24:25], v[128:129], v[128:129]
    v_pk_mul_f32 v[26:27], v[136:137], v[136:137]
    v_pk_mul_f32 v[28:29], v[144:145], v[144:145]
    v_pk_mul_f32 v[30:31], v[152:153], v[152:153]
    v_pk_fma_f32 v[16:17], v[98:99], v[98:99], v[16:17]
    v_pk_fma_f32 v[18:19], v[106:107], v[106:107], v[18:19]
    v_pk_fma_f32 v[20:21], v[114:115], v[114:115], v[20:21]
    v_pk_fma_f32 v[22:23], v[122:123], v[122:123], v[22:23]
    v_pk_fma_f32 v[24:25], v[130:131], v[130:131], v[24:25]
    v_pk_fma_f32 v[26:27], v[138:139], v[138:139], v[26:27]
    v_pk_fma_f32 v[28:29], v[146:147], v[146:147], v[28:29]
    v_pk_fma_f32 v[30:31], v[154:155], v[154:155], v[30:31]
    v_pk_fma_f32 v[16:17], v[100:101], v[100:101], v[16:17]
    v_pk_fma_f32 v[18:19], v[108:109], v[108:109], v[18:19]
    v_pk_fma_f32 v[20:21], v[116:117], v[116:117], v[20:21]
    v_pk_fma_f32 v[22:23], v[124:125], v[124:125], v[22:23]
    v_pk_fma_f32 v[24:25], v[132:133], v[132:133], v[24:25]
    v_pk_fma_f32 v[26:27], v[140:141], v[140:141], v[26:27]
    v_pk_fma_f32 v[28:29], v[148:149], v[148:149], v[28:29]
    v_pk_fma_f32 v[30:31], v[156:157], v[156:157], v[30:31]
    v_pk_fma_f32 v[16:17], v[102:103], v[102:103], v[16:17]
    v_pk_fma_f32 v[18:19], v[110:111], v[110:111], v[18:19]
    v_pk_fma_f32 v[20:21], v[118:119], v[118:119], v[20:21]
    v_pk_fma_f32 v[22:23], v[126:127], v[126:127], v[22:23]
    v_pk_fma_f32 v[24:25], v[134:135], v[134:135], v[24:25]
    v_pk_fma_f32 v[26:27], v[142:143], v[142:143], v[26:27]
    v_pk_fma_f32 v[28:29], v[150:151], v[150:151], v[28:29]
    v_pk_fma_f32 v[30:31], v[158:159], v[158:159], v[30:31]
    v_add_f32 v48, v16, v17
    v_add_f32 v49, v18, v19
    v_add_f32 v50, v20, v21
    v_add_f32 v51, v22, v23
    v_add_f32 v52, v24, v25
    v_add_f32 v53, v26, v27
    v_add_f32 v54, v28, v29
    v_add_f32 v55, v30, v31
    v_add_f32_dpp v48, v48, v48 row_shr:1 row_mask:0xf bank_mask:0xf
    v_add_f32_dpp v49, v49, v49 row_shr:1 row_mask:0xf bank_mask:0xf
    v_add_f32_dpp v50, v50, v50 row_shr:1 row_mask:0xf bank_mask:0xf
    v_add_f32_dpp v51, v51, v51 row_shr:1 row_mask:0xf bank_mask:0xf
    v_add_f32_dpp v52, v52, v52 row_shr:1 row_mask:0xf bank_mask:0xf
    v_add_f32_dpp v53, v53, v53 row_shr:1 row_mask:0xf bank_mask:0xf
    v_add_f32_dpp v54, v54, v54 row_shr:1 row_mask:0xf bank_mask:0xf
    v_add_f32_dpp v55, v55, v55 row_shr:1 row_mask:0xf bank_mask:0xf
    v_add_f32_dpp v48, v48, v48 row_shr:2 row_mask:0xf bank_mask:0xf
    v_add_f32_dpp v49, v49, v49 row_shr:2 row_mask:0xf bank_mask:0xf
    v_add_f32_dpp v50, v50, v50 row_shr:2 row_mask:0xf bank_mask:0xf
    v_add_f32_dpp v51, v51, v51 row_shr:2 row_mask:0xf bank_mask:0xf
    v_add_f32_dpp v52, v52, v52 row_shr:2 row_mask:0xf bank_mask:0xf
    v_add_f32_dpp v53, v53, v53 row_shr:2 row_mask:0xf bank_mask:0xf
    v_add_f32_dpp v54, v54, v54 row_shr:2 row_mask:0xf bank_mask:0xf
    v_add_f32_dpp v55, v55, v55 row_shr:2 row_mask:0xf bank_mask:0xf
    v_add_f32_dpp v48, v48, v48 row_shr:4 row_mask:0xf bank_mask:0xf
    v_add_f32_dpp v49, v49, v49 row_shr:4 row_mask:0xf bank_mask:0xf
    v_add_f32_dpp v50, v50, v50 row_shr:4 row_mask:0xf bank_mask:0xf
    v_add_f32_dpp v51, v51, v51 row_shr:4 row_mask:0xf bank_mask:0xf
    v_add_f32_dpp v52, v52, v52 row_shr:4 row_mask:0xf bank_mask:0xf
    v_add_f32_dpp v53, v53, v53 row_shr:4 row_mask:0xf bank_mask:0xf
    v_add_f32_dpp v54, v54, v54 row_shr:4 row_mask:0xf bank_mask:0xf
    v_add_f32_dpp v55, v55, v55 row_shr:4 row_mask:0xf bank_mask:0xf
    v_add_f32_dpp v48, v48, v48 row_shr:8 row_mask:0xf bank_mask:0xf
    v_add_f32_dpp v49, v49, v49 row_shr:8 row_mask:0xf bank_mask:0xf
    v_add_f32_dpp v50, v50, v50 row_shr:8 row_mask:0xf bank_mask:0xf
    v_add_f32_dpp v51, v51, v51 row_shr:8 row_mask:0xf bank_mask:0xf
    v_add_f32_dpp v52, v52, v52 row_shr:8 row_mask:0xf bank_mask:0xf
    v_add_f32_dpp v53, v53, v53 row_shr:8 row_mask:0xf bank_mask:0xf
    v_add_f32_dpp v54, v54, v54 row_shr:8 row_mask:0xf bank_mask:0xf
    v_add_f32_dpp v55, v55, v55 row_shr:8 row_mask:0xf bank_mask:0xf
    v_add_f32_dpp v48, v48, v48 row_bcast:15 row_mask:0xa bank_mask:0xf
    v_add_f32_dpp v49, v49, v49 row_bcast:15 row_mask:0xa bank_mask:0xf
    v_add_f32_dpp v50, v50, v50 row_bcast:15 row_mask:0xa bank_mask:0xf
    v_add_f32_dpp v51, v51, v51 row_bcast:15 row_mask:0xa bank_mask:0xf
    v_add_f32_dpp v52, v52, v52 row_bcast:15 row_mask:0xa bank_mask:0xf
    v_add_f32_dpp v53, v53, v53 row_bcast:15 row_mask:0xa bank_mask:0xf
    v_add_f32_dpp v54, v54, v54 row_bcast:15 row_mask:0xa bank_mask:0xf
    v_add_f32_dpp v55, v55, v55 row_bcast:15 row_mask:0xa bank_mask:0xf
    v_add_f32_dpp v48, v48, v48 row_bcast:31 row_mask:0xc bank_mask:0xf
    v_add_f32_dpp v49, v49, v49 row_bcast:31 row_mask:0xc bank_mask:0xf
    v_add_f32_dpp v50, v50, v50 row_bcast:31 row_mask:0xc bank_mask:0xf
    v_add_f32_dpp v51, v51, v51 row_bcast:31 row_mask:0xc bank_mask:0xf
    v_add_f32_dpp v52, v52, v52 row_bcast:31 row_mask:0xc bank_mask:0xf
    v_add_f32_dpp v53, v53, v53 row_bcast:31 row_mask:0xc bank_mask:0xf
    v_add_f32_dpp v54, v54, v54 row_bcast:31 row_mask:0xc bank_mask:0xf
    v_add_f32_dpp v55, v55, v55 row_bcast:31 row_mask:0xc bank_mask:0xf
    v_mov_b32 v56, 0x3727c5ac
    v_fmamk_f32 v48, v48, 0x3b000000, v56
    v_fmamk_f32 v49, v49, 0x3b000000, v56
    v_fmamk_f32 v50, v50, 0x3b000000, v56
    v_fmamk_f32 v51, v51, 0x3b000000, v56
    v_fmamk_f32 v52, v52, 0x3b000000, v56
    v_fmamk_f32 v53, v53, 0x3b000000, v56
    v_fmamk_f32 v54, v54, 0x3b000000, v56
    v_fmamk_f32 v55, v55, 0x3b000000, v56
    v_rsq_f32 v48, v48
    v_rsq_f32 v49, v49
    v_rsq_f32 v50, v50
    v_rsq_f32 v51, v51
    v_rsq_f32 v52, v52
    v_rsq_f32 v53, v53
    v_rsq_f32 v54, v54
    v_rsq_f32 v55, v55
    v_readlane_b32 s40, v48, 63
    v_readlane_b32 s42, v49, 63
    v_readlane_b32 s44, v50, 63
    v_readlane_b32 s46, v51, 63
    v_readlane_b32 s48, v52, 63
    v_readlane_b32 s50, v53, 63
    v_readlane_b32 s52, v54, 63
    v_readlane_b32 s54, v55, 63
    v_pk_mul_f32 v[96:97], v[96:97], s[40:41] op_sel_hi:[1,0]
    v_pk_mul_f32 v[98:99], v[98:99], s[40:41] op_sel_hi:[1,0]
    v_pk_mul_f32 v[100:101], v[100:101], s[40:41] op_sel_hi:[1,0]
    v_pk_mul_f32 v[102:103], v[102:103], s[40:41] op_sel_hi:[1,0]
    v_pk_mul_f32 v[104:105], v[104:105], s[42:43] op_sel_hi:[1,0]
    v_pk_mul_f32 v[106:107], v[106:107], s[42:43] op_sel_hi:[1,0]
    v_pk_mul_f32 v[108:109], v[108:109], s[42:43] op_sel_hi:[1,0]
    v_pk_mul_f32 v[110:111], v[110:111], s[42:43] op_sel_hi:[1,0]
    v_pk_mul_f32 v[112:113], v[112:113], s[44:45] op_sel_hi:[1,0]
    v_pk_mul_f32 v[114:115], v[114:115], s[44:45] op_sel_hi:[1,0]
    v_pk_mul_f32 v[116:117], v[116:117], s[44:45] op_sel_hi:[1,0]
    v_pk_mul_f32 v[118:119], v[118:119], s[44:45] op_sel_hi:[1,0]
    v_pk_mul_f32 v[120:121], v[120:121], s[46:47] op_sel_hi:[1,0]
    v_pk_mul_f32 v[122:123], v[122:123], s[46:47] op_sel_hi:[1,0]
    v_pk_mul_f32 v[124:125], v[124:125], s[46:47] op_sel_hi:[1,0]
    v_pk_mul_f32 v[126:127], v[126:127], s[46:47] op_sel_hi:[1,0]
    v_pk_mul_f32 v[128:129], v[128:129], s[48:49] op_sel_hi:[1,0]
    v_pk_mul_f32 v[130:131], v[130:131], s[48:49] op_sel_hi:[1,0]
    v_pk_mul_f32 v[132:133], v[132:133], s[48:49] op_sel_hi:[1,0]
    v_pk_mul_f32 v[134:135], v[134:135], s[48:49] op_sel_hi:[1,0]
    v_pk_mul_f32 v[136:137], v[136:137], s[50:51] op_sel_hi:[1,0]
    v_pk_mul_f32 v[138:139], v[138:139], s[50:51] op_sel_hi:[1,0]
    v_pk_mul_f32 v[140:141], v[140:141], s[50:51] op_sel_hi:[1,0]
    v_pk_mul_f32 v[142:143], v[142:143], s[50:51] op_sel_hi:[1,0]
    v_pk_mul_f32 v[144:145], v[144:145], s[52:53] op_sel_hi:[1,0]
    v_pk_mul_f32 v[146:147], v[146:147], s[52:53] op_sel_hi:[1,0]
    v_pk_mul_f32 v[148:149], v[148:149], s[52:53] op_sel_hi:[1,0]
    v_pk_mul_f32 v[150:151], v[150:151], s[52:53] op_sel_hi:[1,0]
    v_pk_mul_f32 v[152:153], v[152:153], s[54:55] op_sel_hi:[1,0]
    v_pk_mul_f32 v[154:155], v[154:155], s[54:55] op_sel_hi:[1,0]
    v_pk_mul_f32 v[156:157], v[156:157], s[54:55] op_sel_hi:[1,0]
    v_pk_mul_f32 v[158:159], v[158:159], s[54:55] op_sel_hi:[1,0]
    s_waitcnt lgkmcnt(0)
    s_barrier
    s_mov_b32 s61, 262144
    buffer_load_dwordx4 v[16:19], v14, s[20:23], s61 offen sc1
    buffer_load_dwordx4 v[20:23], v14, s[20:23], s61 offen offset:16 sc1
    s_mov_b32 s61, 286720
    buffer_load_dwordx4 v[24:27], v14, s[20:23], s61 offen sc1
    buffer_load_dwordx4 v[28:31], v14, s[20:23], s61 offen offset:16 sc1
    s_mov_b32 s61, 311296
    buffer_load_dwordx4 v[32:35], v14, s[20:23], s61 offen sc1
    buffer_load_dwordx4 v[36:39], v14, s[20:23], s61 offen offset:16 sc1
    s_mov_b32 s61, 335872
    buffer_load_dwordx4 v[40:43], v14, s[20:23], s61 offen sc1
    buffer_load_dwordx4 v[44:47], v14, s[20:23], s61 offen offset:16 sc1
    buffer_load_dwordx2 v[60:61], v59, s[20:23], s63 offen sc1
    s_mov_b32 s62, 0x40000
    s_cmp_eq_u32 s3, 0
    s_cbranch_scc1 F_SL0
    s_cmp_eq_u32 s3, 3
    s_cbranch_scc1 F_SL3
    buffer_load_dwordx4 v[160:163], v10, s[36:39], s13 offen
    s_add_u32 s13, s13, 6144
    buffer_load_dwordx4 v[164:167], v10, s[36:39], s13 offen
    s_add_u32 s13, s13, 6144
    buffer_load_dwordx4 v[168:171], v10, s[36:39], s13 offen
    s_add_u32 s13, s13, 6144
    buffer_load_dwordx4 v[172:175], v10, s[36:39], s13 offen
    global_load_dwordx2 v[176:177], v5, s[32:33]
    s_waitcnt vmcnt(5)
    s_branch F_SLY
F_SL3:
    s_cmp_ge_u32 s2, 128
    s_cbranch_scc1 F_SLX
    v_lshrrev_b32 v9, 3, v2
    v_lshlrev_b32 v10, 10, v9
    v_and_b32 v9, 7, v2
    v_lshl_add_u32 v10, v9, 4, v10
    s_lshl_b32 s13, s5, 15
    s_lshl_b32 s15, s4, 7
    s_add_u32 s13, s13, s15
    s_mov_b32 s36, s28
    s_and_b32 s37, s29, 0xffff
    s_mov_b32 s38, 524288
    s_mov_b32 s39, 0x20000
    s_mov_b32 m0, 151552
    s_nop 0
    buffer_load_dwordx4 v10, s[36:39], s13 offen lds
    s_mov_b32 m0, 152576
    s_add_u32 s13, s13, 8192
    buffer_load_dwordx4 v10, s[36:39], s13 offen lds
    s_mov_b32 m0, 153600
    s_add_u32 s13, s13, 8192
    buffer_load_dwordx4 v10, s[36:39], s13 offen lds
    s_mov_b32 m0, 154624
    s_add_u32 s13, s13, 8192
    buffer_load_dwordx4 v10, s[36:39], s13 offen lds
    s_waitcnt vmcnt(4)
    s_branch F_SLY
F_SL0:
    s_and_b32 s12, s8, 1
    v_and_b32 v8, 3, v2
    v_lshrrev_b32 v9, 1, v8
    v_and_b32 v10, 1, v8
    v_lshl_add_u32 v9, v10, 1, v9
    s_cmp_lg_u32 s12, 0
    s_cselect_b64 s[40:41], -1, 0
    v_cndmask_b32 v8, v8, v9, s[40:41]
    v_lshlrev_b32 v8, 3, v8
    v_bfe_u32 v9, v2, 2, 2
    v_lshl_add_u32 v8, v9, 5, v8
    v_lshrrev_b32 v9, 4, v2
    v_lshl_add_u32 v8, v9, 8, v8
    v_add_u32 v8, 131072, v8
F_SLX:
F_SW:
    s_waitcnt vmcnt(0)
F_SLY:
    v_xor_b32 v48, s59, v61
    v_xor_b32 v49, s59, v17
    v_or_b32 v48, v48, v49
    v_xor_b32 v49, s59, v19
    v_or_b32 v48, v48, v49
    v_xor_b32 v49, s59, v21
    v_or_b32 v48, v48, v49
    v_xor_b32 v49, s59, v23
    v_or_b32 v48, v48, v49
    v_xor_b32 v49, s59, v25
    v_or_b32 v48, v48, v49
    v_xor_b32 v49, s59, v27
    v_or_b32 v48, v48, v49
    v_xor_b32 v49, s59, v29
    v_or_b32 v48, v48, v49
    v_xor_b32 v49, s59, v31
    v_or_b32 v48, v48, v49
    v_xor_b32 v49, s59, v33
    v_or_b32 v48, v48, v49
    v_xor_b32 v49, s59, v35
    v_or_b32 v48, v48, v49
    v_xor_b32 v49, s59, v37
    v_or_b32 v48, v48, v49
    v_xor_b32 v49, s59, v39
    v_or_b32 v48, v48, v49
    v_xor_b32 v49, s59, v41
    v_or_b32 v48, v48, v49
    v_xor_b32 v49, s59, v43
    v_or_b32 v48, v48, v49
    v_xor_b32 v49, s59, v45
    v_or_b32 v48, v48, v49
    v_xor_b32 v49, s59, v47
    v_or_b32 v48, v48, v49
    v_cmp_ne_u32 vcc, 0, v48
    s_nop 0
    s_cmp_eq_u64 vcc, 0
    s_cbranch_scc1 F_SG
    s_mov_b64 exec, vcc
    s_sleep 2
    s_mov_b32 s61, 262144
    buffer_load_dwordx4 v[16:19], v14, s[20:23], s61 offen sc1
    buffer_load_dwordx4 v[20:23], v14, s[20:23], s61 offen offset:16 sc1
    s_mov_b32 s61, 286720
    buffer_load_dwordx4 v[24:27], v14, s[20:23], s61 offen sc1
    buffer_load_dwordx4 v[28:31], v14, s[20:23], s61 offen offset:16 sc1
    s_mov_b32 s61, 311296
    buffer_load_dwordx4 v[32:35], v14, s[20:23], s61 offen sc1
    buffer_load_dwordx4 v[36:39], v14, s[20:23], s61 offen offset:16 sc1
    s_mov_b32 s61, 335872
    buffer_load_dwordx4 v[40:43], v14, s[20:23], s61 offen sc1
    buffer_load_dwordx4 v[44:47], v14, s[20:23], s61 offen offset:16 sc1
    buffer_load_dwordx2 v[60:61], v59, s[20:23], s63 offen sc1
    s_mov_b64 exec, -1
    s_sub_u32 s62, s62, 1
    s_cmp_lg_u32 s62, 0
    s_cbranch_scc1 F_SW
    s_waitcnt vmcnt(0)
F_SG:
    v_cmp_eq_u32 vcc, s58, v60
    s_nop 0
    s_cmp_eq_u64 vcc, -1
    s_cselect_b32 s60, 1, 0
    v_mov_b32 v60, s60
    ds_write_b32 v15, v60 offset:4
    v_add_f32 v16, v16, v24
    v_add_f32 v32, v32, v40
    v_add_f32 v18, v18, v26
    v_add_f32 v34, v34, v42
    v_add_f32 v20, v20, v28
    v_add_f32 v36, v36, v44
    v_add_f32 v22, v22, v30
    v_add_f32 v38, v38, v46
    v_add_f32 v16, v16, v32
    v_add_f32 v17, v18, v34
    v_add_f32 v18, v20, v36
    v_add_f32 v19, v22, v38
    v_cvt_pk_bf16_f32 v20, v16, v17
    v_cvt_pk_bf16_f32 v21, v18, v19
    v_lshlrev_b32 v16, 16, v20
    v_and_b32 v17, 0xffff0000, v20
    v_lshlrev_b32 v18, 16, v21
    v_and_b32 v19, 0xffff0000, v21
    s_cmp_lt_u32 s3, 2
    s_cbranch_scc1 F_NOADD
    v_add_f32 v16, 1.0, v16
    v_add_f32 v17, 1.0, v17
    v_add_f32 v18, 1.0, v18
    v_add_f32 v19, 1.0, v19
    v_cvt_pk_bf16_f32 v20, v16, v17
    v_cvt_pk_bf16_f32 v21, v18, v19
    v_lshlrev_b32 v16, 16, v20
    v_and_b32 v17, 0xffff0000, v20
    v_lshlrev_b32 v18, 16, v21
    v_and_b32 v19, 0xffff0000, v21
F_NOADD:
    v_lshrrev_b32 v20, 1, v14
    v_add_u32 v20, 147456, v20
    ds_write_b128 v20, v[16:19]
    s_waitcnt lgkmcnt(0)
    s_barrier
    ds_read_b128 v[16:19], v12
    ds_read_b128 v[20:23], v12 offset:16
    ds_read_b128 v[24:27], v12 offset:2048
    ds_read_b128 v[28:31], v12 offset:2064
    s_waitcnt lgkmcnt(0)
    v_pk_fma_f32 v[96:97], v[96:97], v[24:25], v[16:17]
    v_pk_fma_f32 v[98:99], v[98:99], v[26:27], v[18:19]
    v_pk_fma_f32 v[100:101], v[100:101], v[28:29], v[20:21]
    v_pk_fma_f32 v[102:103], v[102:103], v[30:31], v[22:23]
    v_cvt_pk_bf16_f32 v64, v96, v97
    v_cvt_pk_bf16_f32 v65, v98, v99
    v_cvt_pk_bf16_f32 v66, v100, v101
    v_cvt_pk_bf16_f32 v67, v102, v103
    ds_write_b128 v6, v[64:67]
    v_pk_fma_f32 v[104:105], v[104:105], v[24:25], v[16:17]
    v_pk_fma_f32 v[106:107], v[106:107], v[26:27], v[18:19]
    v_pk_fma_f32 v[108:109], v[108:109], v[28:29], v[20:21]
    v_pk_fma_f32 v[110:111], v[110:111], v[30:31], v[22:23]
    v_cvt_pk_bf16_f32 v68, v104, v105
    v_cvt_pk_bf16_f32 v69, v106, v107
    v_cvt_pk_bf16_f32 v70, v108, v109
    v_cvt_pk_bf16_f32 v71, v110, v111
    v_xor_b32 v13, 16, v6
    ds_write_b128 v13, v[68:71]
    v_pk_fma_f32 v[112:113], v[112:113], v[24:25], v[16:17]
    v_pk_fma_f32 v[114:115], v[114:115], v[26:27], v[18:19]
    v_pk_fma_f32 v[116:117], v[116:117], v[28:29], v[20:21]
    v_pk_fma_f32 v[118:119], v[118:119], v[30:31], v[22:23]
    v_cvt_pk_bf16_f32 v72, v112, v113
    v_cvt_pk_bf16_f32 v73, v114, v115
    v_cvt_pk_bf16_f32 v74, v116, v117
    v_cvt_pk_bf16_f32 v75, v118, v119
    v_xor_b32 v13, 32, v6
    ds_write_b128 v13, v[72:75]
    v_pk_fma_f32 v[120:121], v[120:121], v[24:25], v[16:17]
    v_pk_fma_f32 v[122:123], v[122:123], v[26:27], v[18:19]
    v_pk_fma_f32 v[124:125], v[124:125], v[28:29], v[20:21]
    v_pk_fma_f32 v[126:127], v[126:127], v[30:31], v[22:23]
    v_cvt_pk_bf16_f32 v76, v120, v121
    v_cvt_pk_bf16_f32 v77, v122, v123
    v_cvt_pk_bf16_f32 v78, v124, v125
    v_cvt_pk_bf16_f32 v79, v126, v127
    v_xor_b32 v13, 48, v6
    ds_write_b128 v13, v[76:79]
    v_pk_fma_f32 v[128:129], v[128:129], v[24:25], v[16:17]
    v_pk_fma_f32 v[130:131], v[130:131], v[26:27], v[18:19]
    v_pk_fma_f32 v[132:133], v[132:133], v[28:29], v[20:21]
    v_pk_fma_f32 v[134:135], v[134:135], v[30:31], v[22:23]
    v_cvt_pk_bf16_f32 v80, v128, v129
    v_cvt_pk_bf16_f32 v81, v130, v131
    v_cvt_pk_bf16_f32 v82, v132, v133
    v_cvt_pk_bf16_f32 v83, v134, v135
    v_xor_b32 v13, 64, v6
    ds_write_b128 v13, v[80:83]
    v_pk_fma_f32 v[136:137], v[136:137], v[24:25], v[16:17]
    v_pk_fma_f32 v[138:139], v[138:139], v[26:27], v[18:19]
    v_pk_fma_f32 v[140:141], v[140:141], v[28:29], v[20:21]
    v_pk_fma_f32 v[142:143], v[142:143], v[30:31], v[22:23]
    v_cvt_pk_bf16_f32 v84, v136, v137
    v_cvt_pk_bf16_f32 v85, v138, v139
    v_cvt_pk_bf16_f32 v86, v140, v141
    v_cvt_pk_bf16_f32 v87, v142, v143
    v_xor_b32 v13, 80, v6
    ds_write_b128 v13, v[84:87]
    v_pk_fma_f32 v[144:145], v[144:145], v[24:25], v[16:17]
    v_pk_fma_f32 v[146:147], v[146:147], v[26:27], v[18:19]
    v_pk_fma_f32 v[148:149], v[148:149], v[28:29], v[20:21]
    v_pk_fma_f32 v[150:151], v[150:151], v[30:31], v[22:23]
    v_cvt_pk_bf16_f32 v88, v144, v145
    v_cvt_pk_bf16_f32 v89, v146, v147
    v_cvt_pk_bf16_f32 v90, v148, v149
    v_cvt_pk_bf16_f32 v91, v150, v151
    v_xor_b32 v13, 96, v6
    ds_write_b128 v13, v[88:91]
    v_pk_fma_f32 v[152:153], v[152:153], v[24:25], v[16:17]
    v_pk_fma_f32 v[154:155], v[154:155], v[26:27], v[18:19]
    v_pk_fma_f32 v[156:157], v[156:157], v[28:29], v[20:21]
    v_pk_fma_f32 v[158:159], v[158:159], v[30:31], v[22:23]
    v_cvt_pk_bf16_f32 v92, v152, v153
    v_cvt_pk_bf16_f32 v93, v154, v155
    v_cvt_pk_bf16_f32 v94, v156, v157
    v_cvt_pk_bf16_f32 v95, v158, v159
    v_xor_b32 v13, 112, v6
    ds_write_b128 v13, v[92:95]
    s_waitcnt lgkmcnt(0)
    s_barrier
    s_cmp_eq_u32 s3, 0
    s_cbranch_scc1 F_KV
    s_waitcnt vmcnt(0)
    s_cmp_eq_u32 s3, 3
    s_cbranch_scc1 F_S3
    v_lshlrev_b32 v180, 16, v176
    v_and_b32 v181, 0xffff0000, v176
    v_lshlrev_b32 v182, 16, v177
    v_and_b32 v183, 0xffff0000, v177
    v_mul_f32 v184, 0xbfb8aa3b, v180
    v_mul_f32 v185, 0xbfb8aa3b, v181
    v_mul_f32 v186, 0xbfb8aa3b, v182
    v_mul_f32 v187, 0xbfb8aa3b, v183
    v_exp_f32 v184, v184
    v_exp_f32 v185, v185
    v_exp_f32 v186, v186
    v_exp_f32 v187, v187
    v_add_f32 v184, 1.0, v184
    v_add_f32 v185, 1.0, v185
    v_add_f32 v186, 1.0, v186
    v_add_f32 v187, 1.0, v187
    v_rcp_f32 v184, v184
    v_rcp_f32 v185, v185
    v_rcp_f32 v186, v186
    v_rcp_f32 v187, v187
    v_mul_f32 v180, v180, v184
    v_mul_f32 v181, v181, v185
    v_mul_f32 v182, v182, v186
    v_mul_f32 v183, v183, v187
    v_cvt_pk_bf16_f32 v184, v180, v181
    v_cvt_pk_bf16_f32 v185, v182, v183
    v_lshlrev_b32 v180, 16, v184
    v_and_b32 v181, 0xffff0000, v184
    v_lshlrev_b32 v182, 16, v185
    v_and_b32 v183, 0xffff0000, v185
    v_lshlrev_b32 v192, 16, v160
    v_and_b32 v193, 0xffff0000, v160
    v_lshlrev_b32 v194, 16, v161
    v_and_b32 v195, 0xffff0000, v161
    v_lshlrev_b32 v196, 16, v162
    v_and_b32 v197, 0xffff0000, v162
    v_lshlrev_b32 v198, 16, v163
    v_and_b32 v199, 0xffff0000, v163
    v_mul_f32 v184, v192, v180
    v_mul_f32 v185, v193, v180
    v_mul_f32 v186, v194, v180
    v_mul_f32 v187, v195, v180
    v_mul_f32 v188, v196, v180
    v_mul_f32 v189, v197, v180
    v_mul_f32 v190, v198, v180
    v_mul_f32 v191, v199, v180
    v_lshlrev_b32 v192, 16, v164
    v_and_b32 v193, 0xffff0000, v164
    v_lshlrev_b32 v194, 16, v165
    v_and_b32 v195, 0xffff0000, v165
    v_lshlrev_b32 v196, 16, v166
    v_and_b32 v197, 0xffff0000, v166
    v_lshlrev_b32 v198, 16, v167
    v_and_b32 v199, 0xffff0000, v167
    v_fmac_f32 v184, v192, v181
    v_fmac_f32 v185, v193, v181
    v_fmac_f32 v186, v194, v181
    v_fmac_f32 v187, v195, v181
    v_fmac_f32 v188, v196, v181
    v_fmac_f32 v189, v197, v181
    v_fmac_f32 v190, v198, v181
    v_fmac_f32 v191, v199, v181
    v_lshlrev_b32 v192, 16, v168
    v_and_b32 v193, 0xffff0000, v168
    v_lshlrev_b32 v194, 16, v169
    v_and_b32 v195, 0xffff0000, v169
    v_lshlrev_b32 v196, 16, v170
    v_and_b32 v197, 0xffff0000, v170
    v_lshlrev_b32 v198, 16, v171
    v_and_b32 v199, 0xffff0000, v171
    v_fmac_f32 v184, v192, v182
    v_fmac_f32 v185, v193, v182
    v_fmac_f32 v186, v194, v182
    v_fmac_f32 v187, v195, v182
    v_fmac_f32 v188, v196, v182
    v_fmac_f32 v189, v197, v182
    v_fmac_f32 v190, v198, v182
    v_fmac_f32 v191, v199, v182
    v_lshlrev_b32 v192, 16, v172
    v_and_b32 v193, 0xffff0000, v172
    v_lshlrev_b32 v194, 16, v173
    v_and_b32 v195, 0xffff0000, v173
    v_lshlrev_b32 v196, 16, v174
    v_and_b32 v197, 0xffff0000, v174
    v_lshlrev_b32 v198, 16, v175
    v_and_b32 v199, 0xffff0000, v175
    v_fmac_f32 v184, v192, v183
    v_fmac_f32 v185, v193, v183
    v_fmac_f32 v186, v194, v183
    v_fmac_f32 v187, v195, v183
    v_fmac_f32 v188, v196, v183
    v_fmac_f32 v189, v197, v183
    v_fmac_f32 v190, v198, v183
    v_fmac_f32 v191, v199, v183
    v_permlane32_swap_b32 v184, v188
    v_permlane32_swap_b32 v185, v189
    v_permlane32_swap_b32 v186, v190
    v_permlane32_swap_b32 v187, v191
    v_add_f32 v184, v184, v188
    v_add_f32 v185, v185, v189
    v_add_f32 v186, v186, v190
    v_add_f32 v187, v187, v191
    s_nop 0
    v_permlane16_swap_b32 v184, v186
    v_permlane16_swap_b32 v185, v187
    v_add_f32 v184, v184, v186
    v_add_f32 v185, v185, v187
    s_nop 0
    v_add_f32_dpp v184, v184, v184 row_ror:8 row_mask:0xf bank_mask:0xf
    v_add_f32_dpp v185, v185, v185 row_ror:8 row_mask:0xf bank_mask:0xf
    s_nop 0
    v_add_f32_dpp v184, v184, v184 row_ror:4 row_mask:0xf bank_mask:0xf
    v_add_f32_dpp v185, v185, v185 row_ror:4 row_mask:0xf bank_mask:0xf
    s_nop 0
    v_add_f32_dpp v184, v184, v184 row_ror:2 row_mask:0xf bank_mask:0xf
    v_add_f32_dpp v185, v185, v185 row_ror:2 row_mask:0xf bank_mask:0xf
    v_mov_b32 v186, v185
    v_mov_b32 v185, s59
    v_mov_b32 v187, s59
    s_mov_b32 exec_lo, 0x00030003
    s_mov_b32 exec_hi, 0x00030003
    buffer_store_dwordx4 v[184:187], v11, s[20:23], s14 offen sc0 sc1
    s_mov_b64 exec, -1
    s_branch F_END
F_S3:
    s_cmp_ge_u32 s2, 128
    s_cbranch_scc1 F_END
    v_lshrrev_b32 v9, 4, v2
    v_lshlrev_b32 v8, 10, v9
    v_bfe_u32 v9, v2, 2, 2
    v_lshl_add_u32 v8, v9, 7, v8
    v_and_b32 v9, 3, v2
    v_lshl_add_u32 v8, v9, 5, v8
    s_lshl_b32 s13, s4, 16
    s_lshl_b32 s15, s5, 10
    s_add_u32 s13, s13, s15
    v_add_u32 v8, 151552, v8
    s_add_u32 s13, s13, 1048576
    ds_read_b64_tr_b16 v[160:161], v8 offset:0
    ds_read_b64_tr_b16 v[162:163], v8 offset:512
    ds_read_b64_tr_b16 v[164:165], v8 offset:8
    ds_read_b64_tr_b16 v[166:167], v8 offset:520
    ds_read_b64_tr_b16 v[168:169], v8 offset:16
    ds_read_b64_tr_b16 v[170:171], v8 offset:528
    ds_read_b64_tr_b16 v[172:173], v8 offset:24
    ds_read_b64_tr_b16 v[174:175], v8 offset:536
    s_waitcnt lgkmcnt(0)
    buffer_store_dwordx4 v[160:163], v3, s[20:23], s13 offen sc0 sc1
    s_add_u32 s13, s13, 16384
    buffer_store_dwordx4 v[164:167], v3, s[20:23], s13 offen sc0 sc1
    s_add_u32 s13, s13, 16384
    buffer_store_dwordx4 v[168:171], v3, s[20:23], s13 offen sc0 sc1
    s_add_u32 s13, s13, 16384
    buffer_store_dwordx4 v[172:175], v3, s[20:23], s13 offen sc0 sc1
    s_branch F_END
F_KV:
    ds_read_b64_tr_b16 v[160:161], v8 offset:0
    ds_read_b64_tr_b16 v[162:163], v8 offset:128
    ds_read_b64_tr_b16 v[164:165], v8 offset:1024
    ds_read_b64_tr_b16 v[166:167], v8 offset:1152
    ds_read_b64_tr_b16 v[168:169], v8 offset:2048
    ds_read_b64_tr_b16 v[170:171], v8 offset:2176
    ds_read_b64_tr_b16 v[172:173], v8 offset:3072
    ds_read_b64_tr_b16 v[174:175], v8 offset:3200
    ds_read_b64_tr_b16 v[176:177], v8 offset:4096
    ds_read_b64_tr_b16 v[178:179], v8 offset:4224
    ds_read_b64_tr_b16 v[180:181], v8 offset:5120
    ds_read_b64_tr_b16 v[182:183], v8 offset:5248
    ds_read_b64_tr_b16 v[184:185], v8 offset:6144
    ds_read_b64_tr_b16 v[186:187], v8 offset:6272
    ds_read_b64_tr_b16 v[188:189], v8 offset:7168
    ds_read_b64_tr_b16 v[190:191], v8 offset:7296
    ds_read_b64_tr_b16 v[192:193], v8 offset:8192
    ds_read_b64_tr_b16 v[194:195], v8 offset:8320
    ds_read_b64_tr_b16 v[196:197], v8 offset:9216
    ds_read_b64_tr_b16 v[198:199], v8 offset:9344
    ds_read_b64_tr_b16 v[200:201], v8 offset:10240
    ds_read_b64_tr_b16 v[202:203], v8 offset:10368
    ds_read_b64_tr_b16 v[204:205], v8 offset:11264
    ds_read_b64_tr_b16 v[206:207], v8 offset:11392
    ds_read_b64_tr_b16 v[208:209], v8 offset:12288
    ds_read_b64_tr_b16 v[210:211], v8 offset:12416
    ds_read_b64_tr_b16 v[212:213], v8 offset:13312
    ds_read_b64_tr_b16 v[214:215], v8 offset:13440
    ds_read_b64_tr_b16 v[216:217], v8 offset:14336
    ds_read_b64_tr_b16 v[218:219], v8 offset:14464
    ds_read_b64_tr_b16 v[220:221], v8 offset:15360
    ds_read_b64_tr_b16 v[222:223], v8 offset:15488
    s_lshr_b32 s13, s8, 1
    s_lshl_b32 s13, s13, 4
    v_and_b32 v10, 15, v2
    v_add_u32 v10, s13, v10
    v_bfe_u32 v11, v2, 4, 1
    v_lshrrev_b32 v12, 5, v2
    v_lshl_add_u32 v15, v11, 5, v10
    v_lshl_add_u32 v14, v12, 1, v11
    v_xor_b32 v7, v15, v14
    v_lshlrev_b32 v7, 4, v7
    v_lshl_add_u32 v7, v12, 10, v7
    v_xor_b32 v9, 64, v7
    v_add_u32 v9, 2048, v9
    ds_read_b128 v[96:99], v7 offset:0
    ds_read_b128 v[100:103], v9 offset:0
    ds_read_b128 v[104:107], v7 offset:4096
    ds_read_b128 v[108:111], v9 offset:4096
    ds_read_b128 v[112:115], v7 offset:8192
    ds_read_b128 v[116:119], v9 offset:8192
    ds_read_b128 v[120:123], v7 offset:12288
    ds_read_b128 v[124:127], v9 offset:12288
    ds_read_b128 v[128:131], v7 offset:16384
    ds_read_b128 v[132:135], v9 offset:16384
    ds_read_b128 v[136:139], v7 offset:20480
    ds_read_b128 v[140:143], v9 offset:20480
    ds_read_b128 v[144:147], v7 offset:24576
    ds_read_b128 v[148:151], v9 offset:24576
    ds_read_b128 v[152:155], v7 offset:28672
    ds_read_b128 v[156:159], v9 offset:28672
    v_lshrrev_b32 v11, 4, v2
    v_and_b32 v12, 1, v11
    v_lshrrev_b32 v11, 1, v11
    s_lshl_b32 s14, s7, 11
    s_add_u32 s14, s14, 131072
    s_cmp_lg_u32 s12, 0
    s_cbranch_scc1 F_V
    s_waitcnt lgkmcnt(15)
    v_mfma_f32_16x16x32_bf16 v[16:19], v[160:163], v[96:99], 0
    s_waitcnt lgkmcnt(14)
    v_mfma_f32_16x16x32_bf16 v[16:19], v[164:167], v[100:103], v[16:19]
    s_waitcnt lgkmcnt(13)
    v_mfma_f32_16x16x32_bf16 v[16:19], v[168:171], v[104:107], v[16:19]
    s_waitcnt lgkmcnt(12)
    v_mfma_f32_16x16x32_bf16 v[16:19], v[172:175], v[108:111], v[16:19]
    s_waitcnt lgkmcnt(11)
    v_mfma_f32_16x16x32_bf16 v[16:19], v[176:179], v[112:115], v[16:19]
    s_waitcnt lgkmcnt(10)
    v_mfma_f32_16x16x32_bf16 v[16:19], v[180:183], v[116:119], v[16:19]
    s_waitcnt lgkmcnt(9)
    v_mfma_f32_16x16x32_bf16 v[16:19], v[184:187], v[120:123], v[16:19]
    s_waitcnt lgkmcnt(8)
    v_mfma_f32_16x16x32_bf16 v[16:19], v[188:191], v[124:127], v[16:19]
    s_waitcnt lgkmcnt(7)
    v_mfma_f32_16x16x32_bf16 v[16:19], v[192:195], v[128:131], v[16:19]
    s_waitcnt lgkmcnt(6)
    v_mfma_f32_16x16x32_bf16 v[16:19], v[196:199], v[132:135], v[16:19]
    s_waitcnt lgkmcnt(5)
    v_mfma_f32_16x16x32_bf16 v[16:19], v[200:203], v[136:139], v[16:19]
    s_waitcnt lgkmcnt(4)
    v_mfma_f32_16x16x32_bf16 v[16:19], v[204:207], v[140:143], v[16:19]
    s_waitcnt lgkmcnt(3)
    v_mfma_f32_16x16x32_bf16 v[16:19], v[208:211], v[144:147], v[16:19]
    s_waitcnt lgkmcnt(2)
    v_mfma_f32_16x16x32_bf16 v[16:19], v[212:215], v[148:151], v[16:19]
    s_waitcnt lgkmcnt(1)
    v_mfma_f32_16x16x32_bf16 v[16:19], v[216:219], v[152:155], v[16:19]
    s_waitcnt lgkmcnt(0)
    v_mfma_f32_16x16x32_bf16 v[16:19], v[220:223], v[156:159], v[16:19]
    v_lshlrev_b32 v15, 9, v11
    v_lshl_add_u32 v15, v10, 4, v15
    v_lshl_add_u32 v15, v12, 3, v15
    s_branch F_KVST
F_V:
    s_waitcnt lgkmcnt(15)
    v_mfma_f32_16x16x32_bf16 v[16:19], v[96:99], v[160:163], 0
    s_waitcnt lgkmcnt(14)
    v_mfma_f32_16x16x32_bf16 v[16:19], v[100:103], v[164:167], v[16:19]
    s_waitcnt lgkmcnt(13)
    v_mfma_f32_16x16x32_bf16 v[16:19], v[104:107], v[168:171], v[16:19]
    s_waitcnt lgkmcnt(12)
    v_mfma_f32_16x16x32_bf16 v[16:19], v[108:111], v[172:175], v[16:19]
    s_waitcnt lgkmcnt(11)
    v_mfma_f32_16x16x32_bf16 v[16:19], v[112:115], v[176:179], v[16:19]
    s_waitcnt lgkmcnt(10)
    v_mfma_f32_16x16x32_bf16 v[16:19], v[116:119], v[180:183], v[16:19]
    s_waitcnt lgkmcnt(9)
    v_mfma_f32_16x16x32_bf16 v[16:19], v[120:123], v[184:187], v[16:19]
    s_waitcnt lgkmcnt(8)
    v_mfma_f32_16x16x32_bf16 v[16:19], v[124:127], v[188:191], v[16:19]
    s_waitcnt lgkmcnt(7)
    v_mfma_f32_16x16x32_bf16 v[16:19], v[128:131], v[192:195], v[16:19]
    s_waitcnt lgkmcnt(6)
    v_mfma_f32_16x16x32_bf16 v[16:19], v[132:135], v[196:199], v[16:19]
    s_waitcnt lgkmcnt(5)
    v_mfma_f32_16x16x32_bf16 v[16:19], v[136:139], v[200:203], v[16:19]
    s_waitcnt lgkmcnt(4)
    v_mfma_f32_16x16x32_bf16 v[16:19], v[140:143], v[204:207], v[16:19]
    s_waitcnt lgkmcnt(3)
    v_mfma_f32_16x16x32_bf16 v[16:19], v[144:147], v[208:211], v[16:19]
    s_waitcnt lgkmcnt(2)
    v_mfma_f32_16x16x32_bf16 v[16:19], v[148:151], v[212:215], v[16:19]
    s_waitcnt lgkmcnt(1)
    v_mfma_f32_16x16x32_bf16 v[16:19], v[152:155], v[216:219], v[16:19]
    s_waitcnt lgkmcnt(0)
    v_mfma_f32_16x16x32_bf16 v[16:19], v[156:159], v[220:223], v[16:19]
    v_and_b32 v15, 15, v2
    v_lshl_add_u32 v15, v12, 4, v15
    v_lshlrev_b32 v15, 4, v15
    v_lshl_add_u32 v15, v11, 3, v15
    s_lshl_b32 s13, s13, 5
    s_add_u32 s13, s13, 1024
    v_add_u32 v15, s13, v15
F_KVST:
    s_nop 4
    v_cvt_pk_bf16_f32 v20, v16, v17
    v_cvt_pk_bf16_f32 v21, v18, v19
    s_add_u32 s15, s14, 262144
    s_lshl_b32 s13, s4, 5
    s_add_u32 s13, s13, s5
    s_lshl_b32 s13, s13, 2
    s_add_u32 s12, s13, 69632
    s_add_u32 s13, s13, 57344
    s_cmp_lg_u32 s60, 0
    s_cbranch_scc0 F_KVS
    buffer_store_dwordx2 v[20:21], v15, s[20:23], s15 offen
    buffer_store_dwordx2 v[20:21], v15, s[20:23], s14 offen sc0 sc1
    v_mov_b32 v16, s59
    v_mov_b32 v17, 0
    s_waitcnt vmcnt(1)
    s_mov_b64 exec, 1
    buffer_store_dword v16, v17, s[20:23], s12 offen
    s_mov_b64 exec, -1
    v_mov_b32 v16, s59
    v_mov_b32 v17, 0
    s_waitcnt vmcnt(1)
    s_mov_b64 exec, 1
    buffer_store_dword v16, v17, s[20:23], s13 offen sc0 sc1
    s_mov_b64 exec, -1
    s_branch F_END
F_KVS:
    buffer_store_dwordx2 v[20:21], v15, s[20:23], s15 offen sc0 sc1
    buffer_store_dwordx2 v[20:21], v15, s[20:23], s14 offen sc0 sc1
    v_mov_b32 v16, s59
    v_mov_b32 v17, 0
    s_waitcnt vmcnt(0)
    s_mov_b64 exec, 1
    buffer_store_dword v16, v17, s[20:23], s12 offen sc0 sc1
    s_mov_b64 exec, -1
    v_mov_b32 v16, s59
    v_mov_b32 v17, 0
    s_waitcnt vmcnt(1)
    s_mov_b64 exec, 1
    buffer_store_dword v16, v17, s[20:23], s13 offen sc0 sc1
    s_mov_b64 exec, -1
    s_branch F_END
F_HI:
    v_lshrrev_b32 v7, 5, v2
    v_lshlrev_b32 v8, 10, v7
    v_bfe_u32 v6, v2, 2, 2
    v_lshl_add_u32 v8, v6, 7, v8
    v_bfe_u32 v5, v2, 1, 1
    v_lshl_add_u32 v8, v5, 3, v8
    v_and_b32 v5, 1, v2
    v_lshlrev_b32 v5, 1, v5
    v_bfe_u32 v9, v2, 4, 1
    v_add_u32 v5, v5, v9
    v_and_b32 v6, 2, v6
    v_lshl_add_u32 v5, v6, 1, v5
    s_and_b32 s52, s9, 1
    s_lshl_b32 s52, s52, 2
    v_xor_b32 v5, s52, v5
    v_lshl_add_u32 v8, v5, 4, v8
    s_lshr_b32 s52, s9, 1
    s_lshl_b32 s52, s52, 16
    v_add_u32 v13, s52, v8
    s_waitcnt vmcnt(16)
    s_barrier
    ds_read_b64_tr_b16 v[64:65], v13 offset:0
    ds_read_b64_tr_b16 v[66:67], v13 offset:512
    ds_read_b64_tr_b16 v[68:69], v13 offset:2048
    ds_read_b64_tr_b16 v[70:71], v13 offset:2560
    ds_read_b64_tr_b16 v[72:73], v13 offset:4096
    ds_read_b64_tr_b16 v[74:75], v13 offset:4608
    ds_read_b64_tr_b16 v[76:77], v13 offset:6144
    ds_read_b64_tr_b16 v[78:79], v13 offset:6656
    ds_read_b64_tr_b16 v[80:81], v13 offset:8192
    ds_read_b64_tr_b16 v[82:83], v13 offset:8704
    ds_read_b64_tr_b16 v[84:85], v13 offset:10240
    ds_read_b64_tr_b16 v[86:87], v13 offset:10752
    ds_read_b64_tr_b16 v[88:89], v13 offset:12288
    ds_read_b64_tr_b16 v[90:91], v13 offset:12800
    ds_read_b64_tr_b16 v[92:93], v13 offset:14336
    ds_read_b64_tr_b16 v[94:95], v13 offset:14848
    ds_read_b64_tr_b16 v[96:97], v13 offset:16384
    ds_read_b64_tr_b16 v[98:99], v13 offset:16896
    ds_read_b64_tr_b16 v[100:101], v13 offset:18432
    ds_read_b64_tr_b16 v[102:103], v13 offset:18944
    ds_read_b64_tr_b16 v[104:105], v13 offset:20480
    ds_read_b64_tr_b16 v[106:107], v13 offset:20992
    ds_read_b64_tr_b16 v[108:109], v13 offset:22528
    ds_read_b64_tr_b16 v[110:111], v13 offset:23040
    ds_read_b64_tr_b16 v[112:113], v13 offset:24576
    ds_read_b64_tr_b16 v[114:115], v13 offset:25088
    ds_read_b64_tr_b16 v[116:117], v13 offset:26624
    ds_read_b64_tr_b16 v[118:119], v13 offset:27136
    ds_read_b64_tr_b16 v[120:121], v13 offset:28672
    ds_read_b64_tr_b16 v[122:123], v13 offset:29184
    ds_read_b64_tr_b16 v[124:125], v13 offset:30720
    ds_read_b64_tr_b16 v[126:127], v13 offset:31232
    s_and_b32 s48, s8, 1
    s_cmp_lg_u32 s48, 0
    s_cselect_b32 s44, s26, s24
    s_cselect_b32 s45, s27, s25
    s_and_b32 s45, s45, 0xffff
    s_mov_b32 s46, 16384
    s_mov_b32 s47, 0x20000
    s_lshl_b32 s48, s6, 11
    s_add_u32 s48, s48, s12
    s_and_b32 s48, s48, 0x3fff
    s_add_u32 s49, s12, 131072
    s_mov_b32 m0, s49
    s_nop 0
    buffer_load_dwordx4 v3, s[44:47], s48 offen lds
    s_add_u32 s48, s48, 4096
    s_and_b32 s48, s48, 0x3fff
    s_add_u32 s49, s12, 135168
    s_mov_b32 m0, s49
    s_nop 0
    buffer_load_dwordx4 v3, s[44:47], s48 offen lds
    s_add_u32 s48, s48, 4096
    s_and_b32 s48, s48, 0x3fff
    s_add_u32 s49, s12, 139264
    s_mov_b32 m0, s49
    s_nop 0
    buffer_load_dwordx4 v3, s[44:47], s48 offen lds
    s_add_u32 s48, s48, 4096
    s_and_b32 s48, s48, 0x3fff
    s_add_u32 s49, s12, 143360
    s_mov_b32 m0, s49
    s_nop 0
    buffer_load_dwordx4 v3, s[44:47], s48 offen lds
    v_add_u32 v8, 0, v7
    v_xor_b32 v8, v8, v2
    v_lshlrev_b32 v8, 4, v8
    v_add_u32 v9, 2, v7
    v_xor_b32 v9, v9, v2
    v_lshlrev_b32 v9, 4, v9
    v_add_u32 v9, 1024, v9
    v_add_u32 v10, 4, v7
    v_xor_b32 v10, v10, v2
    v_lshlrev_b32 v10, 4, v10
    v_add_u32 v10, 2048, v10
    v_add_u32 v11, 6, v7
    v_xor_b32 v11, v11, v2
    v_lshlrev_b32 v11, 4, v11
    v_add_u32 v11, 3072, v11
    s_lshl_b32 s53, s7, 2
    s_add_u32 s53, s53, s8
    s_lshl_b32 s53, s53, 2
    s_add_u32 s53, s53, s9
    s_lshl_b32 s54, s53, 2
    s_lshl_b32 s53, s53, 11
    s_add_u32 s53, s53, 2097152
    s_add_u32 s54, s54, 61440
    s_mov_b32 s55, 0x3eb8aa3b
    s_mov_b32 s20, s30
    s_and_b32 s21, s31, 0xffff
    s_mov_b32 s22, 19922944
    s_mov_b32 s23, 0x20000
    v_and_b32 v14, 15, v2
    v_lshlrev_b32 v14, 7, v14
    v_add_u32 v12, s53, v14
    s_lshl_b32 s14, s7, 11
    s_add_u32 s14, s14, 393216
    v_add_u32 v14, s14, v14
    v_cmp_gt_u32 vcc, 16, v2
    s_lshl_b32 s14, s4, 7
    s_add_u32 s14, s14, 69632
    v_cndmask_b32 v12, v14, v12, vcc
    v_writelane_b32 v12, s14, 32
    v_writelane_b32 v12, s54, 33
    ds_read_b32 v63, v15
    s_waitcnt lgkmcnt(0)
    v_readfirstlane_b32 s59, v63
    s_barrier
    s_mov_b32 exec_hi, 3
    buffer_load_dword v1, v12, s[20:23], 0 offen
    s_mov_b64 exec, -1
    ds_read_b32 v63, v15 offset:4
    s_waitcnt lgkmcnt(0)
    v_readfirstlane_b32 s60, v63
    s_waitcnt vmcnt(1)
    s_barrier
    ds_read_b128 v[32:35], v8 offset:0
    ds_read_b128 v[36:39], v9 offset:0
    ds_read_b128 v[40:43], v10 offset:0
    ds_read_b128 v[44:47], v11 offset:0
    ds_read_b128 v[48:51], v8 offset:4096
    ds_read_b128 v[52:55], v9 offset:4096
    s_waitcnt lgkmcnt(5)
    v_mfma_f32_32x32x16_bf16 v[16:31], v[64:67], v[32:35], 0
    ds_read_b128 v[56:59], v10 offset:4096
    ds_read_b64_tr_b16 v[128:129], v13 offset:32768
    ds_read_b64_tr_b16 v[130:131], v13 offset:33280
    s_waitcnt lgkmcnt(7)
    v_mfma_f32_32x32x16_bf16 v[16:31], v[68:71], v[36:39], v[16:31]
    ds_read_b128 v[60:63], v11 offset:4096
    ds_read_b64_tr_b16 v[132:133], v13 offset:34816
    ds_read_b64_tr_b16 v[134:135], v13 offset:35328
    s_waitcnt lgkmcnt(9)
    v_mfma_f32_32x32x16_bf16 v[16:31], v[72:75], v[40:43], v[16:31]
    ds_read_b128 v[32:35], v8 offset:8192
    ds_read_b64_tr_b16 v[136:137], v13 offset:36864
    ds_read_b64_tr_b16 v[138:139], v13 offset:37376
    s_waitcnt lgkmcnt(11)
    v_mfma_f32_32x32x16_bf16 v[16:31], v[76:79], v[44:47], v[16:31]
    ds_read_b128 v[36:39], v9 offset:8192
    ds_read_b64_tr_b16 v[140:141], v13 offset:38912
    ds_read_b64_tr_b16 v[142:143], v13 offset:39424
    s_waitcnt lgkmcnt(13)
    v_mfma_f32_32x32x16_bf16 v[16:31], v[80:83], v[48:51], v[16:31]
    ds_read_b128 v[40:43], v10 offset:8192
    ds_read_b64_tr_b16 v[144:145], v13 offset:40960
    ds_read_b64_tr_b16 v[146:147], v13 offset:41472
    s_waitcnt lgkmcnt(15)
    v_mfma_f32_32x32x16_bf16 v[16:31], v[84:87], v[52:55], v[16:31]
    ds_read_b128 v[44:47], v11 offset:8192
    ds_read_b64_tr_b16 v[148:149], v13 offset:43008
    ds_read_b64_tr_b16 v[150:151], v13 offset:43520
    s_waitcnt lgkmcnt(15)
    v_mfma_f32_32x32x16_bf16 v[16:31], v[88:91], v[56:59], v[16:31]
    ds_read_b128 v[48:51], v8 offset:12288
    ds_read_b64_tr_b16 v[152:153], v13 offset:45056
    ds_read_b64_tr_b16 v[154:155], v13 offset:45568
    s_waitcnt lgkmcnt(15)
    v_mfma_f32_32x32x16_bf16 v[16:31], v[92:95], v[60:63], v[16:31]
    ds_read_b128 v[52:55], v9 offset:12288
    ds_read_b64_tr_b16 v[156:157], v13 offset:47104
    ds_read_b64_tr_b16 v[158:159], v13 offset:47616
    s_waitcnt lgkmcnt(15)
    v_mfma_f32_32x32x16_bf16 v[16:31], v[96:99], v[32:35], v[16:31]
    ds_read_b128 v[56:59], v10 offset:12288
    ds_read_b64_tr_b16 v[160:161], v13 offset:49152
    ds_read_b64_tr_b16 v[162:163], v13 offset:49664
    s_waitcnt lgkmcnt(15)
    v_mfma_f32_32x32x16_bf16 v[16:31], v[100:103], v[36:39], v[16:31]
    ds_read_b128 v[60:63], v11 offset:12288
    ds_read_b64_tr_b16 v[164:165], v13 offset:51200
    ds_read_b64_tr_b16 v[166:167], v13 offset:51712
    s_waitcnt lgkmcnt(15)
    v_mfma_f32_32x32x16_bf16 v[16:31], v[104:107], v[40:43], v[16:31]
    ds_read_b128 v[32:35], v8 offset:16384
    ds_read_b64_tr_b16 v[168:169], v13 offset:53248
    ds_read_b64_tr_b16 v[170:171], v13 offset:53760
    s_waitcnt lgkmcnt(15)
    v_mfma_f32_32x32x16_bf16 v[16:31], v[108:111], v[44:47], v[16:31]
    ds_read_b128 v[36:39], v9 offset:16384
    ds_read_b64_tr_b16 v[172:173], v13 offset:55296
    ds_read_b64_tr_b16 v[174:175], v13 offset:55808
    s_waitcnt lgkmcnt(15)
    v_mfma_f32_32x32x16_bf16 v[16:31], v[112:115], v[48:51], v[16:31]
    ds_read_b128 v[40:43], v10 offset:16384
    ds_read_b64_tr_b16 v[176:177], v13 offset:57344
    ds_read_b64_tr_b16 v[178:179], v13 offset:57856
    s_waitcnt lgkmcnt(15)
    v_mfma_f32_32x32x16_bf16 v[16:31], v[116:119], v[52:55], v[16:31]
    ds_read_b128 v[44:47], v11 offset:16384
    ds_read_b64_tr_b16 v[180:181], v13 offset:59392
    ds_read_b64_tr_b16 v[182:183], v13 offset:59904
    s_waitcnt lgkmcnt(15)
    v_mfma_f32_32x32x16_bf16 v[16:31], v[120:123], v[56:59], v[16:31]
    ds_read_b128 v[48:51], v8 offset:20480
    ds_read_b64_tr_b16 v[184:185], v13 offset:61440
    ds_read_b64_tr_b16 v[186:187], v13 offset:61952
    s_waitcnt lgkmcnt(15)
    v_mfma_f32_32x32x16_bf16 v[16:31], v[124:127], v[60:63], v[16:31]
    ds_read_b128 v[52:55], v9 offset:20480
    ds_read_b64_tr_b16 v[188:189], v13 offset:63488
    ds_read_b64_tr_b16 v[190:191], v13 offset:64000
    s_waitcnt lgkmcnt(15)
    v_mfma_f32_32x32x16_bf16 v[16:31], v[128:131], v[32:35], v[16:31]
    ds_read_b128 v[56:59], v10 offset:20480
    s_waitcnt lgkmcnt(15)
    v_mfma_f32_32x32x16_bf16 v[16:31], v[132:135], v[36:39], v[16:31]
    ds_read_b128 v[60:63], v11 offset:20480
    s_waitcnt lgkmcnt(13)
    v_mfma_f32_32x32x16_bf16 v[16:31], v[136:139], v[40:43], v[16:31]
    ds_read_b128 v[32:35], v8 offset:24576
    s_waitcnt lgkmcnt(11)
    v_mfma_f32_32x32x16_bf16 v[16:31], v[140:143], v[44:47], v[16:31]
    ds_read_b128 v[36:39], v9 offset:24576
    s_waitcnt lgkmcnt(9)
    v_mfma_f32_32x32x16_bf16 v[16:31], v[144:147], v[48:51], v[16:31]
    ds_read_b128 v[40:43], v10 offset:24576
    s_waitcnt lgkmcnt(7)
    v_mfma_f32_32x32x16_bf16 v[16:31], v[148:151], v[52:55], v[16:31]
    ds_read_b128 v[44:47], v11 offset:24576
    s_waitcnt lgkmcnt(5)
    v_mfma_f32_32x32x16_bf16 v[16:31], v[152:155], v[56:59], v[16:31]
    ds_read_b128 v[48:51], v8 offset:28672
    s_waitcnt lgkmcnt(5)
    v_mfma_f32_32x32x16_bf16 v[16:31], v[156:159], v[60:63], v[16:31]
    ds_read_b128 v[52:55], v9 offset:28672
    s_waitcnt lgkmcnt(5)
    v_mfma_f32_32x32x16_bf16 v[16:31], v[160:163], v[32:35], v[16:31]
    ds_read_b128 v[56:59], v10 offset:28672
    s_waitcnt lgkmcnt(5)
    v_mfma_f32_32x32x16_bf16 v[16:31], v[164:167], v[36:39], v[16:31]
    ds_read_b128 v[60:63], v11 offset:28672
    s_waitcnt lgkmcnt(5)
    v_mfma_f32_32x32x16_bf16 v[16:31], v[168:171], v[40:43], v[16:31]
    s_waitcnt lgkmcnt(4)
    v_mfma_f32_32x32x16_bf16 v[16:31], v[172:175], v[44:47], v[16:31]
    s_waitcnt lgkmcnt(3)
    v_mfma_f32_32x32x16_bf16 v[16:31], v[176:179], v[48:51], v[16:31]
    s_waitcnt lgkmcnt(2)
    v_mfma_f32_32x32x16_bf16 v[16:31], v[180:183], v[52:55], v[16:31]
    s_waitcnt lgkmcnt(1)
    v_mfma_f32_32x32x16_bf16 v[16:31], v[184:187], v[56:59], v[16:31]
    s_waitcnt lgkmcnt(0)
    v_mfma_f32_32x32x16_bf16 v[16:31], v[188:191], v[60:63], v[16:31]
    s_nop 11
    v_mul_f32 v16, s55, v16
    v_mul_f32 v17, s55, v17
    v_mul_f32 v18, s55, v18
    v_mul_f32 v19, s55, v19
    v_mul_f32 v20, s55, v20
    v_mul_f32 v21, s55, v21
    v_mul_f32 v22, s55, v22
    v_mul_f32 v23, s55, v23
    v_mul_f32 v24, s55, v24
    v_mul_f32 v25, s55, v25
    v_mul_f32 v26, s55, v26
    v_mul_f32 v27, s55, v27
    v_mul_f32 v28, s55, v28
    v_mul_f32 v29, s55, v29
    v_mul_f32 v30, s55, v30
    v_mul_f32 v31, s55, v31
    v_cvt_pk_bf16_f32 v32, v16, v17
    v_cvt_pk_bf16_f32 v33, v18, v19
    v_cvt_pk_bf16_f32 v34, v20, v21
    v_cvt_pk_bf16_f32 v35, v22, v23
    v_cvt_pk_bf16_f32 v36, v24, v25
    v_cvt_pk_bf16_f32 v37, v26, v27
    v_cvt_pk_bf16_f32 v38, v28, v29
    v_cvt_pk_bf16_f32 v39, v30, v31
    s_cmp_lg_u32 s60, 0
    s_cbranch_scc1 F_QF
    buffer_store_dwordx4 v[32:35], v3, s[20:23], s53 offen sc0 sc1
    buffer_store_dwordx4 v[36:39], v3, s[20:23], s53 offen offset:1024 sc0 sc1
    v_mov_b32 v16, s59
    v_mov_b32 v17, 0
    s_waitcnt vmcnt(0)
    s_mov_b64 exec, 1
    buffer_store_dword v16, v17, s[20:23], s54 offen sc0 sc1
    s_mov_b64 exec, -1
    s_branch F_END
F_QF:
    buffer_store_dwordx4 v[32:35], v3, s[20:23], s53 offen
    buffer_store_dwordx4 v[36:39], v3, s[20:23], s53 offen offset:1024
    v_mov_b32 v16, s59
    v_mov_b32 v17, 0
    s_waitcnt vmcnt(0)
    s_mov_b64 exec, 1
    buffer_store_dword v16, v17, s[20:23], s54 offen
    s_mov_b64 exec, -1
F_END:
    s_lshl_b32 s6, s4, 8
    s_lshl_b32 s9, s5, 3
    s_add_u32 s6, s6, s9
    v_and_b32 v4, 31, v2
    v_lshrrev_b32 v5, 5, v2
    v_lshlrev_b32 v6, 5, v4
    v_lshl_add_u32 v6, v5, 4, v6
    v_lshrrev_b32 v7, 1, v4
    v_lshlrev_b32 v7, 11, v7
    v_lshl_add_u32 v7, v5, 10, v7
    v_and_b32 v8, 1, v4
    v_lshl_add_u32 v7, v8, 9, v7
    s_add_u32 s9, s6, s3
    s_and_b32 s9, s9, 31
    s_lshl_b32 s9, s9, 4
    s_lshl_b32 s10, s7, 15
    s_add_u32 s9, s9, s10
    s_add_u32 s9, s9, 2097152
    v_mov_b32 v8, v3
    v_lshl_add_u32 v9, v5, 4, v4
    v_lshlrev_b32 v9, 4, v9
    v_add_u32 v9, 0x400, v9
    v_cmp_gt_u32 s[32:33], 16, v4
    v_mov_b32 v11, 132096
    v_mov_b32 v12, 0x4000
    v_and_b32 v13, 27, v4
    v_cmp_eq_u32 s[34:35], 16, v13
    v_add_u32 v13, 16, v11
    s_nop 0
    v_cndmask_b32 v13, v13, v11, s[34:35]
    v_add_u32 v14, 4, v4
    v_and_b32 v14, 8, v14
    v_lshl_add_u32 v13, v14, 3, v13
    v_cndmask_b32 v9, v13, v9, s[32:33]
    v_cndmask_b32 v10, 0, v12, s[32:33]
    v_lshrrev_b32 v12, 1, v2
    v_lshlrev_b32 v12, 11, v12
    v_and_b32 v13, 1, v2
    v_lshl_add_u32 v12, v13, 9, v12
    v_add_u32 v12, v12, v11
    v_mov_b32 v96, 0x3f803f80
    v_mov_b32 v97, 0x3f803f80
    v_mov_b32 v98, 0x3f803f80
    v_mov_b32 v99, 0x3f803f80
    v_mov_b32 v100, 0
    v_mov_b32 v101, 0
    v_mov_b32 v102, 0
    v_mov_b32 v103, 0
    v_mov_b32 v76, 0
    v_mov_b32 v77, 0
    v_mov_b32 v78, 0
    v_mov_b32 v79, 0
    v_mov_b32 v80, 0
    v_mov_b32 v81, 0
    v_mov_b32 v82, 0
    v_mov_b32 v83, 0
    v_mov_b32 v84, 0
    v_mov_b32 v85, 0
    v_mov_b32 v86, 0
    v_mov_b32 v87, 0
    v_mov_b32 v88, 0
    v_mov_b32 v89, 0
    v_mov_b32 v90, 0
    v_mov_b32 v91, 0
    v_mov_b32 v56, 0
    v_mov_b32 v57, 0
    v_mov_b32 v58, 0
    v_mov_b32 v59, 0
    v_mov_b32 v66, 0
    v_mov_b32 v67, 0
    s_lshl_b32 s63, s3, 10
    s_mov_b32 s10, s63
    s_lshl_b32 s11, s4, 14
    s_add_u32 s11, s11, s10
    s_cmp_lg_u32 s3, 7
    s_cbranch_scc1 M_NP0
    v_and_b32 v13, 15, v2
    s_lshl_b32 s14, s7, 6
    s_lshl_b32 s15, s4, 7
    s_add_u32 s14, s14, 61440
    s_add_u32 s15, s15, 69632
    v_lshl_add_u32 v13, v13, 2, s14
    v_lshl_add_u32 v14, v4, 2, s15
    v_cmp_gt_u32 vcc, 32, v2
    s_mov_b32 s36, 0x80000
    s_nop 0
    v_cndmask_b32 v13, v13, v14, vcc
M_W0:
    buffer_load_dword v24, v13, s[20:23], 0 offen sc1
    s_waitcnt vmcnt(0)
    v_cmp_eq_u32 vcc, s59, v24
    s_nop 0
    s_cmp_eq_u64 vcc, -1
    s_cbranch_scc1 M_NP0
    s_sleep 1
    s_sub_u32 s36, s36, 1
    s_cmp_lg_u32 s36, 0
    s_cbranch_scc1 M_W0
M_NP0:
    s_barrier
    buffer_load_dwordx4 v[16:19], v7, s[20:23], s9 offen sc1
    s_mov_b32 m0, s10
    s_add_u32 s12, s11, 393216
    buffer_load_dwordx4 v3, s[20:23], s12 offen sc1 lds
    s_add_u32 s10, s10, 8192
    s_add_u32 s11, s11, 8192
    s_and_b32 s11, s11, 0x1ffff
    s_mov_b32 m0, s10
    s_add_u32 s12, s11, 393216
    buffer_load_dwordx4 v3, s[20:23], s12 offen sc1 lds
    s_add_u32 s10, s10, 8192
    s_add_u32 s11, s11, 8192
    s_and_b32 s11, s11, 0x1ffff
    s_mov_b64 exec, 0xffff
    ds_write_b128 v12, v[96:99]
    ds_write_b128 v12, v[100:103] offset:16
    ds_write_b128 v12, v[96:99] offset:64
    ds_write_b128 v12, v[100:103] offset:80
    s_mov_b64 exec, -1
    s_waitcnt vmcnt(0) lgkmcnt(0)
    s_barrier
    s_cmp_lg_u32 s3, 3
    s_cbranch_scc1 M_NWF
    s_cmp_ge_u32 s2, 128
    s_cbranch_scc1 M_NWF
    s_lshl_b32 s12, s2, 2
    s_add_u32 s12, s12, 58368
    v_mov_b32 v14, s59
    v_mov_b32 v15, 0
    s_mov_b64 exec, 1
    buffer_store_dword v14, v15, s[20:23], s12 offen sc0 sc1
    s_mov_b64 exec, -1
M_NWF:
    ds_read_b128 v[92:95], v8
    s_waitcnt lgkmcnt(0)
    v_mfma_f32_32x32x16_bf16 v[36:51], v[92:95], v[16:19], 0
    s_nop 11
    v_max3_f32 v12, v36, v37, v38
    v_max3_f32 v13, v39, v40, v41
    v_max3_f32 v12, v12, v42, v43
    v_max3_f32 v13, v13, v44, v45
    v_max3_f32 v12, v12, v46, v47
    v_max3_f32 v13, v13, v48, v49
    v_max3_f32 v12, v12, v50, v51
    v_max_f32 v12, v12, v13
    v_mov_b32 v13, v12
    s_nop 1
    v_permlane32_swap_b32 v12, v13
    v_max_f32 v12, v12, v13
    v_sub_f32 v20, 0, v12
    v_sub_f32 v21, 0, v12
    v_sub_f32 v22, 0, v12
    v_sub_f32 v23, 0, v12
    v_sub_f32 v24, 0, v12
    v_sub_f32 v25, 0, v12
    v_sub_f32 v26, 0, v12
    v_sub_f32 v27, 0, v12
    v_sub_f32 v28, 0, v12
    v_sub_f32 v29, 0, v12
    v_sub_f32 v30, 0, v12
    v_sub_f32 v31, 0, v12
    v_sub_f32 v32, 0, v12
    v_sub_f32 v33, 0, v12
    v_sub_f32 v34, 0, v12
    v_sub_f32 v35, 0, v12
    s_nop 1
    v_mfma_f32_32x32x16_bf16 v[36:51], v[92:95], v[16:19], v[20:35]
    ds_read_b128 v[92:95], v8 offset:2048
    ds_read_b128 v[96:99], v9
    s_nop 7
    v_lshlrev_b32 v12, 3, v2
    s_mov_b32 s15, 57344
    buffer_load_dwordx4 v[220:223], v3, s[20:23], s15 offen sc1
    v_exp_f32 v36, v36
    v_cvt_pk_bf16_f32 v59, v66, v67
    v_exp_f32 v37, v37
    v_exp_f32 v38, v38
    v_cvt_pk_bf16_f32 v36, v36, v37
    s_waitcnt lgkmcnt(2)
    v_mfma_f32_32x32x16_bf16 v[76:91], v[100:103], v[56:59], v[76:91]
    ds_read_b128 v[100:103], v9 offset:512
    v_exp_f32 v39, v39
    v_exp_f32 v40, v40
    v_cvt_pk_bf16_f32 v37, v38, v39
    s_cmp_lt_u32 s3, 4
    s_cbranch_scc1 M_Pa0
    s_setprio 1
M_Pa0:
    v_exp_f32 v41, v41
    v_exp_f32 v42, v42
    v_cvt_pk_bf16_f32 v38, v40, v41
    s_waitcnt lgkmcnt(2)
    v_mfma_f32_32x32x16_bf16 v[52:67], v[92:95], v[16:19], v[20:35]
    ds_read_b128 v[92:95], v8 offset:4096
    v_exp_f32 v43, v43
    v_exp_f32 v44, v44
    v_cvt_pk_bf16_f32 v39, v42, v43
    v_exp_f32 v45, v45
    v_exp_f32 v46, v46
    s_waitcnt lgkmcnt(2)
    v_mfma_f32_32x32x16_bf16 v[76:91], v[96:99], v[36:39], v[76:91]
    ds_read_b128 v[96:99], v9 offset:2048
    v_cvt_pk_bf16_f32 v40, v44, v45
    v_exp_f32 v47, v47
    v_exp_f32 v48, v48
    v_cvt_pk_bf16_f32 v41, v46, v47
    v_exp_f32 v49, v49
    v_exp_f32 v50, v50
    v_cvt_pk_bf16_f32 v42, v48, v49
    v_exp_f32 v51, v51
    v_exp_f32 v52, v52
    v_cvt_pk_bf16_f32 v43, v50, v51
    v_exp_f32 v53, v53
    v_exp_f32 v54, v54
    v_cvt_pk_bf16_f32 v52, v52, v53
    s_waitcnt lgkmcnt(2)
    v_mfma_f32_32x32x16_bf16 v[76:91], v[100:103], v[40:43], v[76:91]
    ds_read_b128 v[100:103], v9 offset:2560
    v_exp_f32 v55, v55
    v_exp_f32 v56, v56
    v_cvt_pk_bf16_f32 v53, v54, v55
    v_exp_f32 v57, v57
    v_exp_f32 v58, v58
    v_cvt_pk_bf16_f32 v54, v56, v57
    s_waitcnt lgkmcnt(2)
    v_mfma_f32_32x32x16_bf16 v[36:51], v[92:95], v[16:19], v[20:35]
    ds_read_b128 v[92:95], v8 offset:6144
    v_exp_f32 v59, v59
    v_exp_f32 v60, v60
    v_cvt_pk_bf16_f32 v55, v58, v59
    v_exp_f32 v61, v61
    v_exp_f32 v62, v62
    s_waitcnt lgkmcnt(2)
    v_mfma_f32_32x32x16_bf16 v[76:91], v[96:99], v[52:55], v[76:91]
    ds_read_b128 v[96:99], v9 offset:4096
    v_cvt_pk_bf16_f32 v56, v60, v61
    v_exp_f32 v63, v63
    v_exp_f32 v64, v64
    v_cvt_pk_bf16_f32 v57, v62, v63
    v_exp_f32 v65, v65
    v_exp_f32 v66, v66
    v_cvt_pk_bf16_f32 v58, v64, v65
    v_exp_f32 v67, v67
    v_exp_f32 v36, v36
    v_cvt_pk_bf16_f32 v59, v66, v67
    v_exp_f32 v37, v37
    v_exp_f32 v38, v38
    v_cvt_pk_bf16_f32 v36, v36, v37
    s_waitcnt lgkmcnt(2)
    v_mfma_f32_32x32x16_bf16 v[76:91], v[100:103], v[56:59], v[76:91]
    ds_read_b128 v[100:103], v9 offset:4608
    v_exp_f32 v39, v39
    v_exp_f32 v40, v40
    v_cvt_pk_bf16_f32 v37, v38, v39
    s_mov_b32 s36, 0x80000
M_GW:
    s_waitcnt vmcnt(0)
    v_xor_b32 v220, s59, v220
    v_xor_b32 v221, s59, v221
    v_xor_b32 v222, s59, v222
    v_xor_b32 v223, s59, v223
    v_or3_b32 v220, v220, v221, v222
    v_or_b32 v220, v220, v223
    v_cmp_eq_u32 vcc, 0, v220
    s_nop 0
    s_cmp_eq_u64 vcc, -1
    s_cbranch_scc1 M_GG
    s_sleep 4
    s_mov_b32 s15, 57344
    buffer_load_dwordx4 v[220:223], v3, s[20:23], s15 offen sc1
    s_sub_u32 s36, s36, 1
    s_cmp_lg_u32 s36, 0
    s_cbranch_scc1 M_GW
    s_waitcnt vmcnt(0)
M_GG:
    s_lshl_b32 s61, s4, 12
    s_add_u32 s61, s61, 81920
    v_exp_f32 v41, v41
    v_exp_f32 v42, v42
    v_cvt_pk_bf16_f32 v38, v40, v41
    s_waitcnt lgkmcnt(2)
    v_mfma_f32_32x32x16_bf16 v[52:67], v[92:95], v[16:19], v[20:35]
    ds_read_b128 v[92:95], v8 offset:8192
    v_exp_f32 v43, v43
    v_exp_f32 v44, v44
    v_cvt_pk_bf16_f32 v39, v42, v43
    v_exp_f32 v45, v45
    v_exp_f32 v46, v46
    s_waitcnt lgkmcnt(2)
    v_mfma_f32_32x32x16_bf16 v[76:91], v[96:99], v[36:39], v[76:91]
    ds_read_b128 v[96:99], v9 offset:6144
    v_cvt_pk_bf16_f32 v40, v44, v45
    v_exp_f32 v47, v47
    v_exp_f32 v48, v48
    v_cvt_pk_bf16_f32 v41, v46, v47
    s_mov_b32 m0, s10
    s_add_u32 s12, s11, 131072
    buffer_load_dwordx4 v3, s[20:23], s12 offen sc1 lds
    s_add_u32 s10, s10, 8192
    s_add_u32 s11, s11, 8192
    s_and_b32 s11, s11, 0x1ffff
    v_exp_f32 v49, v49
    v_exp_f32 v50, v50
    v_cvt_pk_bf16_f32 v42, v48, v49
    v_exp_f32 v51, v51
    s_mov_b32 m0, s10
    s_add_u32 s12, s11, 131072
    buffer_load_dwordx4 v3, s[20:23], s12 offen sc1 lds
    s_add_u32 s10, s10, 8192
    s_add_u32 s11, s11, 8192
    s_and_b32 s11, s11, 0x1ffff
    v_exp_f32 v52, v52
    v_cvt_pk_bf16_f32 v43, v50, v51
    v_exp_f32 v53, v53
    v_exp_f32 v54, v54
    v_cvt_pk_bf16_f32 v52, v52, v53
    s_waitcnt lgkmcnt(2)
    v_mfma_f32_32x32x16_bf16 v[76:91], v[100:103], v[40:43], v[76:91]
    ds_read_b128 v[100:103], v9 offset:6656
    v_exp_f32 v55, v55
    v_exp_f32 v56, v56
    v_cvt_pk_bf16_f32 v53, v54, v55
    s_mov_b32 m0, s10
    s_add_u32 s12, s11, 131072
    buffer_load_dwordx4 v3, s[20:23], s12 offen sc1 lds
    s_add_u32 s10, s10, 8192
    s_add_u32 s11, s11, 8192
    s_and_b32 s11, s11, 0x1ffff
    v_exp_f32 v57, v57
    v_exp_f32 v58, v58
    v_cvt_pk_bf16_f32 v54, v56, v57
    s_waitcnt lgkmcnt(2)
    v_mfma_f32_32x32x16_bf16 v[36:51], v[92:95], v[16:19], v[20:35]
    ds_read_b128 v[92:95], v8 offset:10240
    v_exp_f32 v59, v59
    v_exp_f32 v60, v60
    v_cvt_pk_bf16_f32 v55, v58, v59
    v_exp_f32 v61, v61
    v_exp_f32 v62, v62
    s_waitcnt lgkmcnt(2)
    v_mfma_f32_32x32x16_bf16 v[76:91], v[96:99], v[52:55], v[76:91]
    ds_read_b128 v[96:99], v9 offset:8192
    v_cvt_pk_bf16_f32 v56, v60, v61
    v_exp_f32 v63, v63
    v_exp_f32 v64, v64
    v_cvt_pk_bf16_f32 v57, v62, v63
    s_mov_b32 m0, s10
    s_add_u32 s12, s11, 131072
    buffer_load_dwordx4 v3, s[20:23], s12 offen sc1 lds
    s_add_u32 s10, s10, 8192
    s_add_u32 s11, s11, 8192
    s_and_b32 s11, s11, 0x1ffff
    v_exp_f32 v65, v65
    v_exp_f32 v66, v66
    v_cvt_pk_bf16_f32 v58, v64, v65
    v_exp_f32 v67, v67
    v_exp_f32 v36, v36
    v_cvt_pk_bf16_f32 v59, v66, v67
    v_exp_f32 v37, v37
    v_exp_f32 v38, v38
    v_cvt_pk_bf16_f32 v36, v36, v37
    s_waitcnt lgkmcnt(2)
    v_mfma_f32_32x32x16_bf16 v[76:91], v[100:103], v[56:59], v[76:91]
    ds_read_b128 v[100:103], v9 offset:8704
    v_exp_f32 v39, v39
    v_exp_f32 v40, v40
    v_cvt_pk_bf16_f32 v37, v38, v39
    s_cmp_lt_u32 s3, 4
    s_cbranch_scc1 M_Pb0
    s_setprio 0
M_Pb0:
    v_exp_f32 v41, v41
    v_exp_f32 v42, v42
    v_cvt_pk_bf16_f32 v38, v40, v41
    s_waitcnt lgkmcnt(2)
    v_mfma_f32_32x32x16_bf16 v[52:67], v[92:95], v[16:19], v[20:35]
    ds_read_b128 v[92:95], v8 offset:12288
    v_exp_f32 v43, v43
    v_exp_f32 v44, v44
    v_cvt_pk_bf16_f32 v39, v42, v43
    v_exp_f32 v45, v45
    v_exp_f32 v46, v46
    s_waitcnt lgkmcnt(2)
    v_mfma_f32_32x32x16_bf16 v[76:91], v[96:99], v[36:39], v[76:91]
    ds_read_b128 v[96:99], v9 offset:10240
    v_cvt_pk_bf16_f32 v40, v44, v45
    v_exp_f32 v47, v47
    v_exp_f32 v48, v48
    v_cvt_pk_bf16_f32 v41, v46, v47
    s_mov_b32 m0, s10
    s_add_u32 s12, s11, 131072
    buffer_load_dwordx4 v3, s[20:23], s12 offen sc1 lds
    s_add_u32 s10, s10, 8192
    s_add_u32 s11, s11, 8192
    s_and_b32 s11, s11, 0x1ffff
    v_exp_f32 v49, v49
    v_exp_f32 v50, v50
    v_cvt_pk_bf16_f32 v42, v48, v49
    v_exp_f32 v51, v51
    s_mov_b32 m0, s10
    s_add_u32 s12, s11, 131072
    buffer_load_dwordx4 v3, s[20:23], s12 offen sc1 lds
    s_add_u32 s10, s10, 8192
    s_add_u32 s11, s11, 8192
    s_and_b32 s11, s11, 0x1ffff
    v_exp_f32 v52, v52
    v_cvt_pk_bf16_f32 v43, v50, v51
    v_exp_f32 v53, v53
    v_exp_f32 v54, v54
    v_cvt_pk_bf16_f32 v52, v52, v53
    s_waitcnt lgkmcnt(2)
    v_mfma_f32_32x32x16_bf16 v[76:91], v[100:103], v[40:43], v[76:91]
    ds_read_b128 v[100:103], v9 offset:10752
    v_exp_f32 v55, v55
    v_exp_f32 v56, v56
    v_cvt_pk_bf16_f32 v53, v54, v55
    s_mov_b32 m0, s10
    s_add_u32 s12, s11, 131072
    buffer_load_dwordx4 v3, s[20:23], s12 offen sc1 lds
    s_add_u32 s10, s10, 8192
    s_add_u32 s11, s11, 8192
    s_and_b32 s11, s11, 0x1ffff
    v_exp_f32 v57, v57
    v_exp_f32 v58, v58
    v_cvt_pk_bf16_f32 v54, v56, v57
    s_waitcnt lgkmcnt(2)
    v_mfma_f32_32x32x16_bf16 v[36:51], v[92:95], v[16:19], v[20:35]
    ds_read_b128 v[92:95], v8 offset:14336
    v_exp_f32 v59, v59
    v_exp_f32 v60, v60
    v_cvt_pk_bf16_f32 v55, v58, v59
    v_exp_f32 v61, v61
    v_exp_f32 v62, v62
    s_waitcnt lgkmcnt(2)
    v_mfma_f32_32x32x16_bf16 v[76:91], v[96:99], v[52:55], v[76:91]
    ds_read_b128 v[96:99], v9 offset:12288
    v_cvt_pk_bf16_f32 v56, v60, v61
    v_exp_f32 v63, v63
    v_exp_f32 v64, v64
    v_cvt_pk_bf16_f32 v57, v62, v63
    s_mov_b32 m0, s10
    s_add_u32 s12, s11, 131072
    buffer_load_dwordx4 v3, s[20:23], s12 offen sc1 lds
    s_add_u32 s10, s10, 8192
    s_add_u32 s11, s11, 8192
    s_and_b32 s11, s11, 0x1ffff
    v_exp_f32 v65, v65
    v_exp_f32 v66, v66
    v_cvt_pk_bf16_f32 v58, v64, v65
    v_exp_f32 v67, v67
    s_waitcnt vmcnt(6)
    s_barrier
    v_exp_f32 v36, v36
    v_cvt_pk_bf16_f32 v59, v66, v67
    v_exp_f32 v37, v37
    v_exp_f32 v38, v38
    v_cvt_pk_bf16_f32 v36, v36, v37
    s_waitcnt lgkmcnt(2)
    v_mfma_f32_32x32x16_bf16 v[76:91], v[100:103], v[56:59], v[76:91]
    ds_read_b128 v[100:103], v9 offset:12800
    v_exp_f32 v39, v39
    v_exp_f32 v40, v40
    v_cvt_pk_bf16_f32 v37, v38, v39
    s_cmp_lt_u32 s3, 4
    s_cbranch_scc1 M_Pa6
    s_setprio 1
M_Pa6:
    v_exp_f32 v41, v41
    v_exp_f32 v42, v42
    v_cvt_pk_bf16_f32 v38, v40, v41
    s_waitcnt lgkmcnt(2)
    v_mfma_f32_32x32x16_bf16 v[52:67], v[92:95], v[16:19], v[20:35]
    ds_read_b128 v[92:95], v8 offset:16384
    v_exp_f32 v43, v43
    v_exp_f32 v44, v44
    v_cvt_pk_bf16_f32 v39, v42, v43
    v_exp_f32 v45, v45
    v_exp_f32 v46, v46
    s_waitcnt lgkmcnt(2)
    v_mfma_f32_32x32x16_bf16 v[76:91], v[96:99], v[36:39], v[76:91]
    ds_read_b128 v[96:99], v9 offset:14336
    v_cvt_pk_bf16_f32 v40, v44, v45
    v_exp_f32 v47, v47
    v_exp_f32 v48, v48
    v_cvt_pk_bf16_f32 v41, v46, v47
    s_mov_b32 m0, s10
    s_add_u32 s12, s11, 131072
    buffer_load_dwordx4 v3, s[20:23], s12 offen sc1 lds
    s_add_u32 s10, s10, 8192
    s_add_u32 s11, s11, 8192
    s_and_b32 s11, s11, 0x1ffff
    v_exp_f32 v49, v49
    v_exp_f32 v50, v50
    v_cvt_pk_bf16_f32 v42, v48, v49
    v_exp_f32 v51, v51
    s_mov_b32 m0, s10
    s_add_u32 s12, s11, 131072
    buffer_load_dwordx4 v3, s[20:23], s12 offen sc1 lds
    s_add_u32 s10, s10, 8192
    s_add_u32 s11, s11, 8192
    s_and_b32 s11, s11, 0x1ffff
    v_exp_f32 v52, v52
    v_cvt_pk_bf16_f32 v43, v50, v51
    v_exp_f32 v53, v53
    v_exp_f32 v54, v54
    v_cvt_pk_bf16_f32 v52, v52, v53
    s_waitcnt lgkmcnt(2)
    v_mfma_f32_32x32x16_bf16 v[76:91], v[100:103], v[40:43], v[76:91]
    ds_read_b128 v[100:103], v9 offset:14848
    v_exp_f32 v55, v55
    v_exp_f32 v56, v56
    v_cvt_pk_bf16_f32 v53, v54, v55
    s_mov_b32 m0, s10
    s_add_u32 s12, s11, 131072
    buffer_load_dwordx4 v3, s[20:23], s12 offen sc1 lds
    s_add_u32 s10, s10, 8192
    s_add_u32 s11, s11, 8192
    s_and_b32 s11, s11, 0x1ffff
    v_exp_f32 v57, v57
    v_exp_f32 v58, v58
    v_cvt_pk_bf16_f32 v54, v56, v57
    s_waitcnt lgkmcnt(2)
    v_mfma_f32_32x32x16_bf16 v[36:51], v[92:95], v[16:19], v[20:35]
    ds_read_b128 v[92:95], v8 offset:18432
    v_exp_f32 v59, v59
    v_exp_f32 v60, v60
    v_cvt_pk_bf16_f32 v55, v58, v59
    v_exp_f32 v61, v61
    v_exp_f32 v62, v62
    s_waitcnt lgkmcnt(2)
    v_mfma_f32_32x32x16_bf16 v[76:91], v[96:99], v[52:55], v[76:91]
    v_add_u32 v9, v9, v10
    ds_read_b128 v[96:99], v9
    v_add_u32 v8, 0x4000, v8
    v_cvt_pk_bf16_f32 v56, v60, v61
    v_exp_f32 v63, v63
    v_exp_f32 v64, v64
    v_cvt_pk_bf16_f32 v57, v62, v63
    s_mov_b32 m0, s10
    s_add_u32 s12, s11, 131072
    buffer_load_dwordx4 v3, s[20:23], s12 offen sc1 lds
    s_add_u32 s10, s10, 8192
    s_add_u32 s11, s11, 8192
    s_and_b32 s11, s11, 0x1ffff
    v_exp_f32 v65, v65
    v_exp_f32 v66, v66
    v_cvt_pk_bf16_f32 v58, v64, v65
    v_exp_f32 v67, v67
    v_exp_f32 v36, v36
    v_cvt_pk_bf16_f32 v59, v66, v67
    v_exp_f32 v37, v37
    v_exp_f32 v38, v38
    v_cvt_pk_bf16_f32 v36, v36, v37
    s_waitcnt lgkmcnt(2)
    v_mfma_f32_32x32x16_bf16 v[76:91], v[100:103], v[56:59], v[76:91]
    ds_read_b128 v[100:103], v9 offset:512
    v_exp_f32 v39, v39
    v_exp_f32 v40, v40
    v_cvt_pk_bf16_f32 v37, v38, v39
    s_mov_b32 m0, s10
    s_add_u32 s12, s11, 131072
    buffer_load_dwordx4 v3, s[20:23], s12 offen sc1 lds
    s_add_u32 s10, s10, 8192
    s_add_u32 s11, s11, 8192
    s_and_b32 s11, s11, 0x1ffff
    v_exp_f32 v41, v41
    v_exp_f32 v42, v42
    v_cvt_pk_bf16_f32 v38, v40, v41
    s_waitcnt lgkmcnt(2)
    v_mfma_f32_32x32x16_bf16 v[52:67], v[92:95], v[16:19], v[20:35]
    ds_read_b128 v[92:95], v8 offset:4096
    v_exp_f32 v43, v43
    v_exp_f32 v44, v44
    v_cvt_pk_bf16_f32 v39, v42, v43
    v_exp_f32 v45, v45
    v_exp_f32 v46, v46
    s_waitcnt lgkmcnt(2)
    v_mfma_f32_32x32x16_bf16 v[76:91], v[96:99], v[36:39], v[76:91]
    ds_read_b128 v[96:99], v9 offset:2048
    v_cvt_pk_bf16_f32 v40, v44, v45
    v_exp_f32 v47, v47
    v_exp_f32 v48, v48
    v_cvt_pk_bf16_f32 v41, v46, v47
    s_mov_b32 m0, s10
    s_add_u32 s12, s11, 131072
    buffer_load_dwordx4 v3, s[20:23], s12 offen sc1 lds
    v_exp_f32 v49, v49
    v_exp_f32 v50, v50
    v_cvt_pk_bf16_f32 v42, v48, v49
    v_exp_f32 v51, v51
    v_exp_f32 v52, v52
    v_cvt_pk_bf16_f32 v43, v50, v51
    v_exp_f32 v53, v53
    v_exp_f32 v54, v54
    v_cvt_pk_bf16_f32 v52, v52, v53
    s_waitcnt lgkmcnt(2)
    v_mfma_f32_32x32x16_bf16 v[76:91], v[100:103], v[40:43], v[76:91]
    ds_read_b128 v[100:103], v9 offset:2560
    v_exp_f32 v55, v55
    v_exp_f32 v56, v56
    v_cvt_pk_bf16_f32 v53, v54, v55
    v_and_b32 v13, 7, v2
    v_add_u32 v13, s6, v13
    v_lshlrev_b32 v14, 10, v13
    v_lshrrev_b32 v15, 3, v2
    v_lshl_add_u32 v14, v15, 4, v14
    s_lshl_b32 s12, s3, 7
    v_add_u32 v14, s12, v14
    s_lshl_b32 s13, s3, 16
    s_mul_i32 s62, s3, 28672
    s_lshl_b32 s12, s5, 7
    s_add_u32 s62, s62, s12
    s_add_u32 s13, s13, 1048576
    global_load_dwordx4 v[104:107], v14, s[16:17]
    v_exp_f32 v57, v57
    v_exp_f32 v58, v58
    v_cvt_pk_bf16_f32 v54, v56, v57
    s_waitcnt lgkmcnt(2)
    v_mfma_f32_32x32x16_bf16 v[36:51], v[92:95], v[16:19], v[20:35]
    ds_read_b128 v[92:95], v8 offset:6144
    v_exp_f32 v59, v59
    v_exp_f32 v60, v60
    v_cvt_pk_bf16_f32 v55, v58, v59
    v_exp_f32 v61, v61
    v_exp_f32 v62, v62
    s_waitcnt lgkmcnt(2)
    v_mfma_f32_32x32x16_bf16 v[76:91], v[96:99], v[52:55], v[76:91]
    ds_read_b128 v[96:99], v9 offset:4096
    v_cvt_pk_bf16_f32 v56, v60, v61
    v_exp_f32 v63, v63
    v_exp_f32 v64, v64
    v_cvt_pk_bf16_f32 v57, v62, v63
    s_mov_b32 s15, 58368
    buffer_load_dwordx2 v[216:217], v12, s[20:23], s15 offen sc1
    v_exp_f32 v65, v65
    v_exp_f32 v66, v66
    v_cvt_pk_bf16_f32 v58, v64, v65
    v_exp_f32 v67, v67
    s_cmp_lg_u32 s3, 2
    s_cbranch_scc1 M_MA
    s_lshl_b32 s38, s5, 9
    s_add_u32 s38, s38, 270336
    s_add_u32 s12, s38, 0
    buffer_load_dwordx2 v[240:241], v12, s[20:23], s12 offen sc1
    s_add_u32 s12, s38, 24576
    buffer_load_dwordx2 v[242:243], v12, s[20:23], s12 offen sc1
    s_add_u32 s12, s38, 49152
    buffer_load_dwordx2 v[244:245], v12, s[20:23], s12 offen sc1
    s_add_u32 s12, s38, 73728
    buffer_load_dwordx2 v[246:247], v12, s[20:23], s12 offen sc1
M_MA:
    v_exp_f32 v36, v36
    v_cvt_pk_bf16_f32 v59, v66, v67
    v_exp_f32 v37, v37
    v_exp_f32 v38, v38
    v_cvt_pk_bf16_f32 v36, v36, v37
    s_waitcnt lgkmcnt(2)
    v_mfma_f32_32x32x16_bf16 v[76:91], v[100:103], v[56:59], v[76:91]
    ds_read_b128 v[100:103], v9 offset:4608
    v_exp_f32 v39, v39
    v_exp_f32 v40, v40
    v_cvt_pk_bf16_f32 v37, v38, v39
    s_cmp_lt_u32 s3, 4
    s_cbranch_scc1 M_Pb6
    s_setprio 0
M_Pb6:
    v_exp_f32 v41, v41
    v_exp_f32 v42, v42
    v_cvt_pk_bf16_f32 v38, v40, v41
    s_waitcnt lgkmcnt(2)
    v_mfma_f32_32x32x16_bf16 v[52:67], v[92:95], v[16:19], v[20:35]
    ds_read_b128 v[92:95], v8 offset:8192
    v_exp_f32 v43, v43
    v_exp_f32 v44, v44
    v_cvt_pk_bf16_f32 v39, v42, v43
    v_exp_f32 v45, v45
    v_exp_f32 v46, v46
    s_waitcnt lgkmcnt(2)
    v_mfma_f32_32x32x16_bf16 v[76:91], v[96:99], v[36:39], v[76:91]
    ds_read_b128 v[96:99], v9 offset:6144
    v_cvt_pk_bf16_f32 v40, v44, v45
    v_exp_f32 v47, v47
    v_exp_f32 v48, v48
    v_cvt_pk_bf16_f32 v41, v46, v47
    s_mul_i32 s54, s5, 57344
    v_lshlrev_b32 v11, 7, v2
    s_and_b32 s65, s65, 0xffff
    s_mov_b32 s66, 1835008
    s_mov_b32 s67, 0x20000
    s_and_b32 s69, s69, 0xffff
    s_mov_b32 s70, 1835008
    s_mov_b32 s71, 0x20000
    s_and_b32 s73, s73, 0xffff
    s_mov_b32 s74, 1835008
    s_mov_b32 s75, 0x20000
    v_exp_f32 v49, v49
    v_exp_f32 v50, v50
    v_cvt_pk_bf16_f32 v42, v48, v49
    v_exp_f32 v51, v51
    s_lshl_b32 s12, s2, 3
    s_add_u32 s12, s12, s3
    s_cmp_lg_u32 s12, 1
    s_cbranch_scc1 M_NB
    v_mov_b32 v220, s59
    v_mov_b32 v221, 0
    s_mov_b32 s12, 55296
    s_mov_b64 exec, 1
    buffer_store_dword v220, v221, s[20:23], s12 offen
    s_mov_b64 exec, -1
M_NB:
    v_exp_f32 v52, v52
    v_cvt_pk_bf16_f32 v43, v50, v51
    v_exp_f32 v53, v53
    v_exp_f32 v54, v54
    v_cvt_pk_bf16_f32 v52, v52, v53
    s_waitcnt lgkmcnt(2)
    v_mfma_f32_32x32x16_bf16 v[76:91], v[100:103], v[40:43], v[76:91]
    ds_read_b128 v[100:103], v9 offset:6656
    v_exp_f32 v55, v55
    v_exp_f32 v56, v56
    v_cvt_pk_bf16_f32 v53, v54, v55
    v_exp_f32 v57, v57
    v_exp_f32 v58, v58
    v_cvt_pk_bf16_f32 v54, v56, v57
    s_waitcnt lgkmcnt(2)
    v_mfma_f32_32x32x16_bf16 v[36:51], v[92:95], v[16:19], v[20:35]
    ds_read_b128 v[92:95], v8 offset:10240
    v_exp_f32 v59, v59
    v_exp_f32 v60, v60
    v_cvt_pk_bf16_f32 v55, v58, v59
    v_exp_f32 v61, v61
    v_exp_f32 v62, v62
    s_waitcnt lgkmcnt(2)
    v_mfma_f32_32x32x16_bf16 v[76:91], v[96:99], v[52:55], v[76:91]
    ds_read_b128 v[96:99], v9 offset:8192
    v_cvt_pk_bf16_f32 v56, v60, v61
    v_exp_f32 v63, v63
    v_exp_f32 v64, v64
    v_cvt_pk_bf16_f32 v57, v62, v63
    v_exp_f32 v65, v65
    v_exp_f32 v66, v66
    v_cvt_pk_bf16_f32 v58, v64, v65
    v_exp_f32 v67, v67
    s_waitcnt vmcnt(0)
    s_barrier
    v_exp_f32 v36, v36
    v_cvt_pk_bf16_f32 v59, v66, v67
    v_exp_f32 v37, v37
    v_exp_f32 v38, v38
    v_cvt_pk_bf16_f32 v36, v36, v37
    s_waitcnt lgkmcnt(2)
    v_mfma_f32_32x32x16_bf16 v[76:91], v[100:103], v[56:59], v[76:91]
    ds_read_b128 v[100:103], v9 offset:8704
    v_exp_f32 v39, v39
    v_exp_f32 v40, v40
    v_cvt_pk_bf16_f32 v37, v38, v39
    s_cmp_lt_u32 s3, 4
    s_cbranch_scc1 M_Pa12
    s_setprio 1
M_Pa12:
    v_exp_f32 v41, v41
    v_exp_f32 v42, v42
    v_cvt_pk_bf16_f32 v38, v40, v41
    s_waitcnt lgkmcnt(2)
    v_mfma_f32_32x32x16_bf16 v[52:67], v[92:95], v[16:19], v[20:35]
    ds_read_b128 v[92:95], v8 offset:12288
    v_exp_f32 v43, v43
    v_exp_f32 v44, v44
    v_cvt_pk_bf16_f32 v39, v42, v43
    v_exp_f32 v45, v45
    v_exp_f32 v46, v46
    s_waitcnt lgkmcnt(2)
    v_mfma_f32_32x32x16_bf16 v[76:91], v[96:99], v[36:39], v[76:91]
    ds_read_b128 v[96:99], v9 offset:10240
    v_cvt_pk_bf16_f32 v40, v44, v45
    v_exp_f32 v47, v47
    v_exp_f32 v48, v48
    v_cvt_pk_bf16_f32 v41, v46, v47
    s_mov_b32 s36, 0x80000
M_WW:
    v_cmp_eq_u32 vcc, s59, v216
    v_cmp_eq_u32 s[34:35], s59, v217
    s_nop 0
    s_and_b64 vcc, vcc, s[34:35]
    s_cmp_eq_u64 vcc, -1
    s_cbranch_scc1 M_WG
    s_sleep 4
    buffer_load_dwordx2 v[216:217], v12, s[20:23], s15 offen sc1
    s_waitcnt vmcnt(0)
    s_sub_u32 s36, s36, 1
    s_cmp_lg_u32 s36, 0
    s_cbranch_scc1 M_WW
M_WG:
    v_exp_f32 v49, v49
    v_exp_f32 v50, v50
    v_cvt_pk_bf16_f32 v42, v48, v49
    v_exp_f32 v51, v51
    s_cmp_lg_u32 s3, 2
    s_cbranch_scc1 M_MB
    s_mov_b32 s39, 0x40000
M_MW:
    s_waitcnt vmcnt(0)
    v_xor_b32 v241, s59, v241
    v_xor_b32 v243, s59, v243
    v_xor_b32 v245, s59, v245
    v_xor_b32 v247, s59, v247
    v_or3_b32 v241, v241, v243, v245
    v_or_b32 v241, v241, v247
    v_cmp_eq_u32 vcc, 0, v241
    s_nop 0
    s_cmp_eq_u64 vcc, -1
    s_cbranch_scc1 M_MG
    s_add_u32 s12, s38, 0
    buffer_load_dwordx2 v[240:241], v12, s[20:23], s12 offen sc1
    s_add_u32 s12, s38, 24576
    buffer_load_dwordx2 v[242:243], v12, s[20:23], s12 offen sc1
    s_add_u32 s12, s38, 49152
    buffer_load_dwordx2 v[244:245], v12, s[20:23], s12 offen sc1
    s_add_u32 s12, s38, 73728
    buffer_load_dwordx2 v[246:247], v12, s[20:23], s12 offen sc1
    s_sub_u32 s39, s39, 1
    s_cmp_lg_u32 s39, 0
    s_cbranch_scc1 M_MW
    s_waitcnt vmcnt(0)
M_MG:
    v_add_f32 v240, v240, v242
    v_add_f32 v244, v244, v246
    v_add_f32 v240, v240, v244
    v_cvt_pk_bf16_f32 v240, v240, v240
    v_lshlrev_b32 v240, 16, v240
    s_lshr_b32 s12, s5, 3
    s_cmp_lg_u32 s12, 2
    s_cbranch_scc1 M_NOADD
    v_add_f32 v240, 1.0, v240
    v_cvt_pk_bf16_f32 v240, v240, v240
    v_lshlrev_b32 v240, 16, v240
M_NOADD:
    s_lshl_b32 s12, s4, 13
    s_lshl_b32 s39, s5, 8
    s_add_u32 s12, s12, s39
    s_add_u32 s12, s12, 1572864
    v_lshlrev_b32 v241, 2, v2
    buffer_store_dword v240, v241, s[20:23], s12 offen sc0 sc1
M_MB:
    s_cmp_lg_u32 s3, 0
    s_cbranch_scc1 M_To0
    s_lshl_b32 s55, s5, 14
    s_add_u32 s55, s55, 1048576
    buffer_load_dword v1, v11, s[20:23], s55 offen
M_To0:
    s_cmp_lg_u32 s3, 1
    s_cbranch_scc1 M_To1
    s_lshl_b32 s55, s5, 14
    s_add_u32 s55, s55, 1056768
    buffer_load_dword v1, v11, s[20:23], s55 offen
M_To1:
    v_exp_f32 v52, v52
    v_cvt_pk_bf16_f32 v43, v50, v51
    v_exp_f32 v53, v53
    v_exp_f32 v54, v54
    v_cvt_pk_bf16_f32 v52, v52, v53
    s_waitcnt lgkmcnt(2)
    v_mfma_f32_32x32x16_bf16 v[76:91], v[100:103], v[40:43], v[76:91]
    ds_read_b128 v[100:103], v9 offset:10752
    v_exp_f32 v55, v55
    v_exp_f32 v56, v56
    v_cvt_pk_bf16_f32 v53, v54, v55
    v_exp_f32 v57, v57
    v_exp_f32 v58, v58
    v_cvt_pk_bf16_f32 v54, v56, v57
    s_waitcnt lgkmcnt(2)
    v_mfma_f32_32x32x16_bf16 v[36:51], v[92:95], v[16:19], v[20:35]
    ds_read_b128 v[92:95], v8 offset:14336
    v_exp_f32 v59, v59
    v_exp_f32 v60, v60
    v_cvt_pk_bf16_f32 v55, v58, v59
    v_exp_f32 v61, v61
    v_exp_f32 v62, v62
    s_waitcnt lgkmcnt(2)
    v_mfma_f32_32x32x16_bf16 v[76:91], v[96:99], v[52:55], v[76:91]
    ds_read_b128 v[96:99], v9 offset:12288
    v_cvt_pk_bf16_f32 v56, v60, v61
    v_exp_f32 v63, v63
    v_exp_f32 v64, v64
    v_cvt_pk_bf16_f32 v57, v62, v63
    v_exp_f32 v65, v65
    v_exp_f32 v66, v66
    v_cvt_pk_bf16_f32 v58, v64, v65
    v_exp_f32 v67, v67
    v_exp_f32 v36, v36
    v_cvt_pk_bf16_f32 v59, v66, v67
    v_exp_f32 v37, v37
    v_exp_f32 v38, v38
    v_cvt_pk_bf16_f32 v36, v36, v37
    s_waitcnt lgkmcnt(2)
    v_mfma_f32_32x32x16_bf16 v[76:91], v[100:103], v[56:59], v[76:91]
    ds_read_b128 v[100:103], v9 offset:12800
    v_exp_f32 v39, v39
    v_exp_f32 v40, v40
    v_cvt_pk_bf16_f32 v37, v38, v39
    v_exp_f32 v41, v41
    v_exp_f32 v42, v42
    v_cvt_pk_bf16_f32 v38, v40, v41
    s_waitcnt lgkmcnt(2)
    v_mfma_f32_32x32x16_bf16 v[52:67], v[92:95], v[16:19], v[20:35]
    ds_read_b128 v[92:95], v8 offset:16384
    v_exp_f32 v43, v43
    v_exp_f32 v44, v44
    v_cvt_pk_bf16_f32 v39, v42, v43
    v_exp_f32 v45, v45
    v_exp_f32 v46, v46
    s_waitcnt lgkmcnt(2)
    v_mfma_f32_32x32x16_bf16 v[76:91], v[96:99], v[36:39], v[76:91]
    ds_read_b128 v[96:99], v9 offset:14336
    v_cvt_pk_bf16_f32 v40, v44, v45
    v_exp_f32 v47, v47
    v_exp_f32 v48, v48
    v_cvt_pk_bf16_f32 v41, v46, v47
    v_exp_f32 v49, v49
    v_exp_f32 v50, v50
    v_cvt_pk_bf16_f32 v42, v48, v49
    v_exp_f32 v51, v51
    v_exp_f32 v52, v52
    v_cvt_pk_bf16_f32 v43, v50, v51
    v_exp_f32 v53, v53
    v_exp_f32 v54, v54
    v_cvt_pk_bf16_f32 v52, v52, v53
    s_waitcnt lgkmcnt(2)
    v_mfma_f32_32x32x16_bf16 v[76:91], v[100:103], v[40:43], v[76:91]
    ds_read_b128 v[100:103], v9 offset:14848
    v_exp_f32 v55, v55
    v_exp_f32 v56, v56
    v_cvt_pk_bf16_f32 v53, v54, v55
    s_cmp_lg_u32 s3, 2
    s_cbranch_scc1 M_MC
    s_lshl_b32 s12, s4, 5
    s_add_u32 s12, s12, s5
    s_lshl_b32 s12, s12, 2
    s_add_u32 s12, s12, 71680
    v_mov_b32 v12, s59
    v_mov_b32 v13, 0
    s_waitcnt vmcnt(0)
    s_mov_b64 exec, 1
    buffer_store_dword v12, v13, s[20:23], s12 offen sc0 sc1
    s_mov_b64 exec, -1
M_MC:
    v_exp_f32 v57, v57
    v_exp_f32 v58, v58
    v_cvt_pk_bf16_f32 v54, v56, v57
    s_waitcnt lgkmcnt(2)
    v_mfma_f32_32x32x16_bf16 v[36:51], v[92:95], v[16:19], v[20:35]
    ds_read_b128 v[92:95], v8 offset:18432
    v_exp_f32 v59, v59
    v_exp_f32 v60, v60
    v_cvt_pk_bf16_f32 v55, v58, v59
    v_exp_f32 v61, v61
    v_exp_f32 v62, v62
    s_waitcnt lgkmcnt(2)
    v_mfma_f32_32x32x16_bf16 v[76:91], v[96:99], v[52:55], v[76:91]
    v_add_u32 v9, v9, v10
    ds_read_b128 v[96:99], v9
    v_add_u32 v8, 0x4000, v8
    v_cvt_pk_bf16_f32 v56, v60, v61
    v_exp_f32 v63, v63
    v_exp_f32 v64, v64
    v_cvt_pk_bf16_f32 v57, v62, v63
    v_exp_f32 v65, v65
    v_exp_f32 v66, v66
    v_cvt_pk_bf16_f32 v58, v64, v65
    v_exp_f32 v67, v67
    v_exp_f32 v36, v36
    v_cvt_pk_bf16_f32 v59, v66, v67
    v_exp_f32 v37, v37
    v_exp_f32 v38, v38
    v_cvt_pk_bf16_f32 v36, v36, v37
    s_waitcnt lgkmcnt(2)
    v_mfma_f32_32x32x16_bf16 v[76:91], v[100:103], v[56:59], v[76:91]
    ds_read_b128 v[100:103], v9 offset:512
    v_exp_f32 v39, v39
    v_exp_f32 v40, v40
    v_cvt_pk_bf16_f32 v37, v38, v39
    s_lshl_b32 s10, s63, 1
    s_add_u32 s10, s10, 131072
    s_mov_b32 m0, s10
    s_add_u32 s12, s13, 58368
    buffer_load_dwordx4 v3, s[20:23], s12 offen sc1 lds
    v_exp_f32 v41, v41
    v_exp_f32 v42, v42
    v_cvt_pk_bf16_f32 v38, v40, v41
    s_waitcnt lgkmcnt(2)
    v_mfma_f32_32x32x16_bf16 v[52:67], v[92:95], v[16:19], v[20:35]
    ds_read_b128 v[92:95], v8 offset:4096
    v_exp_f32 v43, v43
    v_exp_f32 v44, v44
    v_cvt_pk_bf16_f32 v39, v42, v43
    v_exp_f32 v45, v45
    v_exp_f32 v46, v46
    s_waitcnt lgkmcnt(2)
    v_mfma_f32_32x32x16_bf16 v[76:91], v[96:99], v[36:39], v[76:91]
    ds_read_b128 v[96:99], v9 offset:2048
    v_cvt_pk_bf16_f32 v40, v44, v45
    v_exp_f32 v47, v47
    v_exp_f32 v48, v48
    v_cvt_pk_bf16_f32 v41, v46, v47
    s_add_u32 s12, s13, 0
    buffer_load_dwordx4 v[108:111], v3, s[20:23], s12 offen sc1
    v_exp_f32 v49, v49
    v_exp_f32 v50, v50
    v_cvt_pk_bf16_f32 v42, v48, v49
    v_exp_f32 v51, v51
    s_add_u32 s12, s13, 16384
    buffer_load_dwordx4 v[112:115], v3, s[20:23], s12 offen sc1
    s_add_u32 s12, s13, 32768
    buffer_load_dwordx4 v[116:119], v3, s[20:23], s12 offen sc1
    v_exp_f32 v52, v52
    v_cvt_pk_bf16_f32 v43, v50, v51
    v_exp_f32 v53, v53
    v_exp_f32 v54, v54
    v_cvt_pk_bf16_f32 v52, v52, v53
    s_waitcnt lgkmcnt(2)
    v_mfma_f32_32x32x16_bf16 v[76:91], v[100:103], v[40:43], v[76:91]
    ds_read_b128 v[100:103], v9 offset:2560
    v_exp_f32 v55, v55
    v_exp_f32 v56, v56
    v_cvt_pk_bf16_f32 v53, v54, v55
    s_cmp_lt_u32 s3, 4
    s_cbranch_scc1 M_Pb12
    s_setprio 0
M_Pb12:
    v_exp_f32 v57, v57
    v_exp_f32 v58, v58
    v_cvt_pk_bf16_f32 v54, v56, v57
    s_waitcnt lgkmcnt(2)
    v_mfma_f32_32x32x16_bf16 v[36:51], v[92:95], v[16:19], v[20:35]
    ds_read_b128 v[92:95], v8 offset:6144
    v_exp_f32 v59, v59
    v_exp_f32 v60, v60
    v_cvt_pk_bf16_f32 v55, v58, v59
    v_exp_f32 v61, v61
    v_exp_f32 v62, v62
    s_waitcnt lgkmcnt(2)
    v_mfma_f32_32x32x16_bf16 v[76:91], v[96:99], v[52:55], v[76:91]
    ds_read_b128 v[96:99], v9 offset:4096
    v_cvt_pk_bf16_f32 v56, v60, v61
    v_exp_f32 v63, v63
    v_exp_f32 v64, v64
    v_cvt_pk_bf16_f32 v57, v62, v63
    s_add_u32 s12, s13, 49152
    buffer_load_dwordx4 v[120:123], v3, s[20:23], s12 offen sc1
    v_exp_f32 v65, v65
    v_exp_f32 v66, v66
    v_cvt_pk_bf16_f32 v58, v64, v65
    v_exp_f32 v67, v67
    s_add_u32 s12, s13, 1024
    buffer_load_dwordx4 v[124:127], v3, s[20:23], s12 offen sc1
    v_exp_f32 v36, v36
    v_cvt_pk_bf16_f32 v59, v66, v67
    v_exp_f32 v37, v37
    v_exp_f32 v38, v38
    v_cvt_pk_bf16_f32 v36, v36, v37
    s_waitcnt lgkmcnt(2)
    v_mfma_f32_32x32x16_bf16 v[76:91], v[100:103], v[56:59], v[76:91]
    ds_read_b128 v[100:103], v9 offset:4608
    v_exp_f32 v39, v39
    v_exp_f32 v40, v40
    v_cvt_pk_bf16_f32 v37, v38, v39
    s_add_u32 s12, s13, 17408
    buffer_load_dwordx4 v[128:131], v3, s[20:23], s12 offen sc1
    v_exp_f32 v41, v41
    v_exp_f32 v42, v42
    v_cvt_pk_bf16_f32 v38, v40, v41
    s_waitcnt lgkmcnt(2)
    v_mfma_f32_32x32x16_bf16 v[52:67], v[92:95], v[16:19], v[20:35]
    ds_read_b128 v[92:95], v8 offset:8192
    v_exp_f32 v43, v43
    v_exp_f32 v44, v44
    v_cvt_pk_bf16_f32 v39, v42, v43
    v_exp_f32 v45, v45
    v_exp_f32 v46, v46
    s_waitcnt lgkmcnt(2)
    v_mfma_f32_32x32x16_bf16 v[76:91], v[96:99], v[36:39], v[76:91]
    ds_read_b128 v[96:99], v9 offset:6144
    v_cvt_pk_bf16_f32 v40, v44, v45
    v_exp_f32 v47, v47
    v_exp_f32 v48, v48
    v_cvt_pk_bf16_f32 v41, v46, v47
    s_add_u32 s12, s13, 33792
    buffer_load_dwordx4 v[132:135], v3, s[20:23], s12 offen sc1
    v_exp_f32 v49, v49
    v_exp_f32 v50, v50
    v_cvt_pk_bf16_f32 v42, v48, v49
    v_exp_f32 v51, v51
    v_exp_f32 v52, v52
    v_cvt_pk_bf16_f32 v43, v50, v51
    v_exp_f32 v53, v53
    v_exp_f32 v54, v54
    v_cvt_pk_bf16_f32 v52, v52, v53
    s_waitcnt lgkmcnt(2)
    v_mfma_f32_32x32x16_bf16 v[76:91], v[100:103], v[40:43], v[76:91]
    ds_read_b128 v[100:103], v9 offset:6656
    v_exp_f32 v55, v55
    v_exp_f32 v56, v56
    v_cvt_pk_bf16_f32 v53, v54, v55
    s_cmp_lt_u32 s3, 4
    s_cbranch_scc1 M_Pa19
    s_setprio 1
M_Pa19:
    v_exp_f32 v57, v57
    v_exp_f32 v58, v58
    v_cvt_pk_bf16_f32 v54, v56, v57
    s_waitcnt lgkmcnt(2)
    v_mfma_f32_32x32x16_bf16 v[36:51], v[92:95], v[16:19], v[20:35]
    ds_read_b128 v[92:95], v8 offset:10240
    v_exp_f32 v59, v59
    v_exp_f32 v60, v60
    v_cvt_pk_bf16_f32 v55, v58, v59
    v_exp_f32 v61, v61
    v_exp_f32 v62, v62
    s_waitcnt lgkmcnt(2)
    v_mfma_f32_32x32x16_bf16 v[76:91], v[96:99], v[52:55], v[76:91]
    ds_read_b128 v[96:99], v9 offset:8192
    v_cvt_pk_bf16_f32 v56, v60, v61
    v_exp_f32 v63, v63
    v_exp_f32 v64, v64
    v_cvt_pk_bf16_f32 v57, v62, v63
    s_add_u32 s12, s13, 50176
    buffer_load_dwordx4 v[136:139], v3, s[20:23], s12 offen sc1
    v_exp_f32 v65, v65
    v_exp_f32 v66, v66
    v_cvt_pk_bf16_f32 v58, v64, v65
    v_exp_f32 v67, v67
    s_add_u32 s12, s13, 2048
    buffer_load_dwordx4 v[140:143], v3, s[20:23], s12 offen sc1
    s_add_u32 s12, s13, 18432
    buffer_load_dwordx4 v[144:147], v3, s[20:23], s12 offen sc1
    v_exp_f32 v36, v36
    v_cvt_pk_bf16_f32 v59, v66, v67
    v_exp_f32 v37, v37
    v_exp_f32 v38, v38
    v_cvt_pk_bf16_f32 v36, v36, v37
    s_waitcnt lgkmcnt(2)
    v_mfma_f32_32x32x16_bf16 v[76:91], v[100:103], v[56:59], v[76:91]
    ds_read_b128 v[100:103], v9 offset:8704
    v_exp_f32 v39, v39
    v_exp_f32 v40, v40
    v_cvt_pk_bf16_f32 v37, v38, v39
    s_add_u32 s12, s13, 34816
    buffer_load_dwordx4 v[148:151], v3, s[20:23], s12 offen sc1
    v_exp_f32 v41, v41
    v_exp_f32 v42, v42
    v_cvt_pk_bf16_f32 v38, v40, v41
    s_waitcnt lgkmcnt(2)
    v_mfma_f32_32x32x16_bf16 v[52:67], v[92:95], v[16:19], v[20:35]
    ds_read_b128 v[92:95], v8 offset:12288
    v_exp_f32 v43, v43
    v_exp_f32 v44, v44
    v_cvt_pk_bf16_f32 v39, v42, v43
    v_exp_f32 v45, v45
    v_exp_f32 v46, v46
    s_waitcnt lgkmcnt(2)
    v_mfma_f32_32x32x16_bf16 v[76:91], v[96:99], v[36:39], v[76:91]
    ds_read_b128 v[96:99], v9 offset:10240
    v_cvt_pk_bf16_f32 v40, v44, v45
    v_exp_f32 v47, v47
    v_exp_f32 v48, v48
    v_cvt_pk_bf16_f32 v41, v46, v47
    s_add_u32 s12, s13, 51200
    buffer_load_dwordx4 v[152:155], v3, s[20:23], s12 offen sc1
    v_exp_f32 v49, v49
    v_exp_f32 v50, v50
    v_cvt_pk_bf16_f32 v42, v48, v49
    v_exp_f32 v51, v51
    v_exp_f32 v52, v52
    v_cvt_pk_bf16_f32 v43, v50, v51
    v_exp_f32 v53, v53
    v_exp_f32 v54, v54
    v_cvt_pk_bf16_f32 v52, v52, v53
    s_waitcnt lgkmcnt(2)
    v_mfma_f32_32x32x16_bf16 v[76:91], v[100:103], v[40:43], v[76:91]
    ds_read_b128 v[100:103], v9 offset:10752
    v_exp_f32 v55, v55
    v_exp_f32 v56, v56
    v_cvt_pk_bf16_f32 v53, v54, v55
    s_add_u32 s12, s13, 3072
    buffer_load_dwordx4 v[156:159], v3, s[20:23], s12 offen sc1
    v_exp_f32 v57, v57
    v_exp_f32 v58, v58
    v_cvt_pk_bf16_f32 v54, v56, v57
    s_waitcnt lgkmcnt(2)
    v_mfma_f32_32x32x16_bf16 v[36:51], v[92:95], v[16:19], v[20:35]
    ds_read_b128 v[92:95], v8 offset:14336
    v_exp_f32 v59, v59
    v_exp_f32 v60, v60
    v_cvt_pk_bf16_f32 v55, v58, v59
    v_exp_f32 v61, v61
    v_exp_f32 v62, v62
    s_waitcnt lgkmcnt(2)
    v_mfma_f32_32x32x16_bf16 v[76:91], v[96:99], v[52:55], v[76:91]
    ds_read_b128 v[96:99], v9 offset:12288
    v_cvt_pk_bf16_f32 v56, v60, v61
    v_exp_f32 v63, v63
    v_exp_f32 v64, v64
    v_cvt_pk_bf16_f32 v57, v62, v63
    s_add_u32 s12, s13, 19456
    buffer_load_dwordx4 v[160:163], v3, s[20:23], s12 offen sc1
    v_exp_f32 v65, v65
    v_exp_f32 v66, v66
    v_cvt_pk_bf16_f32 v58, v64, v65
    v_exp_f32 v67, v67
    v_exp_f32 v36, v36
    v_cvt_pk_bf16_f32 v59, v66, v67
    v_exp_f32 v37, v37
    v_exp_f32 v38, v38
    v_cvt_pk_bf16_f32 v36, v36, v37
    s_waitcnt lgkmcnt(2)
    v_mfma_f32_32x32x16_bf16 v[76:91], v[100:103], v[56:59], v[76:91]
    ds_read_b128 v[100:103], v9 offset:12800
    v_exp_f32 v39, v39
    v_exp_f32 v40, v40
    v_cvt_pk_bf16_f32 v37, v38, v39
    s_add_u32 s12, s13, 35840
    buffer_load_dwordx4 v[164:167], v3, s[20:23], s12 offen sc1
    v_exp_f32 v41, v41
    v_exp_f32 v42, v42
    v_cvt_pk_bf16_f32 v38, v40, v41
    s_waitcnt lgkmcnt(2)
    v_mfma_f32_32x32x16_bf16 v[52:67], v[92:95], v[16:19], v[20:35]
    ds_read_b128 v[92:95], v8 offset:16384
    v_exp_f32 v43, v43
    v_exp_f32 v44, v44
    v_cvt_pk_bf16_f32 v39, v42, v43
    v_exp_f32 v45, v45
    v_exp_f32 v46, v46
    s_waitcnt lgkmcnt(2)
    v_mfma_f32_32x32x16_bf16 v[76:91], v[96:99], v[36:39], v[76:91]
    ds_read_b128 v[96:99], v9 offset:14336
    v_cvt_pk_bf16_f32 v40, v44, v45
    v_exp_f32 v47, v47
    v_exp_f32 v48, v48
    v_cvt_pk_bf16_f32 v41, v46, v47
    s_add_u32 s12, s13, 52224
    buffer_load_dwordx4 v[168:171], v3, s[20:23], s12 offen sc1
    v_exp_f32 v49, v49
    v_exp_f32 v50, v50
    v_cvt_pk_bf16_f32 v42, v48, v49
    v_exp_f32 v51, v51
    s_add_u32 s12, s13, 4096
    buffer_load_dwordx4 v[172:175], v3, s[20:23], s12 offen sc1
    v_exp_f32 v52, v52
    v_cvt_pk_bf16_f32 v43, v50, v51
    v_exp_f32 v53, v53
    v_exp_f32 v54, v54
    v_cvt_pk_bf16_f32 v52, v52, v53
    s_waitcnt lgkmcnt(2)
    v_mfma_f32_32x32x16_bf16 v[76:91], v[100:103], v[40:43], v[76:91]
    ds_read_b128 v[100:103], v9 offset:14848
    v_exp_f32 v55, v55
    v_exp_f32 v56, v56
    v_cvt_pk_bf16_f32 v53, v54, v55
    s_add_u32 s12, s13, 20480
    buffer_load_dwordx4 v[176:179], v3, s[20:23], s12 offen sc1
    v_exp_f32 v57, v57
    v_exp_f32 v58, v58
    v_cvt_pk_bf16_f32 v54, v56, v57
    s_waitcnt lgkmcnt(2)
    v_mfma_f32_32x32x16_bf16 v[36:51], v[92:95], v[16:19], v[20:35]
    ds_read_b128 v[92:95], v8 offset:18432
    v_exp_f32 v59, v59
    v_exp_f32 v60, v60
    v_cvt_pk_bf16_f32 v55, v58, v59
    v_exp_f32 v61, v61
    v_exp_f32 v62, v62
    s_waitcnt lgkmcnt(2)
    v_mfma_f32_32x32x16_bf16 v[76:91], v[96:99], v[52:55], v[76:91]
    v_add_u32 v9, v9, v10
    ds_read_b128 v[96:99], v9
    v_add_u32 v8, 0x4000, v8
    v_cvt_pk_bf16_f32 v56, v60, v61
    v_exp_f32 v63, v63
    v_exp_f32 v64, v64
    v_cvt_pk_bf16_f32 v57, v62, v63
    s_add_u32 s12, s13, 36864
    buffer_load_dwordx4 v[180:183], v3, s[20:23], s12 offen sc1
    v_exp_f32 v65, v65
    v_exp_f32 v66, v66
    v_cvt_pk_bf16_f32 v58, v64, v65
    v_exp_f32 v67, v67
    v_exp_f32 v36, v36
    v_cvt_pk_bf16_f32 v59, v66, v67
    v_exp_f32 v37, v37
    v_exp_f32 v38, v38
    v_cvt_pk_bf16_f32 v36, v36, v37
    s_waitcnt lgkmcnt(2)
    v_mfma_f32_32x32x16_bf16 v[76:91], v[100:103], v[56:59], v[76:91]
    ds_read_b128 v[100:103], v9 offset:512
    v_exp_f32 v39, v39
    v_exp_f32 v40, v40
    v_cvt_pk_bf16_f32 v37, v38, v39
    s_cmp_lt_u32 s3, 4
    s_cbranch_scc1 M_Pb19
    s_setprio 0
M_Pb19:
    v_exp_f32 v41, v41
    v_exp_f32 v42, v42
    v_cvt_pk_bf16_f32 v38, v40, v41
    s_waitcnt lgkmcnt(2)
    v_mfma_f32_32x32x16_bf16 v[52:67], v[92:95], v[16:19], v[20:35]
    ds_read_b128 v[92:95], v8 offset:4096
    v_exp_f32 v43, v43
    v_exp_f32 v44, v44
    v_cvt_pk_bf16_f32 v39, v42, v43
    v_exp_f32 v45, v45
    v_exp_f32 v46, v46
    s_waitcnt lgkmcnt(2)
    v_mfma_f32_32x32x16_bf16 v[76:91], v[96:99], v[36:39], v[76:91]
    ds_read_b128 v[96:99], v9 offset:2048
    v_cvt_pk_bf16_f32 v40, v44, v45
    v_exp_f32 v47, v47
    v_exp_f32 v48, v48
    v_cvt_pk_bf16_f32 v41, v46, v47
    s_add_u32 s12, s13, 53248
    buffer_load_dwordx4 v[184:187], v3, s[20:23], s12 offen sc1
    v_exp_f32 v49, v49
    v_exp_f32 v50, v50
    v_cvt_pk_bf16_f32 v42, v48, v49
    v_exp_f32 v51, v51
    s_add_u32 s12, s13, 5120
    buffer_load_dwordx4 v[188:191], v3, s[20:23], s12 offen sc1
    v_exp_f32 v52, v52
    v_cvt_pk_bf16_f32 v43, v50, v51
    v_exp_f32 v53, v53
    v_exp_f32 v54, v54
    v_cvt_pk_bf16_f32 v52, v52, v53
    s_waitcnt lgkmcnt(2)
    v_mfma_f32_32x32x16_bf16 v[76:91], v[100:103], v[40:43], v[76:91]
    ds_read_b128 v[100:103], v9 offset:2560
    v_exp_f32 v55, v55
    v_exp_f32 v56, v56
    v_cvt_pk_bf16_f32 v53, v54, v55
    s_add_u32 s12, s13, 21504
    buffer_load_dwordx4 v[192:195], v3, s[20:23], s12 offen sc1
    v_exp_f32 v57, v57
    v_exp_f32 v58, v58
    v_cvt_pk_bf16_f32 v54, v56, v57
    s_waitcnt lgkmcnt(2)
    v_mfma_f32_32x32x16_bf16 v[36:51], v[92:95], v[16:19], v[20:35]
    ds_read_b128 v[92:95], v8 offset:6144
    v_exp_f32 v59, v59
    v_exp_f32 v60, v60
    v_cvt_pk_bf16_f32 v55, v58, v59
    v_exp_f32 v61, v61
    v_exp_f32 v62, v62
    s_waitcnt lgkmcnt(2)
    v_mfma_f32_32x32x16_bf16 v[76:91], v[96:99], v[52:55], v[76:91]
    ds_read_b128 v[96:99], v9 offset:4096
    v_cvt_pk_bf16_f32 v56, v60, v61
    v_exp_f32 v63, v63
    v_exp_f32 v64, v64
    v_cvt_pk_bf16_f32 v57, v62, v63
    s_add_u32 s12, s13, 37888
    buffer_load_dwordx4 v[196:199], v3, s[20:23], s12 offen sc1
    v_exp_f32 v65, v65
    v_exp_f32 v66, v66
    v_cvt_pk_bf16_f32 v58, v64, v65
    v_exp_f32 v67, v67
    v_exp_f32 v36, v36
    v_cvt_pk_bf16_f32 v59, v66, v67
    v_exp_f32 v37, v37
    v_exp_f32 v38, v38
    v_cvt_pk_bf16_f32 v36, v36, v37
    s_waitcnt lgkmcnt(2)
    v_mfma_f32_32x32x16_bf16 v[76:91], v[100:103], v[56:59], v[76:91]
    ds_read_b128 v[100:103], v9 offset:4608
    v_exp_f32 v39, v39
    v_exp_f32 v40, v40
    v_cvt_pk_bf16_f32 v37, v38, v39
    s_cmp_lt_u32 s3, 4
    s_cbranch_scc1 M_Pa26
    s_setprio 1
M_Pa26:
    v_exp_f32 v41, v41
    v_exp_f32 v42, v42
    v_cvt_pk_bf16_f32 v38, v40, v41
    s_waitcnt lgkmcnt(2)
    v_mfma_f32_32x32x16_bf16 v[52:67], v[92:95], v[16:19], v[20:35]
    ds_read_b128 v[92:95], v8 offset:8192
    v_exp_f32 v43, v43
    v_exp_f32 v44, v44
    v_cvt_pk_bf16_f32 v39, v42, v43
    v_exp_f32 v45, v45
    v_exp_f32 v46, v46
    s_waitcnt lgkmcnt(2)
    v_mfma_f32_32x32x16_bf16 v[76:91], v[96:99], v[36:39], v[76:91]
    ds_read_b128 v[96:99], v9 offset:6144
    v_cvt_pk_bf16_f32 v40, v44, v45
    v_exp_f32 v47, v47
    v_exp_f32 v48, v48
    v_cvt_pk_bf16_f32 v41, v46, v47
    s_lshl_b32 s38, s4, 7
    s_add_u32 s38, s38, 71680
    v_lshlrev_b32 v13, 2, v4
    buffer_load_dword v12, v13, s[20:23], s38 offen sc1
    v_exp_f32 v49, v49
    v_exp_f32 v50, v50
    v_cvt_pk_bf16_f32 v42, v48, v49
    v_exp_f32 v51, v51
    s_add_u32 s12, s13, 54272
    buffer_load_dwordx4 v[200:203], v3, s[20:23], s12 offen sc1
    s_add_u32 s12, s13, 6144
    buffer_load_dwordx4 v[204:207], v3, s[20:23], s12 offen sc1
    s_add_u32 s12, s13, 22528
    buffer_load_dwordx4 v[208:211], v3, s[20:23], s12 offen sc1
    v_exp_f32 v52, v52
    v_cvt_pk_bf16_f32 v43, v50, v51
    v_exp_f32 v53, v53
    v_exp_f32 v54, v54
    v_cvt_pk_bf16_f32 v52, v52, v53
    s_waitcnt lgkmcnt(2)
    v_mfma_f32_32x32x16_bf16 v[76:91], v[100:103], v[40:43], v[76:91]
    ds_read_b128 v[100:103], v9 offset:6656
    v_exp_f32 v55, v55
    v_exp_f32 v56, v56
    v_cvt_pk_bf16_f32 v53, v54, v55
    s_add_u32 s12, s13, 38912
    buffer_load_dwordx4 v[212:215], v3, s[20:23], s12 offen sc1
    v_exp_f32 v57, v57
    v_exp_f32 v58, v58
    v_cvt_pk_bf16_f32 v54, v56, v57
    s_waitcnt lgkmcnt(2)
    v_mfma_f32_32x32x16_bf16 v[36:51], v[92:95], v[16:19], v[20:35]
    ds_read_b128 v[92:95], v8 offset:10240
    v_exp_f32 v59, v59
    v_exp_f32 v60, v60
    v_cvt_pk_bf16_f32 v55, v58, v59
    v_exp_f32 v61, v61
    v_exp_f32 v62, v62
    s_waitcnt lgkmcnt(2)
    v_mfma_f32_32x32x16_bf16 v[76:91], v[96:99], v[52:55], v[76:91]
    ds_read_b128 v[96:99], v9 offset:8192
    v_cvt_pk_bf16_f32 v56, v60, v61
    v_exp_f32 v63, v63
    v_exp_f32 v64, v64
    v_cvt_pk_bf16_f32 v57, v62, v63
    s_add_u32 s12, s13, 55296
    buffer_load_dwordx4 v[216:219], v3, s[20:23], s12 offen sc1
    v_exp_f32 v65, v65
    v_exp_f32 v66, v66
    v_cvt_pk_bf16_f32 v58, v64, v65
    v_exp_f32 v67, v67
    v_exp_f32 v36, v36
    v_cvt_pk_bf16_f32 v59, v66, v67
    v_exp_f32 v37, v37
    v_exp_f32 v38, v38
    v_cvt_pk_bf16_f32 v36, v36, v37
    s_waitcnt lgkmcnt(2)
    v_mfma_f32_32x32x16_bf16 v[76:91], v[100:103], v[56:59], v[76:91]
    ds_read_b128 v[100:103], v9 offset:8704
    v_exp_f32 v39, v39
    v_exp_f32 v40, v40
    v_cvt_pk_bf16_f32 v37, v38, v39
    s_add_u32 s12, s13, 7168
    buffer_load_dwordx4 v[220:223], v3, s[20:23], s12 offen sc1
    v_exp_f32 v41, v41
    v_exp_f32 v42, v42
    v_cvt_pk_bf16_f32 v38, v40, v41
    s_waitcnt lgkmcnt(2)
    v_mfma_f32_32x32x16_bf16 v[52:67], v[92:95], v[16:19], v[20:35]
    ds_read_b128 v[92:95], v8 offset:12288
    v_exp_f32 v43, v43
    v_exp_f32 v44, v44
    v_cvt_pk_bf16_f32 v39, v42, v43
    v_exp_f32 v45, v45
    v_exp_f32 v46, v46
    s_waitcnt lgkmcnt(2)
    v_mfma_f32_32x32x16_bf16 v[76:91], v[96:99], v[36:39], v[76:91]
    ds_read_b128 v[96:99], v9 offset:10240
    v_cvt_pk_bf16_f32 v40, v44, v45
    v_exp_f32 v47, v47
    v_exp_f32 v48, v48
    v_cvt_pk_bf16_f32 v41, v46, v47
    s_add_u32 s12, s13, 23552
    buffer_load_dwordx4 v[224:227], v3, s[20:23], s12 offen sc1
    v_exp_f32 v49, v49
    v_exp_f32 v50, v50
    v_cvt_pk_bf16_f32 v42, v48, v49
    v_exp_f32 v51, v51
    v_exp_f32 v52, v52
    v_cvt_pk_bf16_f32 v43, v50, v51
    v_exp_f32 v53, v53
    v_exp_f32 v54, v54
    v_cvt_pk_bf16_f32 v52, v52, v53
    s_waitcnt lgkmcnt(2)
    v_mfma_f32_32x32x16_bf16 v[76:91], v[100:103], v[40:43], v[76:91]
    ds_read_b128 v[100:103], v9 offset:10752
    v_exp_f32 v55, v55
    v_exp_f32 v56, v56
    v_cvt_pk_bf16_f32 v53, v54, v55
    s_waitcnt vmcnt(7)
    s_mov_b32 s39, 0x80000
M_EW:
    v_cmp_eq_u32 vcc, s59, v12
    s_nop 0
    s_cmp_eq_u64 vcc, -1
    s_cbranch_scc1 M_EG
    s_sleep 2
    buffer_load_dword v12, v13, s[20:23], s38 offen sc1
    s_waitcnt vmcnt(0)
    s_sub_u32 s39, s39, 1
    s_cmp_lg_u32 s39, 0
    s_cbranch_scc1 M_EW
M_EG:
    s_cmp_ge_u32 s3, 6
    s_mov_b32 s12, 155520
    s_cselect_b32 s12, 155648, s12
    s_add_u32 s12, s12, s63
    s_mov_b32 m0, s12
    s_lshl_b32 s12, s4, 13
    s_add_u32 s12, s12, s63
    s_add_u32 s12, s12, 1572864
    buffer_load_dwordx4 v3, s[20:23], s12 offen sc1 lds
    v_exp_f32 v57, v57
    v_exp_f32 v58, v58
    v_cvt_pk_bf16_f32 v54, v56, v57
    s_waitcnt lgkmcnt(2)
    v_mfma_f32_32x32x16_bf16 v[36:51], v[92:95], v[16:19], v[20:35]
    ds_read_b128 v[92:95], v8 offset:14336
    v_exp_f32 v59, v59
    v_exp_f32 v60, v60
    v_cvt_pk_bf16_f32 v55, v58, v59
    v_exp_f32 v61, v61
    v_exp_f32 v62, v62
    s_waitcnt lgkmcnt(2)
    v_mfma_f32_32x32x16_bf16 v[76:91], v[96:99], v[52:55], v[76:91]
    ds_read_b128 v[96:99], v9 offset:12288
    v_cvt_pk_bf16_f32 v56, v60, v61
    v_exp_f32 v63, v63
    v_exp_f32 v64, v64
    v_cvt_pk_bf16_f32 v57, v62, v63
    s_add_u32 s12, s13, 39936
    buffer_load_dwordx4 v[228:231], v3, s[20:23], s12 offen sc1
    v_exp_f32 v65, v65
    v_exp_f32 v66, v66
    v_cvt_pk_bf16_f32 v58, v64, v65
    v_exp_f32 v67, v67
    s_add_u32 s12, s13, 56320
    buffer_load_dwordx4 v[232:235], v3, s[20:23], s12 offen sc1
    s_add_u32 s12, s13, 8192
    buffer_load_dwordx4 v[236:239], v3, s[20:23], s12 offen sc1
    v_exp_f32 v36, v36
    v_cvt_pk_bf16_f32 v59, v66, v67
    v_exp_f32 v37, v37
    v_exp_f32 v38, v38
    v_cvt_pk_bf16_f32 v36, v36, v37
    s_waitcnt lgkmcnt(2)
    v_mfma_f32_32x32x16_bf16 v[76:91], v[100:103], v[56:59], v[76:91]
    ds_read_b128 v[100:103], v9 offset:12800
    v_exp_f32 v39, v39
    v_exp_f32 v40, v40
    v_cvt_pk_bf16_f32 v37, v38, v39
    s_add_u32 s12, s13, 24576
    buffer_load_dwordx4 v[240:243], v3, s[20:23], s12 offen sc1
    v_exp_f32 v41, v41
    v_exp_f32 v42, v42
    v_cvt_pk_bf16_f32 v38, v40, v41
    s_waitcnt lgkmcnt(2)
    v_mfma_f32_32x32x16_bf16 v[52:67], v[92:95], v[16:19], v[20:35]
    ds_read_b128 v[92:95], v8 offset:16384
    v_exp_f32 v43, v43
    v_exp_f32 v44, v44
    v_cvt_pk_bf16_f32 v39, v42, v43
    v_exp_f32 v45, v45
    v_exp_f32 v46, v46
    s_waitcnt lgkmcnt(2)
    v_mfma_f32_32x32x16_bf16 v[76:91], v[96:99], v[36:39], v[76:91]
    ds_read_b128 v[96:99], v9 offset:14336
    v_cvt_pk_bf16_f32 v40, v44, v45
    v_exp_f32 v47, v47
    v_exp_f32 v48, v48
    v_cvt_pk_bf16_f32 v41, v46, v47
    s_add_u32 s12, s13, 40960
    buffer_load_dwordx4 v[244:247], v3, s[20:23], s12 offen sc1
    v_exp_f32 v49, v49
    v_exp_f32 v50, v50
    v_cvt_pk_bf16_f32 v42, v48, v49
    v_exp_f32 v51, v51
    v_exp_f32 v52, v52
    v_cvt_pk_bf16_f32 v43, v50, v51
    v_exp_f32 v53, v53
    v_exp_f32 v54, v54
    v_cvt_pk_bf16_f32 v52, v52, v53
    s_waitcnt lgkmcnt(2)
    v_mfma_f32_32x32x16_bf16 v[76:91], v[100:103], v[40:43], v[76:91]
    ds_read_b128 v[100:103], v9 offset:14848
    v_exp_f32 v55, v55
    v_exp_f32 v56, v56
    v_cvt_pk_bf16_f32 v53, v54, v55
    s_add_u32 s12, s13, 57344
    buffer_load_dwordx4 v[248:251], v3, s[20:23], s12 offen sc1
    v_exp_f32 v57, v57
    v_exp_f32 v58, v58
    v_cvt_pk_bf16_f32 v54, v56, v57
    s_waitcnt lgkmcnt(2)
    v_mfma_f32_32x32x16_bf16 v[36:51], v[92:95], v[16:19], v[20:35]
    ds_read_b128 v[92:95], v8 offset:18432
    v_exp_f32 v59, v59
    v_exp_f32 v60, v60
    v_cvt_pk_bf16_f32 v55, v58, v59
    v_exp_f32 v61, v61
    v_exp_f32 v62, v62
    s_waitcnt lgkmcnt(2)
    v_mfma_f32_32x32x16_bf16 v[76:91], v[96:99], v[52:55], v[76:91]
    v_add_u32 v9, v9, v10
    ds_read_b128 v[96:99], v9
    v_add_u32 v8, 0x4000, v8
    v_cvt_pk_bf16_f32 v56, v60, v61
    v_exp_f32 v63, v63
    v_exp_f32 v64, v64
    v_cvt_pk_bf16_f32 v57, v62, v63
    s_cmp_lt_u32 s3, 4
    s_cbranch_scc1 M_Pb26
    s_setprio 0
M_Pb26:
    v_exp_f32 v65, v65
    v_exp_f32 v66, v66
    v_cvt_pk_bf16_f32 v58, v64, v65
    v_exp_f32 v67, v67
    s_add_u32 s12, s13, 9216
    buffer_load_dwordx4 v[252:255], v3, s[20:23], s12 offen sc1
    v_exp_f32 v36, v36
    v_cvt_pk_bf16_f32 v59, v66, v67
    v_exp_f32 v37, v37
    v_exp_f32 v38, v38
    v_cvt_pk_bf16_f32 v36, v36, v37
    s_waitcnt lgkmcnt(2)
    v_mfma_f32_32x32x16_bf16 v[76:91], v[100:103], v[56:59], v[76:91]
    ds_read_b128 v[100:103], v9 offset:512
    v_exp_f32 v39, v39
    v_exp_f32 v40, v40
    v_cvt_pk_bf16_f32 v37, v38, v39
    s_add_u32 s12, s13, 25600
    buffer_load_dwordx4 v[68:71], v3, s[20:23], s12 offen sc1
    v_exp_f32 v41, v41
    v_exp_f32 v42, v42
    v_cvt_pk_bf16_f32 v38, v40, v41
    s_waitcnt lgkmcnt(2)
    v_mfma_f32_32x32x16_bf16 v[52:67], v[92:95], v[16:19], v[20:35]
    ds_read_b128 v[92:95], v8 offset:4096
    v_exp_f32 v43, v43
    v_exp_f32 v44, v44
    v_cvt_pk_bf16_f32 v39, v42, v43
    v_exp_f32 v45, v45
    v_exp_f32 v46, v46
    s_waitcnt lgkmcnt(2)
    v_mfma_f32_32x32x16_bf16 v[76:91], v[96:99], v[36:39], v[76:91]
    ds_read_b128 v[96:99], v9 offset:2048
    v_cvt_pk_bf16_f32 v40, v44, v45
    v_exp_f32 v47, v47
    v_exp_f32 v48, v48
    v_cvt_pk_bf16_f32 v41, v46, v47
    s_add_u32 s12, s13, 41984
    buffer_load_dwordx4 v[72:75], v3, s[20:23], s12 offen sc1
    v_exp_f32 v49, v49
    v_exp_f32 v50, v50
    v_cvt_pk_bf16_f32 v42, v48, v49
    v_exp_f32 v51, v51
    v_lshrrev_b32 v7, 3, v2
    v_mul_u32_u24 v0, 3584, v7
    v_and_b32 v15, 7, v2
    v_and_b32 v7, 2, v7
    v_xor_b32 v15, v15, v7
    v_lshl_add_u32 v0, v15, 4, v0
    v_xor_b32 v7, 64, v0
    s_mov_b32 s44, s64
    s_mov_b32 s45, s65
    s_mov_b32 s47, 0x20000
    s_mov_b32 s48, s68
    s_mov_b32 s49, s69
    s_mov_b32 s51, 0x20000
    s_cmp_ge_u32 s5, 28
    s_cselect_b32 s46, 0, s66
    s_cselect_b32 s50, 0, s70
    v_exp_f32 v52, v52
    v_cvt_pk_bf16_f32 v43, v50, v51
    v_exp_f32 v53, v53
    v_exp_f32 v54, v54
    v_cvt_pk_bf16_f32 v52, v52, v53
    s_waitcnt lgkmcnt(2)
    v_mfma_f32_32x32x16_bf16 v[76:91], v[100:103], v[40:43], v[76:91]
    ds_read_b128 v[100:103], v9 offset:2560
    v_exp_f32 v55, v55
    v_exp_f32 v56, v56
    v_cvt_pk_bf16_f32 v53, v54, v55
    v_exp_f32 v57, v57
    v_exp_f32 v58, v58
    v_cvt_pk_bf16_f32 v54, v56, v57
    s_waitcnt lgkmcnt(2)
    v_mfma_f32_32x32x16_bf16 v[36:51], v[92:95], v[16:19], v[20:35]
    ds_read_b128 v[92:95], v8 offset:6144
    v_exp_f32 v59, v59
    v_exp_f32 v60, v60
    v_cvt_pk_bf16_f32 v55, v58, v59
    v_exp_f32 v61, v61
    v_exp_f32 v62, v62
    s_waitcnt lgkmcnt(2)
    v_mfma_f32_32x32x16_bf16 v[76:91], v[96:99], v[52:55], v[76:91]
    ds_read_b128 v[96:99], v9 offset:4096
    v_cvt_pk_bf16_f32 v56, v60, v61
    v_exp_f32 v63, v63
    v_exp_f32 v64, v64
    v_cvt_pk_bf16_f32 v57, v62, v63
    v_exp_f32 v65, v65
    v_exp_f32 v66, v66
    v_cvt_pk_bf16_f32 v58, v64, v65
    v_exp_f32 v67, v67
    s_waitcnt vmcnt(9)
    s_barrier
    v_exp_f32 v36, v36
    v_cvt_pk_bf16_f32 v59, v66, v67
    v_exp_f32 v37, v37
    v_exp_f32 v38, v38
    v_cvt_pk_bf16_f32 v36, v36, v37
    s_waitcnt lgkmcnt(2)
    v_mfma_f32_32x32x16_bf16 v[76:91], v[100:103], v[56:59], v[76:91]
    ds_read_b128 v[100:103], v9 offset:4608
    v_exp_f32 v39, v39
    v_exp_f32 v40, v40
    v_cvt_pk_bf16_f32 v37, v38, v39
    s_cmp_lt_u32 s3, 4
    s_cbranch_scc1 M_Pa34
    s_setprio 1
M_Pa34:
    v_exp_f32 v41, v41
    v_exp_f32 v42, v42
    v_cvt_pk_bf16_f32 v38, v40, v41
    s_waitcnt lgkmcnt(2)
    v_mfma_f32_32x32x16_bf16 v[52:67], v[92:95], v[16:19], v[20:35]
    ds_read_b128 v[92:95], v8 offset:8192
    v_exp_f32 v43, v43
    v_exp_f32 v44, v44
    v_cvt_pk_bf16_f32 v39, v42, v43
    v_exp_f32 v45, v45
    v_exp_f32 v46, v46
    s_waitcnt lgkmcnt(2)
    v_mfma_f32_32x32x16_bf16 v[76:91], v[96:99], v[36:39], v[76:91]
    ds_read_b128 v[96:99], v9 offset:6144
    v_cvt_pk_bf16_f32 v40, v44, v45
    v_exp_f32 v47, v47
    v_exp_f32 v48, v48
    v_cvt_pk_bf16_f32 v41, v46, v47
    s_add_u32 s36, s63, 0
    s_mov_b32 m0, s36
    s_add_u32 s37, s62, 0
    buffer_load_dwordx4 v0, s[44:47], s37 offen nt lds
    v_exp_f32 v49, v49
    v_exp_f32 v50, v50
    v_cvt_pk_bf16_f32 v42, v48, v49
    v_exp_f32 v51, v51
    v_exp_f32 v52, v52
    v_cvt_pk_bf16_f32 v43, v50, v51
    v_exp_f32 v53, v53
    v_exp_f32 v54, v54
    v_cvt_pk_bf16_f32 v52, v52, v53
    s_waitcnt lgkmcnt(2)
    v_mfma_f32_32x32x16_bf16 v[76:91], v[100:103], v[40:43], v[76:91]
    ds_read_b128 v[100:103], v9 offset:6656
    v_exp_f32 v55, v55
    v_exp_f32 v56, v56
    v_cvt_pk_bf16_f32 v53, v54, v55
    global_store_dwordx4 v14, v[16:19], s[56:57]
    v_exp_f32 v57, v57
    v_exp_f32 v58, v58
    v_cvt_pk_bf16_f32 v54, v56, v57
    s_waitcnt lgkmcnt(2)
    v_mfma_f32_32x32x16_bf16 v[36:51], v[92:95], v[16:19], v[20:35]
    ds_read_b128 v[92:95], v8 offset:10240
    v_exp_f32 v59, v59
    v_exp_f32 v60, v60
    v_cvt_pk_bf16_f32 v55, v58, v59
    v_exp_f32 v61, v61
    v_exp_f32 v62, v62
    s_waitcnt lgkmcnt(2)
    v_mfma_f32_32x32x16_bf16 v[76:91], v[96:99], v[52:55], v[76:91]
    ds_read_b128 v[96:99], v9 offset:8192
    v_cvt_pk_bf16_f32 v56, v60, v61
    v_exp_f32 v63, v63
    v_exp_f32 v64, v64
    v_cvt_pk_bf16_f32 v57, v62, v63
    v_exp_f32 v65, v65
    v_exp_f32 v66, v66
    v_cvt_pk_bf16_f32 v58, v64, v65
    v_exp_f32 v67, v67
    v_exp_f32 v36, v36
    v_cvt_pk_bf16_f32 v59, v66, v67
    v_exp_f32 v37, v37
    v_exp_f32 v38, v38
    v_cvt_pk_bf16_f32 v36, v36, v37
    s_waitcnt lgkmcnt(2)
    v_mfma_f32_32x32x16_bf16 v[76:91], v[100:103], v[56:59], v[76:91]
    ds_read_b128 v[100:103], v9 offset:8704
    v_exp_f32 v39, v39
    v_exp_f32 v40, v40
    v_cvt_pk_bf16_f32 v37, v38, v39
    s_add_u32 s36, s63, 8192
    s_mov_b32 m0, s36
    s_add_u32 s37, s62, 229376
    buffer_load_dwordx4 v0, s[44:47], s37 offen nt lds
    v_exp_f32 v41, v41
    v_exp_f32 v42, v42
    v_cvt_pk_bf16_f32 v38, v40, v41
    s_waitcnt lgkmcnt(2)
    v_mfma_f32_32x32x16_bf16 v[52:67], v[92:95], v[16:19], v[20:35]
    ds_read_b128 v[92:95], v8 offset:12288
    v_exp_f32 v43, v43
    v_exp_f32 v44, v44
    v_cvt_pk_bf16_f32 v39, v42, v43
    v_exp_f32 v45, v45
    v_exp_f32 v46, v46
    s_waitcnt lgkmcnt(2)
    v_mfma_f32_32x32x16_bf16 v[76:91], v[96:99], v[36:39], v[76:91]
    ds_read_b128 v[96:99], v9 offset:10240
    v_cvt_pk_bf16_f32 v40, v44, v45
    v_exp_f32 v47, v47
    v_exp_f32 v48, v48
    v_cvt_pk_bf16_f32 v41, v46, v47
    v_exp_f32 v49, v49
    v_exp_f32 v50, v50
    v_cvt_pk_bf16_f32 v42, v48, v49
    v_exp_f32 v51, v51
    v_exp_f32 v52, v52
    v_cvt_pk_bf16_f32 v43, v50, v51
    v_exp_f32 v53, v53
    v_exp_f32 v54, v54
    v_cvt_pk_bf16_f32 v52, v52, v53
    s_waitcnt lgkmcnt(2)
    v_mfma_f32_32x32x16_bf16 v[76:91], v[100:103], v[40:43], v[76:91]
    ds_read_b128 v[100:103], v9 offset:10752
    v_exp_f32 v55, v55
    v_exp_f32 v56, v56
    v_cvt_pk_bf16_f32 v53, v54, v55
    s_cmp_lg_u32 s3, 7
    s_cbranch_scc1 M_TD
    s_mul_i32 s55, s2, 7168
    buffer_load_dword v1, v11, s[72:75], s55 offen
M_TD:
    v_exp_f32 v57, v57
    v_exp_f32 v58, v58
    v_cvt_pk_bf16_f32 v54, v56, v57
    s_waitcnt lgkmcnt(2)
    v_mfma_f32_32x32x16_bf16 v[36:51], v[92:95], v[16:19], v[20:35]
    ds_read_b128 v[92:95], v8 offset:14336
    v_exp_f32 v59, v59
    v_exp_f32 v60, v60
    v_cvt_pk_bf16_f32 v55, v58, v59
    v_exp_f32 v61, v61
    v_exp_f32 v62, v62
    s_waitcnt lgkmcnt(2)
    v_mfma_f32_32x32x16_bf16 v[76:91], v[96:99], v[52:55], v[76:91]
    ds_read_b128 v[96:99], v9 offset:12288
    v_cvt_pk_bf16_f32 v56, v60, v61
    v_exp_f32 v63, v63
    v_exp_f32 v64, v64
    v_cvt_pk_bf16_f32 v57, v62, v63
    v_exp_f32 v65, v65
    v_exp_f32 v66, v66
    v_cvt_pk_bf16_f32 v58, v64, v65
    v_exp_f32 v67, v67
    v_exp_f32 v36, v36
    v_cvt_pk_bf16_f32 v59, v66, v67
    v_exp_f32 v37, v37
    v_exp_f32 v38, v38
    v_cvt_pk_bf16_f32 v36, v36, v37
    s_waitcnt lgkmcnt(2)
    v_mfma_f32_32x32x16_bf16 v[76:91], v[100:103], v[56:59], v[76:91]
    ds_read_b128 v[100:103], v9 offset:12800
    v_exp_f32 v39, v39
    v_exp_f32 v40, v40
    v_cvt_pk_bf16_f32 v37, v38, v39
    s_add_u32 s36, s63, 16384
    s_mov_b32 m0, s36
    s_add_u32 s37, s62, 458752
    buffer_load_dwordx4 v0, s[44:47], s37 offen nt lds
    v_exp_f32 v41, v41
    v_exp_f32 v42, v42
    v_cvt_pk_bf16_f32 v38, v40, v41
    s_waitcnt lgkmcnt(2)
    v_mfma_f32_32x32x16_bf16 v[52:67], v[92:95], v[16:19], v[20:35]
    ds_read_b128 v[92:95], v8 offset:16384
    v_exp_f32 v43, v43
    v_exp_f32 v44, v44
    v_cvt_pk_bf16_f32 v39, v42, v43
    v_exp_f32 v45, v45
    v_exp_f32 v46, v46
    s_waitcnt lgkmcnt(2)
    v_mfma_f32_32x32x16_bf16 v[76:91], v[96:99], v[36:39], v[76:91]
    ds_read_b128 v[96:99], v9 offset:14336
    v_cvt_pk_bf16_f32 v40, v44, v45
    v_exp_f32 v47, v47
    v_exp_f32 v48, v48
    v_cvt_pk_bf16_f32 v41, v46, v47
    v_exp_f32 v49, v49
    v_exp_f32 v50, v50
    v_cvt_pk_bf16_f32 v42, v48, v49
    v_exp_f32 v51, v51
    v_exp_f32 v52, v52
    v_cvt_pk_bf16_f32 v43, v50, v51
    v_exp_f32 v53, v53
    v_exp_f32 v54, v54
    v_cvt_pk_bf16_f32 v52, v52, v53
    s_waitcnt lgkmcnt(2)
    v_mfma_f32_32x32x16_bf16 v[76:91], v[100:103], v[40:43], v[76:91]
    ds_read_b128 v[100:103], v9 offset:14848
    v_exp_f32 v55, v55
    v_exp_f32 v56, v56
    v_cvt_pk_bf16_f32 v53, v54, v55
    v_exp_f32 v57, v57
    v_exp_f32 v58, v58
    v_cvt_pk_bf16_f32 v54, v56, v57
    s_waitcnt lgkmcnt(2)
    v_mfma_f32_32x32x16_bf16 v[36:51], v[92:95], v[16:19], v[20:35]
    ds_read_b128 v[92:95], v8 offset:18432
    v_exp_f32 v59, v59
    v_exp_f32 v60, v60
    v_cvt_pk_bf16_f32 v55, v58, v59
    v_exp_f32 v61, v61
    v_exp_f32 v62, v62
    s_waitcnt lgkmcnt(2)
    v_mfma_f32_32x32x16_bf16 v[76:91], v[96:99], v[52:55], v[76:91]
    v_add_u32 v9, v9, v10
    ds_read_b128 v[96:99], v9
    v_add_u32 v8, 0x4000, v8
    v_cvt_pk_bf16_f32 v56, v60, v61
    v_exp_f32 v63, v63
    v_exp_f32 v64, v64
    v_cvt_pk_bf16_f32 v57, v62, v63
    s_cmp_lt_u32 s3, 4
    s_cbranch_scc1 M_Pb34
    s_setprio 0
M_Pb34:
    v_exp_f32 v65, v65
    v_exp_f32 v66, v66
    v_cvt_pk_bf16_f32 v58, v64, v65
    v_exp_f32 v67, v67
    v_exp_f32 v36, v36
    v_cvt_pk_bf16_f32 v59, v66, v67
    v_exp_f32 v37, v37
    v_exp_f32 v38, v38
    v_cvt_pk_bf16_f32 v36, v36, v37
    s_waitcnt lgkmcnt(2)
    v_mfma_f32_32x32x16_bf16 v[76:91], v[100:103], v[56:59], v[76:91]
    ds_read_b128 v[100:103], v9 offset:512
    v_exp_f32 v39, v39
    v_exp_f32 v40, v40
    v_cvt_pk_bf16_f32 v37, v38, v39
    s_add_u32 s36, s63, 24576
    s_mov_b32 m0, s36
    s_add_u32 s37, s62, 688128
    buffer_load_dwordx4 v0, s[44:47], s37 offen nt lds
    v_exp_f32 v41, v41
    v_exp_f32 v42, v42
    v_cvt_pk_bf16_f32 v38, v40, v41
    s_waitcnt lgkmcnt(2)
    v_mfma_f32_32x32x16_bf16 v[52:67], v[92:95], v[16:19], v[20:35]
    ds_read_b128 v[92:95], v8 offset:4096
    v_exp_f32 v43, v43
    v_exp_f32 v44, v44
    v_cvt_pk_bf16_f32 v39, v42, v43
    v_exp_f32 v45, v45
    v_exp_f32 v46, v46
    s_waitcnt lgkmcnt(2)
    v_mfma_f32_32x32x16_bf16 v[76:91], v[96:99], v[36:39], v[76:91]
    ds_read_b128 v[96:99], v9 offset:2048
    v_cvt_pk_bf16_f32 v40, v44, v45
    v_exp_f32 v47, v47
    v_exp_f32 v48, v48
    v_cvt_pk_bf16_f32 v41, v46, v47
    v_exp_f32 v49, v49
    v_exp_f32 v50, v50
    v_cvt_pk_bf16_f32 v42, v48, v49
    v_exp_f32 v51, v51
    v_exp_f32 v52, v52
    v_cvt_pk_bf16_f32 v43, v50, v51
    v_exp_f32 v53, v53
    v_exp_f32 v54, v54
    v_cvt_pk_bf16_f32 v52, v52, v53
    s_waitcnt lgkmcnt(2)
    v_mfma_f32_32x32x16_bf16 v[76:91], v[100:103], v[40:43], v[76:91]
    ds_read_b128 v[100:103], v9 offset:2560
    v_exp_f32 v55, v55
    v_exp_f32 v56, v56
    v_cvt_pk_bf16_f32 v53, v54, v55
    v_exp_f32 v57, v57
    v_exp_f32 v58, v58
    v_cvt_pk_bf16_f32 v54, v56, v57
    s_waitcnt lgkmcnt(2)
    v_mfma_f32_32x32x16_bf16 v[36:51], v[92:95], v[16:19], v[20:35]
    ds_read_b128 v[92:95], v8 offset:6144
    v_exp_f32 v59, v59
    v_exp_f32 v60, v60
    v_cvt_pk_bf16_f32 v55, v58, v59
    v_exp_f32 v61, v61
    v_exp_f32 v62, v62
    s_waitcnt lgkmcnt(2)
    v_mfma_f32_32x32x16_bf16 v[76:91], v[96:99], v[52:55], v[76:91]
    ds_read_b128 v[96:99], v9 offset:4096
    v_cvt_pk_bf16_f32 v56, v60, v61
    v_exp_f32 v63, v63
    v_exp_f32 v64, v64
    v_cvt_pk_bf16_f32 v57, v62, v63
    v_exp_f32 v65, v65
    v_exp_f32 v66, v66
    v_cvt_pk_bf16_f32 v58, v64, v65
    v_exp_f32 v67, v67
    v_exp_f32 v36, v36
    v_cvt_pk_bf16_f32 v59, v66, v67
    v_exp_f32 v37, v37
    v_exp_f32 v38, v38
    v_cvt_pk_bf16_f32 v36, v36, v37
    s_waitcnt lgkmcnt(2)
    v_mfma_f32_32x32x16_bf16 v[76:91], v[100:103], v[56:59], v[76:91]
    ds_read_b128 v[100:103], v9 offset:4608
    v_exp_f32 v39, v39
    v_exp_f32 v40, v40
    v_cvt_pk_bf16_f32 v37, v38, v39
    s_cmp_lt_u32 s3, 4
    s_cbranch_scc1 M_Pa42
    s_setprio 1
M_Pa42:
    v_exp_f32 v41, v41
    v_exp_f32 v42, v42
    v_cvt_pk_bf16_f32 v38, v40, v41
    s_waitcnt lgkmcnt(2)
    v_mfma_f32_32x32x16_bf16 v[52:67], v[92:95], v[16:19], v[20:35]
    ds_read_b128 v[92:95], v8 offset:8192
    v_exp_f32 v43, v43
    v_exp_f32 v44, v44
    v_cvt_pk_bf16_f32 v39, v42, v43
    v_exp_f32 v45, v45
    v_exp_f32 v46, v46
    s_waitcnt lgkmcnt(2)
    v_mfma_f32_32x32x16_bf16 v[76:91], v[96:99], v[36:39], v[76:91]
    ds_read_b128 v[96:99], v9 offset:6144
    v_cvt_pk_bf16_f32 v40, v44, v45
    v_exp_f32 v47, v47
    v_exp_f32 v48, v48
    v_cvt_pk_bf16_f32 v41, v46, v47
    s_add_u32 s36, s63, 32768
    s_mov_b32 m0, s36
    s_add_u32 s37, s62, 917504
    buffer_load_dwordx4 v0, s[44:47], s37 offen nt lds
    v_exp_f32 v49, v49
    v_exp_f32 v50, v50
    v_cvt_pk_bf16_f32 v42, v48, v49
    v_exp_f32 v51, v51
    v_exp_f32 v52, v52
    v_cvt_pk_bf16_f32 v43, v50, v51
    v_exp_f32 v53, v53
    v_exp_f32 v54, v54
    v_cvt_pk_bf16_f32 v52, v52, v53
    s_waitcnt lgkmcnt(2)
    v_mfma_f32_32x32x16_bf16 v[76:91], v[100:103], v[40:43], v[76:91]
    ds_read_b128 v[100:103], v9 offset:6656
    v_exp_f32 v55, v55
    v_exp_f32 v56, v56
    v_cvt_pk_bf16_f32 v53, v54, v55
    v_exp_f32 v57, v57
    v_exp_f32 v58, v58
    v_cvt_pk_bf16_f32 v54, v56, v57
    s_waitcnt lgkmcnt(2)
    v_mfma_f32_32x32x16_bf16 v[36:51], v[92:95], v[16:19], v[20:35]
    ds_read_b128 v[92:95], v8 offset:10240
    v_exp_f32 v59, v59
    v_exp_f32 v60, v60
    v_cvt_pk_bf16_f32 v55, v58, v59
    v_exp_f32 v61, v61
    v_exp_f32 v62, v62
    s_waitcnt lgkmcnt(2)
    v_mfma_f32_32x32x16_bf16 v[76:91], v[96:99], v[52:55], v[76:91]
    ds_read_b128 v[96:99], v9 offset:8192
    v_cvt_pk_bf16_f32 v56, v60, v61
    v_exp_f32 v63, v63
    v_exp_f32 v64, v64
    v_cvt_pk_bf16_f32 v57, v62, v63
    v_exp_f32 v65, v65
    v_exp_f32 v66, v66
    v_cvt_pk_bf16_f32 v58, v64, v65
    v_exp_f32 v67, v67
    v_exp_f32 v36, v36
    v_cvt_pk_bf16_f32 v59, v66, v67
    v_exp_f32 v37, v37
    v_exp_f32 v38, v38
    v_cvt_pk_bf16_f32 v36, v36, v37
    s_waitcnt lgkmcnt(2)
    v_mfma_f32_32x32x16_bf16 v[76:91], v[100:103], v[56:59], v[76:91]
    ds_read_b128 v[100:103], v9 offset:8704
    v_exp_f32 v39, v39
    v_exp_f32 v40, v40
    v_cvt_pk_bf16_f32 v37, v38, v39
    s_add_u32 s36, s63, 40960
    s_mov_b32 m0, s36
    s_add_u32 s37, s62, 1146880
    buffer_load_dwordx4 v0, s[44:47], s37 offen nt lds
    v_exp_f32 v41, v41
    v_exp_f32 v42, v42
    v_cvt_pk_bf16_f32 v38, v40, v41
    s_waitcnt lgkmcnt(2)
    v_mfma_f32_32x32x16_bf16 v[52:67], v[92:95], v[16:19], v[20:35]
    ds_read_b128 v[92:95], v8 offset:12288
    v_exp_f32 v43, v43
    v_exp_f32 v44, v44
    v_cvt_pk_bf16_f32 v39, v42, v43
    v_exp_f32 v45, v45
    v_exp_f32 v46, v46
    s_waitcnt lgkmcnt(2)
    v_mfma_f32_32x32x16_bf16 v[76:91], v[96:99], v[36:39], v[76:91]
    ds_read_b128 v[96:99], v9 offset:10240
    v_cvt_pk_bf16_f32 v40, v44, v45
    v_exp_f32 v47, v47
    v_exp_f32 v48, v48
    v_cvt_pk_bf16_f32 v41, v46, v47
    v_exp_f32 v49, v49
    v_exp_f32 v50, v50
    v_cvt_pk_bf16_f32 v42, v48, v49
    v_exp_f32 v51, v51
    v_exp_f32 v52, v52
    v_cvt_pk_bf16_f32 v43, v50, v51
    v_exp_f32 v53, v53
    v_exp_f32 v54, v54
    v_cvt_pk_bf16_f32 v52, v52, v53
    s_waitcnt lgkmcnt(2)
    v_mfma_f32_32x32x16_bf16 v[76:91], v[100:103], v[40:43], v[76:91]
    ds_read_b128 v[100:103], v9 offset:10752
    v_exp_f32 v55, v55
    v_exp_f32 v56, v56
    v_cvt_pk_bf16_f32 v53, v54, v55
    v_exp_f32 v57, v57
    v_exp_f32 v58, v58
    v_cvt_pk_bf16_f32 v54, v56, v57
    s_waitcnt lgkmcnt(2)
    v_mfma_f32_32x32x16_bf16 v[36:51], v[92:95], v[16:19], v[20:35]
    ds_read_b128 v[92:95], v8 offset:14336
    v_exp_f32 v59, v59
    v_exp_f32 v60, v60
    v_cvt_pk_bf16_f32 v55, v58, v59
    v_exp_f32 v61, v61
    v_exp_f32 v62, v62
    s_waitcnt lgkmcnt(2)
    v_mfma_f32_32x32x16_bf16 v[76:91], v[96:99], v[52:55], v[76:91]
    ds_read_b128 v[96:99], v9 offset:12288
    v_cvt_pk_bf16_f32 v56, v60, v61
    v_exp_f32 v63, v63
    v_exp_f32 v64, v64
    v_cvt_pk_bf16_f32 v57, v62, v63
    v_exp_f32 v65, v65
    v_exp_f32 v66, v66
    v_cvt_pk_bf16_f32 v58, v64, v65
    v_exp_f32 v67, v67
    v_exp_f32 v36, v36
    v_cvt_pk_bf16_f32 v59, v66, v67
    v_exp_f32 v37, v37
    v_exp_f32 v38, v38
    v_cvt_pk_bf16_f32 v36, v36, v37
    s_waitcnt lgkmcnt(2)
    v_mfma_f32_32x32x16_bf16 v[76:91], v[100:103], v[56:59], v[76:91]
    ds_read_b128 v[100:103], v9 offset:12800
    v_exp_f32 v39, v39
    v_exp_f32 v40, v40
    v_cvt_pk_bf16_f32 v37, v38, v39
    s_add_u32 s36, s63, 49152
    s_mov_b32 m0, s36
    s_add_u32 s37, s62, 1376256
    buffer_load_dwordx4 v0, s[44:47], s37 offen nt lds
    v_exp_f32 v41, v41
    v_exp_f32 v42, v42
    v_cvt_pk_bf16_f32 v38, v40, v41
    s_waitcnt lgkmcnt(2)
    v_mfma_f32_32x32x16_bf16 v[52:67], v[92:95], v[16:19], v[20:35]
    ds_read_b128 v[92:95], v8 offset:16384
    v_exp_f32 v43, v43
    v_exp_f32 v44, v44
    v_cvt_pk_bf16_f32 v39, v42, v43
    v_exp_f32 v45, v45
    v_exp_f32 v46, v46
    s_waitcnt lgkmcnt(2)
    v_mfma_f32_32x32x16_bf16 v[76:91], v[96:99], v[36:39], v[76:91]
    ds_read_b128 v[96:99], v9 offset:14336
    v_cvt_pk_bf16_f32 v40, v44, v45
    v_exp_f32 v47, v47
    v_exp_f32 v48, v48
    v_cvt_pk_bf16_f32 v41, v46, v47
    v_exp_f32 v49, v49
    v_exp_f32 v50, v50
    v_cvt_pk_bf16_f32 v42, v48, v49
    v_exp_f32 v51, v51
    v_exp_f32 v52, v52
    v_cvt_pk_bf16_f32 v43, v50, v51
    v_exp_f32 v53, v53
    v_exp_f32 v54, v54
    v_cvt_pk_bf16_f32 v52, v52, v53
    s_waitcnt lgkmcnt(2)
    v_mfma_f32_32x32x16_bf16 v[76:91], v[100:103], v[40:43], v[76:91]
    ds_read_b128 v[100:103], v9 offset:14848
    v_exp_f32 v55, v55
    v_exp_f32 v56, v56
    v_cvt_pk_bf16_f32 v53, v54, v55
    v_exp_f32 v57, v57
    v_exp_f32 v58, v58
    v_cvt_pk_bf16_f32 v54, v56, v57
    s_waitcnt lgkmcnt(2)
    v_mfma_f32_32x32x16_bf16 v[36:51], v[92:95], v[16:19], v[20:35]
    ds_read_b128 v[92:95], v8 offset:18432
    v_exp_f32 v59, v59
    v_exp_f32 v60, v60
    v_cvt_pk_bf16_f32 v55, v58, v59
    v_exp_f32 v61, v61
    v_exp_f32 v62, v62
    s_waitcnt lgkmcnt(2)
    v_mfma_f32_32x32x16_bf16 v[76:91], v[96:99], v[52:55], v[76:91]
    v_add_u32 v9, v9, v10
    ds_read_b128 v[96:99], v9
    v_add_u32 v8, 0x4000, v8
    v_cvt_pk_bf16_f32 v56, v60, v61
    v_exp_f32 v63, v63
    v_exp_f32 v64, v64
    v_cvt_pk_bf16_f32 v57, v62, v63
    s_cmp_lt_u32 s3, 4
    s_cbranch_scc1 M_Pb42
    s_setprio 0
M_Pb42:
    v_exp_f32 v65, v65
    v_exp_f32 v66, v66
    v_cvt_pk_bf16_f32 v58, v64, v65
    v_exp_f32 v67, v67
    v_exp_f32 v36, v36
    v_cvt_pk_bf16_f32 v59, v66, v67
    v_exp_f32 v37, v37
    v_exp_f32 v38, v38
    v_cvt_pk_bf16_f32 v36, v36, v37
    s_waitcnt lgkmcnt(2)
    v_mfma_f32_32x32x16_bf16 v[76:91], v[100:103], v[56:59], v[76:91]
    ds_read_b128 v[100:103], v9 offset:512
    v_exp_f32 v39, v39
    v_exp_f32 v40, v40
    v_cvt_pk_bf16_f32 v37, v38, v39
    s_add_u32 s36, s63, 57344
    s_mov_b32 m0, s36
    s_add_u32 s37, s62, 1605632
    buffer_load_dwordx4 v0, s[44:47], s37 offen nt lds
    v_exp_f32 v41, v41
    v_exp_f32 v42, v42
    v_cvt_pk_bf16_f32 v38, v40, v41
    s_waitcnt lgkmcnt(2)
    v_mfma_f32_32x32x16_bf16 v[52:67], v[92:95], v[16:19], v[20:35]
    ds_read_b128 v[92:95], v8 offset:4096
    v_exp_f32 v43, v43
    v_exp_f32 v44, v44
    v_cvt_pk_bf16_f32 v39, v42, v43
    v_exp_f32 v45, v45
    v_exp_f32 v46, v46
    s_waitcnt lgkmcnt(2)
    v_mfma_f32_32x32x16_bf16 v[76:91], v[96:99], v[36:39], v[76:91]
    ds_read_b128 v[96:99], v9 offset:2048
    v_cvt_pk_bf16_f32 v40, v44, v45
    v_exp_f32 v47, v47
    v_exp_f32 v48, v48
    v_cvt_pk_bf16_f32 v41, v46, v47
    v_exp_f32 v49, v49
    v_exp_f32 v50, v50
    v_cvt_pk_bf16_f32 v42, v48, v49
    v_exp_f32 v51, v51
    v_exp_f32 v52, v52
    v_cvt_pk_bf16_f32 v43, v50, v51
    v_exp_f32 v53, v53
    v_exp_f32 v54, v54
    v_cvt_pk_bf16_f32 v52, v52, v53
    s_waitcnt lgkmcnt(2)
    v_mfma_f32_32x32x16_bf16 v[76:91], v[100:103], v[40:43], v[76:91]
    ds_read_b128 v[100:103], v9 offset:2560
    v_exp_f32 v55, v55
    v_exp_f32 v56, v56
    v_cvt_pk_bf16_f32 v53, v54, v55
    v_exp_f32 v57, v57
    v_exp_f32 v58, v58
    v_cvt_pk_bf16_f32 v54, v56, v57
    s_waitcnt lgkmcnt(2)
    v_mfma_f32_32x32x16_bf16 v[36:51], v[92:95], v[16:19], v[20:35]
    ds_read_b128 v[92:95], v8 offset:6144
    v_exp_f32 v59, v59
    v_exp_f32 v60, v60
    v_cvt_pk_bf16_f32 v55, v58, v59
    v_exp_f32 v61, v61
    v_exp_f32 v62, v62
    s_waitcnt lgkmcnt(2)
    v_mfma_f32_32x32x16_bf16 v[76:91], v[96:99], v[52:55], v[76:91]
    ds_read_b128 v[96:99], v9 offset:4096
    v_cvt_pk_bf16_f32 v56, v60, v61
    v_exp_f32 v63, v63
    v_exp_f32 v64, v64
    v_cvt_pk_bf16_f32 v57, v62, v63
    v_exp_f32 v65, v65
    v_exp_f32 v66, v66
    v_cvt_pk_bf16_f32 v58, v64, v65
    v_exp_f32 v67, v67
    s_barrier
    v_exp_f32 v36, v36
    v_cvt_pk_bf16_f32 v59, v66, v67
    v_exp_f32 v37, v37
    v_exp_f32 v38, v38
    v_cvt_pk_bf16_f32 v36, v36, v37
    s_waitcnt lgkmcnt(2)
    v_mfma_f32_32x32x16_bf16 v[76:91], v[100:103], v[56:59], v[76:91]
    ds_read_b128 v[100:103], v9 offset:4608
    v_exp_f32 v39, v39
    v_exp_f32 v40, v40
    v_cvt_pk_bf16_f32 v37, v38, v39
    s_cmp_lt_u32 s3, 4
    s_cbranch_scc1 M_Pa50
    s_setprio 1
M_Pa50:
    v_exp_f32 v41, v41
    v_exp_f32 v42, v42
    v_cvt_pk_bf16_f32 v38, v40, v41
    s_waitcnt lgkmcnt(2)
    v_mfma_f32_32x32x16_bf16 v[52:67], v[92:95], v[16:19], v[20:35]
    ds_read_b128 v[92:95], v8 offset:8192
    v_exp_f32 v43, v43
    v_exp_f32 v44, v44
    v_cvt_pk_bf16_f32 v39, v42, v43
    v_exp_f32 v45, v45
    v_exp_f32 v46, v46
    s_waitcnt lgkmcnt(2)
    v_mfma_f32_32x32x16_bf16 v[76:91], v[96:99], v[36:39], v[76:91]
    ds_read_b128 v[96:99], v9 offset:6144
    v_cvt_pk_bf16_f32 v40, v44, v45
    v_exp_f32 v47, v47
    v_exp_f32 v48, v48
    v_cvt_pk_bf16_f32 v41, v46, v47
    s_add_u32 s36, s63, 65536
    s_mov_b32 m0, s36
    s_add_u32 s37, s62, 0
    buffer_load_dwordx4 v7, s[48:51], s37 offen nt lds
    v_exp_f32 v49, v49
    v_exp_f32 v50, v50
    v_cvt_pk_bf16_f32 v42, v48, v49
    v_exp_f32 v51, v51
    v_exp_f32 v52, v52
    v_cvt_pk_bf16_f32 v43, v50, v51
    v_exp_f32 v53, v53
    v_exp_f32 v54, v54
    v_cvt_pk_bf16_f32 v52, v52, v53
    s_waitcnt lgkmcnt(2)
    v_mfma_f32_32x32x16_bf16 v[76:91], v[100:103], v[40:43], v[76:91]
    ds_read_b128 v[100:103], v9 offset:6656
    v_exp_f32 v55, v55
    v_exp_f32 v56, v56
    v_cvt_pk_bf16_f32 v53, v54, v55
    v_exp_f32 v57, v57
    v_exp_f32 v58, v58
    v_cvt_pk_bf16_f32 v54, v56, v57
    s_waitcnt lgkmcnt(2)
    v_mfma_f32_32x32x16_bf16 v[36:51], v[92:95], v[16:19], v[20:35]
    ds_read_b128 v[92:95], v8 offset:10240
    v_exp_f32 v59, v59
    v_exp_f32 v60, v60
    v_cvt_pk_bf16_f32 v55, v58, v59
    v_exp_f32 v61, v61
    v_exp_f32 v62, v62
    s_waitcnt lgkmcnt(2)
    v_mfma_f32_32x32x16_bf16 v[76:91], v[96:99], v[52:55], v[76:91]
    ds_read_b128 v[96:99], v9 offset:8192
    v_cvt_pk_bf16_f32 v56, v60, v61
    v_exp_f32 v63, v63
    v_exp_f32 v64, v64
    v_cvt_pk_bf16_f32 v57, v62, v63
    v_exp_f32 v65, v65
    v_exp_f32 v66, v66
    v_cvt_pk_bf16_f32 v58, v64, v65
    v_exp_f32 v67, v67
    v_exp_f32 v36, v36
    v_cvt_pk_bf16_f32 v59, v66, v67
    v_exp_f32 v37, v37
    v_exp_f32 v38, v38
    v_cvt_pk_bf16_f32 v36, v36, v37
    s_waitcnt lgkmcnt(2)
    v_mfma_f32_32x32x16_bf16 v[76:91], v[100:103], v[56:59], v[76:91]
    ds_read_b128 v[100:103], v9 offset:8704
    v_exp_f32 v39, v39
    v_exp_f32 v40, v40
    v_cvt_pk_bf16_f32 v37, v38, v39
    s_add_u32 s36, s63, 73728
    s_mov_b32 m0, s36
    s_add_u32 s37, s62, 229376
    buffer_load_dwordx4 v7, s[48:51], s37 offen nt lds
    v_exp_f32 v41, v41
    v_exp_f32 v42, v42
    v_cvt_pk_bf16_f32 v38, v40, v41
    s_waitcnt lgkmcnt(2)
    v_mfma_f32_32x32x16_bf16 v[52:67], v[92:95], v[16:19], v[20:35]
    ds_read_b128 v[92:95], v8 offset:12288
    v_exp_f32 v43, v43
    v_exp_f32 v44, v44
    v_cvt_pk_bf16_f32 v39, v42, v43
    v_exp_f32 v45, v45
    v_exp_f32 v46, v46
    s_waitcnt lgkmcnt(2)
    v_mfma_f32_32x32x16_bf16 v[76:91], v[96:99], v[36:39], v[76:91]
    ds_read_b128 v[96:99], v9 offset:10240
    v_cvt_pk_bf16_f32 v40, v44, v45
    v_exp_f32 v47, v47
    v_exp_f32 v48, v48
    v_cvt_pk_bf16_f32 v41, v46, v47
    v_exp_f32 v49, v49
    v_exp_f32 v50, v50
    v_cvt_pk_bf16_f32 v42, v48, v49
    v_exp_f32 v51, v51
    v_exp_f32 v52, v52
    v_cvt_pk_bf16_f32 v43, v50, v51
    v_exp_f32 v53, v53
    v_exp_f32 v54, v54
    v_cvt_pk_bf16_f32 v52, v52, v53
    s_waitcnt lgkmcnt(2)
    v_mfma_f32_32x32x16_bf16 v[76:91], v[100:103], v[40:43], v[76:91]
    ds_read_b128 v[100:103], v9 offset:10752
    v_exp_f32 v55, v55
    v_exp_f32 v56, v56
    v_cvt_pk_bf16_f32 v53, v54, v55
    v_exp_f32 v57, v57
    v_exp_f32 v58, v58
    v_cvt_pk_bf16_f32 v54, v56, v57
    s_waitcnt lgkmcnt(2)
    v_mfma_f32_32x32x16_bf16 v[36:51], v[92:95], v[16:19], v[20:35]
    ds_read_b128 v[92:95], v8 offset:14336
    v_exp_f32 v59, v59
    v_exp_f32 v60, v60
    v_cvt_pk_bf16_f32 v55, v58, v59
    v_exp_f32 v61, v61
    v_exp_f32 v62, v62
    s_waitcnt lgkmcnt(2)
    v_mfma_f32_32x32x16_bf16 v[76:91], v[96:99], v[52:55], v[76:91]
    ds_read_b128 v[96:99], v9 offset:12288
    v_cvt_pk_bf16_f32 v56, v60, v61
    v_exp_f32 v63, v63
    v_exp_f32 v64, v64
    v_cvt_pk_bf16_f32 v57, v62, v63
    s_cmp_lt_u32 s3, 4
    s_cbranch_scc1 M_Pb50
    s_setprio 0
M_Pb50:
    v_exp_f32 v65, v65
    v_exp_f32 v66, v66
    v_cvt_pk_bf16_f32 v58, v64, v65
    v_exp_f32 v67, v67
    v_exp_f32 v36, v36
    v_cvt_pk_bf16_f32 v59, v66, v67
    v_exp_f32 v37, v37
    v_exp_f32 v38, v38
    v_cvt_pk_bf16_f32 v36, v36, v37
    s_waitcnt lgkmcnt(2)
    v_mfma_f32_32x32x16_bf16 v[76:91], v[100:103], v[56:59], v[76:91]
    ds_read_b128 v[100:103], v9 offset:12800
    v_exp_f32 v39, v39
    v_exp_f32 v40, v40
    v_cvt_pk_bf16_f32 v37, v38, v39
    s_add_u32 s36, s63, 81920
    s_mov_b32 m0, s36
    s_add_u32 s37, s62, 458752
    buffer_load_dwordx4 v7, s[48:51], s37 offen nt lds
    v_exp_f32 v41, v41
    v_exp_f32 v42, v42
    v_cvt_pk_bf16_f32 v38, v40, v41
    s_waitcnt lgkmcnt(2)
    v_mfma_f32_32x32x16_bf16 v[52:67], v[92:95], v[16:19], v[20:35]
    ds_read_b128 v[92:95], v8 offset:16384
    v_exp_f32 v43, v43
    v_exp_f32 v44, v44
    v_cvt_pk_bf16_f32 v39, v42, v43
    v_exp_f32 v45, v45
    v_exp_f32 v46, v46
    s_waitcnt lgkmcnt(2)
    v_mfma_f32_32x32x16_bf16 v[76:91], v[96:99], v[36:39], v[76:91]
    ds_read_b128 v[96:99], v9 offset:14336
    v_cvt_pk_bf16_f32 v40, v44, v45
    v_exp_f32 v47, v47
    v_exp_f32 v48, v48
    v_cvt_pk_bf16_f32 v41, v46, v47
    v_exp_f32 v49, v49
    v_exp_f32 v50, v50
    v_cvt_pk_bf16_f32 v42, v48, v49
    v_exp_f32 v51, v51
    v_exp_f32 v52, v52
    v_cvt_pk_bf16_f32 v43, v50, v51
    v_exp_f32 v53, v53
    v_exp_f32 v54, v54
    v_cvt_pk_bf16_f32 v52, v52, v53
    s_waitcnt lgkmcnt(2)
    v_mfma_f32_32x32x16_bf16 v[76:91], v[100:103], v[40:43], v[76:91]
    ds_read_b128 v[100:103], v9 offset:14848
    v_exp_f32 v55, v55
    v_exp_f32 v56, v56
    v_cvt_pk_bf16_f32 v53, v54, v55
    s_cmp_lt_u32 s3, 4
    s_cbranch_scc1 M_Pa55
    s_setprio 1
M_Pa55:
    v_exp_f32 v57, v57
    v_exp_f32 v58, v58
    v_cvt_pk_bf16_f32 v54, v56, v57
    s_waitcnt lgkmcnt(2)
    v_mfma_f32_32x32x16_bf16 v[36:51], v[92:95], v[16:19], v[20:35]
    ds_read_b128 v[92:95], v8 offset:18432
    v_exp_f32 v59, v59
    v_exp_f32 v60, v60
    v_cvt_pk_bf16_f32 v55, v58, v59
    v_exp_f32 v61, v61
    v_exp_f32 v62, v62
    s_waitcnt lgkmcnt(2)
    v_mfma_f32_32x32x16_bf16 v[76:91], v[96:99], v[52:55], v[76:91]
    v_add_u32 v9, v9, v10
    ds_read_b128 v[96:99], v9
    v_add_u32 v8, 0x4000, v8
    v_cvt_pk_bf16_f32 v56, v60, v61
    v_exp_f32 v63, v63
    v_exp_f32 v64, v64
    v_cvt_pk_bf16_f32 v57, v62, v63
    v_exp_f32 v65, v65
    v_exp_f32 v66, v66
    v_cvt_pk_bf16_f32 v58, v64, v65
    v_exp_f32 v67, v67
    v_exp_f32 v36, v36
    v_cvt_pk_bf16_f32 v59, v66, v67
    v_exp_f32 v37, v37
    v_exp_f32 v38, v38
    v_cvt_pk_bf16_f32 v36, v36, v37
    s_waitcnt lgkmcnt(2)
    v_mfma_f32_32x32x16_bf16 v[76:91], v[100:103], v[56:59], v[76:91]
    ds_read_b128 v[100:103], v9 offset:512
    v_exp_f32 v39, v39
    v_exp_f32 v40, v40
    v_cvt_pk_bf16_f32 v37, v38, v39
    s_add_u32 s36, s63, 90112
    s_mov_b32 m0, s36
    s_add_u32 s37, s62, 688128
    buffer_load_dwordx4 v7, s[48:51], s37 offen nt lds
    v_exp_f32 v41, v41
    v_exp_f32 v42, v42
    v_cvt_pk_bf16_f32 v38, v40, v41
    s_waitcnt lgkmcnt(2)
    v_mfma_f32_32x32x16_bf16 v[52:67], v[92:95], v[16:19], v[20:35]
    ds_read_b128 v[92:95], v8 offset:4096
    v_exp_f32 v43, v43
    v_exp_f32 v44, v44
    v_cvt_pk_bf16_f32 v39, v42, v43
    v_exp_f32 v45, v45
    v_exp_f32 v46, v46
    s_waitcnt lgkmcnt(2)
    v_mfma_f32_32x32x16_bf16 v[76:91], v[96:99], v[36:39], v[76:91]
    ds_read_b128 v[96:99], v9 offset:2048
    v_cvt_pk_bf16_f32 v40, v44, v45
    v_exp_f32 v47, v47
    v_exp_f32 v48, v48
    v_cvt_pk_bf16_f32 v41, v46, v47
    v_exp_f32 v49, v49
    v_exp_f32 v50, v50
    v_cvt_pk_bf16_f32 v42, v48, v49
    v_exp_f32 v51, v51
    v_exp_f32 v52, v52
    v_cvt_pk_bf16_f32 v43, v50, v51
    v_exp_f32 v53, v53
    v_exp_f32 v54, v54
    v_cvt_pk_bf16_f32 v52, v52, v53
    s_waitcnt lgkmcnt(2)
    v_mfma_f32_32x32x16_bf16 v[76:91], v[100:103], v[40:43], v[76:91]
    ds_read_b128 v[100:103], v9 offset:2560
    v_exp_f32 v55, v55
    v_exp_f32 v56, v56
    v_cvt_pk_bf16_f32 v53, v54, v55
    v_exp_f32 v57, v57
    v_exp_f32 v58, v58
    v_cvt_pk_bf16_f32 v54, v56, v57
    s_waitcnt lgkmcnt(2)
    v_mfma_f32_32x32x16_bf16 v[36:51], v[92:95], v[16:19], v[20:35]
    ds_read_b128 v[92:95], v8 offset:6144
    v_exp_f32 v59, v59
    v_exp_f32 v60, v60
    v_cvt_pk_bf16_f32 v55, v58, v59
    v_exp_f32 v61, v61
    v_exp_f32 v62, v62
    s_waitcnt lgkmcnt(2)
    v_mfma_f32_32x32x16_bf16 v[76:91], v[96:99], v[52:55], v[76:91]
    ds_read_b128 v[96:99], v9 offset:4096
    v_cvt_pk_bf16_f32 v56, v60, v61
    v_exp_f32 v63, v63
    v_exp_f32 v64, v64
    v_cvt_pk_bf16_f32 v57, v62, v63
    v_exp_f32 v65, v65
    v_exp_f32 v66, v66
    v_cvt_pk_bf16_f32 v58, v64, v65
    v_exp_f32 v67, v67
    v_exp_f32 v36, v36
    v_cvt_pk_bf16_f32 v59, v66, v67
    v_exp_f32 v37, v37
    v_exp_f32 v38, v38
    v_cvt_pk_bf16_f32 v36, v36, v37
    s_waitcnt lgkmcnt(2)
    v_mfma_f32_32x32x16_bf16 v[76:91], v[100:103], v[56:59], v[76:91]
    ds_read_b128 v[100:103], v9 offset:4608
    v_exp_f32 v39, v39
    v_exp_f32 v40, v40
    v_cvt_pk_bf16_f32 v37, v38, v39
    v_exp_f32 v41, v41
    v_exp_f32 v42, v42
    v_cvt_pk_bf16_f32 v38, v40, v41
    s_waitcnt lgkmcnt(2)
    v_mfma_f32_32x32x16_bf16 v[52:67], v[92:95], v[16:19], v[20:35]
    ds_read_b128 v[92:95], v8 offset:8192
    v_exp_f32 v43, v43
    v_exp_f32 v44, v44
    v_cvt_pk_bf16_f32 v39, v42, v43
    v_exp_f32 v45, v45
    v_exp_f32 v46, v46
    s_waitcnt lgkmcnt(2)
    v_mfma_f32_32x32x16_bf16 v[76:91], v[96:99], v[36:39], v[76:91]
    ds_read_b128 v[96:99], v9 offset:6144
    v_cvt_pk_bf16_f32 v40, v44, v45
    v_exp_f32 v47, v47
    v_exp_f32 v48, v48
    v_cvt_pk_bf16_f32 v41, v46, v47
    v_exp_f32 v49, v49
    v_exp_f32 v50, v50
    v_cvt_pk_bf16_f32 v42, v48, v49
    v_exp_f32 v51, v51
    v_exp_f32 v52, v52
    v_cvt_pk_bf16_f32 v43, v50, v51
    v_exp_f32 v53, v53
    v_exp_f32 v54, v54
    v_cvt_pk_bf16_f32 v52, v52, v53
    s_waitcnt lgkmcnt(2)
    v_mfma_f32_32x32x16_bf16 v[76:91], v[100:103], v[40:43], v[76:91]
    ds_read_b128 v[100:103], v9 offset:6656
    v_exp_f32 v55, v55
    v_exp_f32 v56, v56
    v_cvt_pk_bf16_f32 v53, v54, v55
    s_cmp_lt_u32 s3, 4
    s_cbranch_scc1 M_Pb55
    s_setprio 0
M_Pb55:
    v_exp_f32 v57, v57
    v_exp_f32 v58, v58
    v_cvt_pk_bf16_f32 v54, v56, v57
    s_waitcnt lgkmcnt(2)
    v_mfma_f32_32x32x16_bf16 v[36:51], v[92:95], v[16:19], v[20:35]
    ds_read_b128 v[92:95], v8 offset:10240
    v_exp_f32 v59, v59
    v_exp_f32 v60, v60
    v_cvt_pk_bf16_f32 v55, v58, v59
    v_exp_f32 v61, v61
    v_exp_f32 v62, v62
    s_waitcnt lgkmcnt(2)
    v_mfma_f32_32x32x16_bf16 v[76:91], v[96:99], v[52:55], v[76:91]
    ds_read_b128 v[96:99], v9 offset:8192
    v_cvt_pk_bf16_f32 v56, v60, v61
    v_exp_f32 v63, v63
    v_exp_f32 v64, v64
    v_cvt_pk_bf16_f32 v57, v62, v63
    v_exp_f32 v65, v65
    v_exp_f32 v66, v66
    v_cvt_pk_bf16_f32 v58, v64, v65
    v_exp_f32 v67, v67
    v_exp_f32 v36, v36
    v_cvt_pk_bf16_f32 v59, v66, v67
    v_exp_f32 v37, v37
    v_exp_f32 v38, v38
    v_cvt_pk_bf16_f32 v36, v36, v37
    s_waitcnt lgkmcnt(2)
    v_mfma_f32_32x32x16_bf16 v[76:91], v[100:103], v[56:59], v[76:91]
    ds_read_b128 v[100:103], v9 offset:8704
    v_exp_f32 v39, v39
    v_exp_f32 v40, v40
    v_cvt_pk_bf16_f32 v37, v38, v39
    v_exp_f32 v41, v41
    v_exp_f32 v42, v42
    v_cvt_pk_bf16_f32 v38, v40, v41
    s_waitcnt lgkmcnt(2)
    v_mfma_f32_32x32x16_bf16 v[52:67], v[92:95], v[16:19], v[20:35]
    ds_read_b128 v[92:95], v8 offset:12288
    v_exp_f32 v43, v43
    v_exp_f32 v44, v44
    v_cvt_pk_bf16_f32 v39, v42, v43
    v_exp_f32 v45, v45
    v_exp_f32 v46, v46
    s_waitcnt lgkmcnt(2)
    v_mfma_f32_32x32x16_bf16 v[76:91], v[96:99], v[36:39], v[76:91]
    ds_read_b128 v[96:99], v9 offset:10240
    v_cvt_pk_bf16_f32 v40, v44, v45
    v_exp_f32 v47, v47
    v_exp_f32 v48, v48
    v_cvt_pk_bf16_f32 v41, v46, v47
    v_exp_f32 v49, v49
    v_exp_f32 v50, v50
    v_cvt_pk_bf16_f32 v42, v48, v49
    v_exp_f32 v51, v51
    s_barrier
    v_exp_f32 v52, v52
    v_cvt_pk_bf16_f32 v43, v50, v51
    v_exp_f32 v53, v53
    v_exp_f32 v54, v54
    v_cvt_pk_bf16_f32 v52, v52, v53
    s_waitcnt lgkmcnt(2)
    v_mfma_f32_32x32x16_bf16 v[76:91], v[100:103], v[40:43], v[76:91]
    ds_read_b128 v[100:103], v9 offset:10752
    v_exp_f32 v55, v55
    v_exp_f32 v56, v56
    v_cvt_pk_bf16_f32 v53, v54, v55
    s_cmp_lt_u32 s3, 4
    s_cbranch_scc1 M_Pa61
    s_setprio 1
M_Pa61:
    v_exp_f32 v57, v57
    v_exp_f32 v58, v58
    v_cvt_pk_bf16_f32 v54, v56, v57
    s_waitcnt lgkmcnt(2)
    v_mfma_f32_32x32x16_bf16 v[36:51], v[92:95], v[16:19], v[20:35]
    ds_read_b128 v[92:95], v8 offset:14336
    v_exp_f32 v59, v59
    v_exp_f32 v60, v60
    v_cvt_pk_bf16_f32 v55, v58, v59
    v_exp_f32 v61, v61
    v_exp_f32 v62, v62
    s_waitcnt lgkmcnt(2)
    v_mfma_f32_32x32x16_bf16 v[76:91], v[96:99], v[52:55], v[76:91]
    ds_read_b128 v[96:99], v9 offset:12288
    v_cvt_pk_bf16_f32 v56, v60, v61
    v_exp_f32 v63, v63
    v_exp_f32 v64, v64
    v_cvt_pk_bf16_f32 v57, v62, v63
    s_add_u32 s10, s63, 98304
    s_mov_b32 m0, s10
    s_add_u32 s12, s13, 10240
    buffer_load_dwordx4 v3, s[20:23], s12 offen sc1 lds
    v_exp_f32 v65, v65
    v_exp_f32 v66, v66
    v_cvt_pk_bf16_f32 v58, v64, v65
    v_exp_f32 v67, v67
    s_add_u32 s10, s63, 106496
    s_mov_b32 m0, s10
    s_add_u32 s12, s13, 26624
    buffer_load_dwordx4 v3, s[20:23], s12 offen sc1 lds
    v_exp_f32 v36, v36
    v_cvt_pk_bf16_f32 v59, v66, v67
    v_exp_f32 v37, v37
    v_exp_f32 v38, v38
    v_cvt_pk_bf16_f32 v36, v36, v37
    s_waitcnt lgkmcnt(2)
    v_mfma_f32_32x32x16_bf16 v[76:91], v[100:103], v[56:59], v[76:91]
    ds_read_b128 v[100:103], v9 offset:12800
    v_exp_f32 v39, v39
    v_exp_f32 v40, v40
    v_cvt_pk_bf16_f32 v37, v38, v39
    s_add_u32 s10, s63, 114688
    s_mov_b32 m0, s10
    s_add_u32 s12, s13, 43008
    buffer_load_dwordx4 v3, s[20:23], s12 offen sc1 lds
    v_exp_f32 v41, v41
    v_exp_f32 v42, v42
    v_cvt_pk_bf16_f32 v38, v40, v41
    s_waitcnt lgkmcnt(2)
    v_mfma_f32_32x32x16_bf16 v[52:67], v[92:95], v[16:19], v[20:35]
    ds_read_b128 v[92:95], v8 offset:16384
    v_exp_f32 v43, v43
    v_exp_f32 v44, v44
    v_cvt_pk_bf16_f32 v39, v42, v43
    v_exp_f32 v45, v45
    v_exp_f32 v46, v46
    s_waitcnt lgkmcnt(2)
    v_mfma_f32_32x32x16_bf16 v[76:91], v[96:99], v[36:39], v[76:91]
    ds_read_b128 v[96:99], v9 offset:14336
    v_cvt_pk_bf16_f32 v40, v44, v45
    v_exp_f32 v47, v47
    v_exp_f32 v48, v48
    v_cvt_pk_bf16_f32 v41, v46, v47
    v_exp_f32 v49, v49
    v_exp_f32 v50, v50
    v_cvt_pk_bf16_f32 v42, v48, v49
    v_exp_f32 v51, v51
    v_exp_f32 v52, v52
    v_cvt_pk_bf16_f32 v43, v50, v51
    v_exp_f32 v53, v53
    v_exp_f32 v54, v54
    v_cvt_pk_bf16_f32 v52, v52, v53
    s_waitcnt lgkmcnt(2)
    v_mfma_f32_32x32x16_bf16 v[76:91], v[100:103], v[40:43], v[76:91]
    ds_read_b128 v[100:103], v9 offset:14848
    v_exp_f32 v55, v55
    v_exp_f32 v56, v56
    v_cvt_pk_bf16_f32 v53, v54, v55
    s_cmp_lt_u32 s3, 4
    s_cbranch_scc1 M_Pb61
    s_setprio 0
M_Pb61:
    v_exp_f32 v57, v57
    v_exp_f32 v58, v58
    v_cvt_pk_bf16_f32 v54, v56, v57
    s_add_u32 s12, s13, 59392
    buffer_load_dwordx4 v[20:23], v3, s[20:23], s12 offen sc1
    s_add_u32 s12, s13, 11264
    buffer_load_dwordx4 v[24:27], v3, s[20:23], s12 offen sc1
    v_exp_f32 v59, v59
    v_exp_f32 v60, v60
    v_cvt_pk_bf16_f32 v55, v58, v59
    v_exp_f32 v61, v61
    v_exp_f32 v62, v62
    s_waitcnt lgkmcnt(1)
    v_mfma_f32_32x32x16_bf16 v[76:91], v[96:99], v[52:55], v[76:91]
    s_add_u32 s12, s13, 27648
    buffer_load_dwordx4 v[28:31], v3, s[20:23], s12 offen sc1
    s_add_u32 s12, s13, 44032
    buffer_load_dwordx4 v[32:35], v3, s[20:23], s12 offen sc1
    v_cvt_pk_bf16_f32 v56, v60, v61
    v_exp_f32 v63, v63
    v_exp_f32 v64, v64
    v_cvt_pk_bf16_f32 v57, v62, v63
    s_add_u32 s12, s13, 60416
    buffer_load_dwordx4 v[36:39], v3, s[20:23], s12 offen sc1
    s_add_u32 s12, s13, 12288
    buffer_load_dwordx4 v[40:43], v3, s[20:23], s12 offen sc1
    v_exp_f32 v65, v65
    v_exp_f32 v66, v66
    v_cvt_pk_bf16_f32 v58, v64, v65
    v_exp_f32 v67, v67
    s_add_u32 s12, s13, 28672
    buffer_load_dwordx4 v[44:47], v3, s[20:23], s12 offen sc1
    s_add_u32 s12, s13, 45056
    buffer_load_dwordx4 v[48:51], v3, s[20:23], s12 offen sc1
    s_setprio 0
    v_cvt_pk_bf16_f32 v59, v66, v67
    s_waitcnt lgkmcnt(0)
    s_nop 0
    v_mfma_f32_32x32x16_bf16 v[76:91], v[100:103], v[56:59], v[76:91]
    s_nop 11
    v_add_f32 v12, |v76|, |v77|
    v_add_f32 v13, |v78|, |v79|
    v_add_f32 v12, v12, |v80|
    v_add_f32 v13, v13, |v81|
    v_add_f32 v12, v12, |v82|
    v_add_f32 v13, v13, |v83|
    v_add_f32 v12, v12, v84
    v_add_f32 v12, v12, v13
    s_mov_b32 s12, 0x7e800000
    v_cmp_gt_f32 vcc, s12, v12
    s_nop 0
    s_cmp_eq_u64 vcc, -1
    s_cbranch_scc0 M_SLOW
M_FIN:
    v_rcp_f32 v12, v84
    s_nop 0
    v_mul_f32 v76, v76, v12
    v_mul_f32 v77, v77, v12
    v_mul_f32 v78, v78, v12
    v_mul_f32 v79, v79, v12
    v_mul_f32 v80, v80, v12
    v_mul_f32 v81, v81, v12
    v_mul_f32 v82, v82, v12
    v_mul_f32 v83, v83, v12
    v_cvt_pk_bf16_f32 v52, v76, v77
    v_cvt_pk_bf16_f32 v53, v78, v79
    v_cvt_pk_bf16_f32 v54, v80, v81
    v_cvt_pk_bf16_f32 v55, v82, v83
    s_mul_i32 s12, s3, 1056
    s_add_u32 s12, s12, 147072
    v_add_u32 v12, s12, v6
    ds_write_b128 v12, v[52:55]
    v_and_b32 v13, 7, v2
    v_mul_u32_u24 v13, 1056, v13
    v_lshrrev_b32 v15, 4, v2
    v_lshl_add_u32 v13, v15, 4, v13
    s_lshl_b32 s10, s63, 1
    v_add_u32 v13, 147072, v13
    s_add_u32 s10, s10, 131072
    v_add_u32 v8, s10, v3
    s_add_u32 s10, s63, 98304
    v_add_u32 v9, s10, v3
    s_add_u32 s12, s13, 61440
    buffer_load_dwordx4 v[76:79], v3, s[20:23], s12 offen sc1
    s_add_u32 s12, s13, 13312
    buffer_load_dwordx4 v[80:83], v3, s[20:23], s12 offen sc1
    s_add_u32 s12, s13, 29696
    buffer_load_dwordx4 v[84:87], v3, s[20:23], s12 offen sc1
    s_add_u32 s12, s13, 46080
    buffer_load_dwordx4 v[88:91], v3, s[20:23], s12 offen sc1
    s_cmp_lt_u32 s3, 4
    s_cbranch_scc1 M_Pe1
    s_setprio 1
M_Pe1:
    s_waitcnt lgkmcnt(0)
    s_barrier
    ds_read_b128 v[92:95], v13 offset:0
    ds_read_b128 v[96:99], v13 offset:64
    ds_read_b128 v[100:103], v13 offset:128
    ds_read_b128 v[16:19], v13 offset:192
    s_waitcnt lgkmcnt(3) vmcnt(12)
    v_mfma_f32_16x16x32_bf16 v[52:55], v[108:111], v[92:95], 0
    s_add_u32 s12, s13, 62464
    buffer_load_dwordx4 v[108:111], v3, s[20:23], s12 offen sc1
    v_mfma_f32_16x16x32_bf16 v[56:59], v[112:115], v[92:95], 0
    s_add_u32 s12, s13, 14336
    buffer_load_dwordx4 v[112:115], v3, s[20:23], s12 offen sc1
    v_mfma_f32_16x16x32_bf16 v[60:63], v[116:119], v[92:95], 0
    s_add_u32 s12, s13, 30720
    buffer_load_dwordx4 v[116:119], v3, s[20:23], s12 offen sc1
    v_mfma_f32_16x16x32_bf16 v[64:67], v[120:123], v[92:95], 0
    s_add_u32 s12, s13, 47104
    buffer_load_dwordx4 v[120:123], v3, s[20:23], s12 offen sc1
    ds_read_b128 v[92:95], v13 offset:256
    s_waitcnt lgkmcnt(3)
    v_mfma_f32_16x16x32_bf16 v[52:55], v[124:127], v[96:99], v[52:55]
    s_add_u32 s12, s13, 63488
    buffer_load_dwordx4 v[124:127], v3, s[20:23], s12 offen sc1
    v_mfma_f32_16x16x32_bf16 v[56:59], v[128:131], v[96:99], v[56:59]
    s_add_u32 s12, s13, 15360
    buffer_load_dwordx4 v[128:131], v3, s[20:23], s12 offen sc1
    v_mfma_f32_16x16x32_bf16 v[60:63], v[132:135], v[96:99], v[60:63]
    s_add_u32 s12, s13, 31744
    buffer_load_dwordx4 v[132:135], v3, s[20:23], s12 offen sc1
    v_mfma_f32_16x16x32_bf16 v[64:67], v[136:139], v[96:99], v[64:67]
    s_add_u32 s12, s13, 48128
    buffer_load_dwordx4 v[136:139], v3, s[20:23], s12 offen sc1
    ds_read_b128 v[96:99], v13 offset:320
    s_waitcnt lgkmcnt(3)
    v_mfma_f32_16x16x32_bf16 v[52:55], v[140:143], v[100:103], v[52:55]
    s_add_u32 s12, s13, 64512
    buffer_load_dwordx4 v[140:143], v3, s[20:23], s12 offen sc1
    v_mfma_f32_16x16x32_bf16 v[56:59], v[144:147], v[100:103], v[56:59]
    ds_read_b128 v[144:147], v8 offset:0
    v_mfma_f32_16x16x32_bf16 v[60:63], v[148:151], v[100:103], v[60:63]
    ds_read_b128 v[148:151], v9 offset:0
    v_mfma_f32_16x16x32_bf16 v[64:67], v[152:155], v[100:103], v[64:67]
    ds_read_b128 v[152:155], v9 offset:8192
    ds_read_b128 v[100:103], v13 offset:384
    s_waitcnt lgkmcnt(6)
    v_mfma_f32_16x16x32_bf16 v[52:55], v[156:159], v[16:19], v[52:55]
    ds_read_b128 v[156:159], v9 offset:16384
    v_mfma_f32_16x16x32_bf16 v[56:59], v[160:163], v[16:19], v[56:59]
    v_mfma_f32_16x16x32_bf16 v[60:63], v[164:167], v[16:19], v[60:63]
    v_mfma_f32_16x16x32_bf16 v[64:67], v[168:171], v[16:19], v[64:67]
    ds_read_b128 v[16:19], v13 offset:448
    s_waitcnt lgkmcnt(7)
    v_mfma_f32_16x16x32_bf16 v[52:55], v[172:175], v[92:95], v[52:55]
    v_mfma_f32_16x16x32_bf16 v[56:59], v[176:179], v[92:95], v[56:59]
    v_mfma_f32_16x16x32_bf16 v[60:63], v[180:183], v[92:95], v[60:63]
    v_mfma_f32_16x16x32_bf16 v[64:67], v[184:187], v[92:95], v[64:67]
    ds_read_b128 v[92:95], v13 offset:512
    s_waitcnt lgkmcnt(7)
    v_mfma_f32_16x16x32_bf16 v[52:55], v[188:191], v[96:99], v[52:55]
    v_mfma_f32_16x16x32_bf16 v[56:59], v[192:195], v[96:99], v[56:59]
    v_mfma_f32_16x16x32_bf16 v[60:63], v[196:199], v[96:99], v[60:63]
    v_mfma_f32_16x16x32_bf16 v[64:67], v[200:203], v[96:99], v[64:67]
    ds_read_b128 v[96:99], v13 offset:576
    s_waitcnt lgkmcnt(4)
    v_mfma_f32_16x16x32_bf16 v[52:55], v[204:207], v[100:103], v[52:55]
    v_mfma_f32_16x16x32_bf16 v[56:59], v[208:211], v[100:103], v[56:59]
    v_mfma_f32_16x16x32_bf16 v[60:63], v[212:215], v[100:103], v[60:63]
    v_mfma_f32_16x16x32_bf16 v[64:67], v[216:219], v[100:103], v[64:67]
    ds_read_b128 v[100:103], v13 offset:640
    s_waitcnt lgkmcnt(3)
    v_mfma_f32_16x16x32_bf16 v[52:55], v[220:223], v[16:19], v[52:55]
    v_mfma_f32_16x16x32_bf16 v[56:59], v[224:227], v[16:19], v[56:59]
    s_waitcnt lgkmcnt(4)
    v_mfma_f32_16x16x32_bf16 v[60:63], v[228:231], v[16:19], v[60:63]
    s_add_u32 s36, s63, 98304
    s_mov_b32 m0, s36
    s_add_u32 s37, s62, 917504
    buffer_load_dwordx4 v7, s[48:51], s37 offen  lds
    v_mfma_f32_16x16x32_bf16 v[64:67], v[232:235], v[16:19], v[64:67]
    s_add_u32 s36, s63, 106496
    s_mov_b32 m0, s36
    s_add_u32 s37, s62, 1146880
    buffer_load_dwordx4 v7, s[48:51], s37 offen  lds
    ds_read_b128 v[16:19], v13 offset:704
    s_waitcnt lgkmcnt(3)
    v_mfma_f32_16x16x32_bf16 v[52:55], v[236:239], v[92:95], v[52:55]
    s_add_u32 s36, s63, 114688
    s_mov_b32 m0, s36
    s_add_u32 s37, s62, 1376256
    buffer_load_dwordx4 v7, s[48:51], s37 offen  lds
    v_mfma_f32_16x16x32_bf16 v[56:59], v[240:243], v[92:95], v[56:59]
    s_add_u32 s36, s63, 122880
    s_mov_b32 m0, s36
    s_add_u32 s37, s62, 1605632
    buffer_load_dwordx4 v7, s[48:51], s37 offen  lds
    v_mfma_f32_16x16x32_bf16 v[60:63], v[244:247], v[92:95], v[60:63]
    v_mfma_f32_16x16x32_bf16 v[64:67], v[248:251], v[92:95], v[64:67]
    ds_read_b128 v[92:95], v13 offset:768
    s_waitcnt lgkmcnt(3)
    v_mfma_f32_16x16x32_bf16 v[52:55], v[252:255], v[96:99], v[52:55]
    v_mfma_f32_16x16x32_bf16 v[56:59], v[68:71], v[96:99], v[56:59]
    v_mfma_f32_16x16x32_bf16 v[60:63], v[72:75], v[96:99], v[60:63]
    s_waitcnt lgkmcnt(10)
    v_mfma_f32_16x16x32_bf16 v[64:67], v[144:147], v[96:99], v[64:67]
    ds_read_b128 v[96:99], v13 offset:832
    s_waitcnt lgkmcnt(3)
    v_mfma_f32_16x16x32_bf16 v[52:55], v[148:151], v[100:103], v[52:55]
    s_setprio 0
    s_waitcnt lgkmcnt(9)
    v_mfma_f32_16x16x32_bf16 v[56:59], v[152:155], v[100:103], v[56:59]
    s_waitcnt lgkmcnt(7)
    v_mfma_f32_16x16x32_bf16 v[60:63], v[156:159], v[100:103], v[60:63]
    v_lshrrev_b32 v15, 3, v2
    v_lshlrev_b32 v12, 5, v15
    s_lshl_b32 s12, s3, 8
    s_add_u32 s12, s12, 155520
    v_add_u32 v12, s12, v12
    ds_read_b128 v[184:187], v12 offset:0
    ds_read_b128 v[188:191], v12 offset:16
    ds_read_b128 v[192:195], v12 offset:2048
    ds_read_b128 v[196:199], v12 offset:2064
    ds_read_b128 v[200:203], v12 offset:4096
    ds_read_b128 v[204:207], v12 offset:4112
    v_lshlrev_b32 v208, 16, v104
    v_and_b32 v209, 0xffff0000, v104
    v_lshlrev_b32 v210, 16, v105
    v_and_b32 v211, 0xffff0000, v105
    v_lshlrev_b32 v212, 16, v106
    v_and_b32 v213, 0xffff0000, v106
    v_lshlrev_b32 v214, 16, v107
    v_and_b32 v215, 0xffff0000, v107
    v_and_b32 v244, 8, v2
    v_cmp_eq_u32 s[34:35], 0, v244
    v_and_b32 v245, 7, v2
    v_lshlrev_b32 v246, 9, v15
    v_lshl_add_u32 v246, v245, 4, v246
    v_lshlrev_b32 v244, 6, v245
    v_add_u32 v244, 132096, v244
    s_lshl_b32 s12, s3, 3
    v_add_u32 v245, s12, v244
    v_mov_b32 v247, 0x3727c5ac
    s_lshr_b32 s38, s6, 5
    s_lshl_b32 s38, s38, 15
    s_and_b32 s14, s6, 31
    s_lshl_b32 s14, s14, 4
    s_add_u32 s38, s38, s14
    s_lshl_b32 s14, s3, 12
    s_add_u32 s38, s38, s14
    s_add_u32 s38, s38, 2097152
    s_waitcnt vmcnt(24)
    v_mfma_f32_16x16x32_bf16 v[64:67], v[20:23], v[100:103], v[64:67]
    ds_read_b128 v[100:103], v13 offset:896
    s_waitcnt lgkmcnt(9) vmcnt(23)
    v_mfma_f32_16x16x32_bf16 v[52:55], v[24:27], v[16:19], v[52:55]
    s_waitcnt vmcnt(22)
    v_mfma_f32_16x16x32_bf16 v[56:59], v[28:31], v[16:19], v[56:59]
    s_waitcnt vmcnt(21)
    v_mfma_f32_16x16x32_bf16 v[60:63], v[32:35], v[16:19], v[60:63]
    s_waitcnt vmcnt(20)
    v_mfma_f32_16x16x32_bf16 v[64:67], v[36:39], v[16:19], v[64:67]
    ds_read_b128 v[16:19], v13 offset:960
    s_waitcnt lgkmcnt(9) vmcnt(19)
    v_mfma_f32_16x16x32_bf16 v[52:55], v[40:43], v[92:95], v[52:55]
    s_waitcnt vmcnt(18)
    v_mfma_f32_16x16x32_bf16 v[56:59], v[44:47], v[92:95], v[56:59]
    s_waitcnt vmcnt(17)
    v_mfma_f32_16x16x32_bf16 v[60:63], v[48:51], v[92:95], v[60:63]
    s_waitcnt vmcnt(16)
    v_mfma_f32_16x16x32_bf16 v[64:67], v[76:79], v[92:95], v[64:67]
    s_waitcnt lgkmcnt(8) vmcnt(15)
    v_mfma_f32_16x16x32_bf16 v[52:55], v[80:83], v[96:99], v[52:55]
    s_waitcnt vmcnt(14)
    v_mfma_f32_16x16x32_bf16 v[56:59], v[84:87], v[96:99], v[56:59]
    s_waitcnt vmcnt(13)
    v_mfma_f32_16x16x32_bf16 v[60:63], v[88:91], v[96:99], v[60:63]
    s_waitcnt vmcnt(12)
    v_mfma_f32_16x16x32_bf16 v[64:67], v[108:111], v[96:99], v[64:67]
    s_waitcnt lgkmcnt(1) vmcnt(11)
    v_mfma_f32_16x16x32_bf16 v[52:55], v[112:115], v[100:103], v[52:55]
    s_waitcnt vmcnt(10)
    v_mfma_f32_16x16x32_bf16 v[56:59], v[116:119], v[100:103], v[56:59]
    s_waitcnt vmcnt(9)
    v_mfma_f32_16x16x32_bf16 v[60:63], v[120:123], v[100:103], v[60:63]
    s_waitcnt vmcnt(8)
    v_mfma_f32_16x16x32_bf16 v[64:67], v[124:127], v[100:103], v[64:67]
    s_waitcnt lgkmcnt(0) vmcnt(7)
    v_mfma_f32_16x16x32_bf16 v[52:55], v[128:131], v[16:19], v[52:55]
    s_waitcnt vmcnt(6)
    v_mfma_f32_16x16x32_bf16 v[56:59], v[132:135], v[16:19], v[56:59]
    s_waitcnt vmcnt(5)
    v_mfma_f32_16x16x32_bf16 v[60:63], v[136:139], v[16:19], v[60:63]
    s_waitcnt vmcnt(4)
    v_mfma_f32_16x16x32_bf16 v[64:67], v[140:143], v[16:19], v[64:67]
    s_nop 5
    v_cndmask_b32 v52, v60, v52, s[34:35]
    v_cndmask_b32 v53, v61, v53, s[34:35]
    v_cndmask_b32 v54, v62, v54, s[34:35]
    v_cndmask_b32 v55, v63, v55, s[34:35]
    v_cndmask_b32 v56, v64, v56, s[34:35]
    v_cndmask_b32 v57, v65, v57, s[34:35]
    v_cndmask_b32 v58, v66, v58, s[34:35]
    v_cndmask_b32 v59, v67, v59, s[34:35]
    v_pk_fma_f32 v[208:209], v[52:53], v[184:185], v[208:209]
    v_pk_fma_f32 v[210:211], v[54:55], v[186:187], v[210:211]
    v_pk_fma_f32 v[212:213], v[56:57], v[188:189], v[212:213]
    v_pk_fma_f32 v[214:215], v[58:59], v[190:191], v[214:215]
    v_pk_add_f32 v[216:217], v[208:209], v[210:211]
    v_pk_add_f32 v[218:219], v[212:213], v[214:215]
    v_pk_add_f32 v[216:217], v[216:217], v[218:219]
    v_add_f32 v216, v216, v217
    v_cvt_pk_bf16_f32 v104, v208, v209
    v_cvt_pk_bf16_f32 v105, v210, v211
    v_add_f32_dpp v216, v216, v216 row_ror:8 row_mask:0xf bank_mask:0xf
    v_mov_b32 v218, v216
    s_nop 1
    v_permlane16_swap_b32 v216, v218
    v_add_f32 v216, v216, v218
    v_mov_b32 v218, v216
    s_nop 1
    v_permlane32_swap_b32 v216, v218
    v_add_f32 v216, v216, v218
    v_mul_f32 v216, 0x3c800000, v216
    v_pk_add_f32 v[220:221], v[208:209], v[216:217] op_sel_hi:[1,0] neg_lo:[0,1] neg_hi:[0,1]
    v_pk_add_f32 v[222:223], v[210:211], v[216:217] op_sel_hi:[1,0] neg_lo:[0,1] neg_hi:[0,1]
    v_pk_add_f32 v[224:225], v[212:213], v[216:217] op_sel_hi:[1,0] neg_lo:[0,1] neg_hi:[0,1]
    v_pk_add_f32 v[226:227], v[214:215], v[216:217] op_sel_hi:[1,0] neg_lo:[0,1] neg_hi:[0,1]
    v_pk_mul_f32 v[218:219], v[220:221], v[220:221]
    v_pk_fma_f32 v[218:219], v[222:223], v[222:223], v[218:219]
    v_pk_fma_f32 v[218:219], v[224:225], v[224:225], v[218:219]
    v_pk_fma_f32 v[218:219], v[226:227], v[226:227], v[218:219]
    v_add_f32 v217, v218, v219
    v_cvt_pk_bf16_f32 v106, v212, v213
    v_cvt_pk_bf16_f32 v107, v214, v215
    v_add_f32_dpp v217, v217, v217 row_ror:8 row_mask:0xf bank_mask:0xf
    v_mov_b32 v218, v217
    s_nop 1
    v_permlane16_swap_b32 v217, v218
    v_add_f32 v217, v217, v218
    v_mov_b32 v218, v217
    s_nop 1
    v_permlane32_swap_b32 v217, v218
    v_add_f32 v217, v217, v218
    s_mov_b64 exec, 0xff
    ds_write_b64 v245, v[216:217]
    s_mov_b64 exec, -1
    global_store_dwordx4 v14, v[104:107], s[56:57]
    v_pk_mul_f32 v[220:221], v[220:221], v[200:201]
    v_pk_mul_f32 v[222:223], v[222:223], v[202:203]
    v_pk_mul_f32 v[224:225], v[224:225], v[204:205]
    v_pk_mul_f32 v[226:227], v[226:227], v[206:207]
    s_waitcnt lgkmcnt(0)
    s_barrier
    ds_read_b128 v[228:231], v244 offset:0
    ds_read_b128 v[232:235], v244 offset:16
    ds_read_b128 v[236:239], v244 offset:32
    ds_read_b128 v[240:243], v244 offset:48
    s_waitcnt lgkmcnt(0)
    v_pk_add_f32 v[208:209], v[228:229], v[230:231]
    v_pk_add_f32 v[210:211], v[232:233], v[234:235]
    v_pk_add_f32 v[212:213], v[236:237], v[238:239]
    v_pk_add_f32 v[214:215], v[240:241], v[242:243]
    v_pk_add_f32 v[208:209], v[208:209], v[210:211]
    v_pk_add_f32 v[212:213], v[212:213], v[214:215]
    v_pk_add_f32 v[208:209], v[208:209], v[212:213]
    v_mul_f32 v208, 0x3e000000, v208
    v_fmamk_f32 v209, v209, 0x3b000000, v247
    v_sub_f32 v228, v228, v208
    v_sub_f32 v230, v230, v208
    v_sub_f32 v232, v232, v208
    v_sub_f32 v234, v234, v208
    v_sub_f32 v236, v236, v208
    v_sub_f32 v238, v238, v208
    v_sub_f32 v240, v240, v208
    v_sub_f32 v242, v242, v208
    v_sub_f32 v216, v216, v208
    v_mul_f32 v210, v228, v228
    v_mul_f32 v211, v230, v230
    v_fmac_f32 v210, v232, v232
    v_fmac_f32 v211, v234, v234
    v_fmac_f32 v210, v236, v236
    v_fmac_f32 v211, v238, v238
    v_fmac_f32 v210, v240, v240
    v_fmac_f32 v211, v242, v242
    v_add_f32 v210, v210, v211
    v_fmac_f32 v209, 0x3e000000, v210
    v_rsq_f32 v212, v209
    v_pk_fma_f32 v[220:221], v[200:201], v[216:217], v[220:221] op_sel_hi:[1,0,1]
    v_pk_fma_f32 v[222:223], v[202:203], v[216:217], v[222:223] op_sel_hi:[1,0,1]
    v_pk_fma_f32 v[224:225], v[204:205], v[216:217], v[224:225] op_sel_hi:[1,0,1]
    v_pk_fma_f32 v[226:227], v[206:207], v[216:217], v[226:227] op_sel_hi:[1,0,1]
    v_pk_fma_f32 v[192:193], v[220:221], v[212:213], v[192:193] op_sel_hi:[1,0,1]
    v_pk_fma_f32 v[194:195], v[222:223], v[212:213], v[194:195] op_sel_hi:[1,0,1]
    v_pk_fma_f32 v[196:197], v[224:225], v[212:213], v[196:197] op_sel_hi:[1,0,1]
    v_pk_fma_f32 v[198:199], v[226:227], v[212:213], v[198:199] op_sel_hi:[1,0,1]
    v_cvt_pk_bf16_f32 v220, v192, v193
    v_cvt_pk_bf16_f32 v221, v194, v195
    v_cvt_pk_bf16_f32 v222, v196, v197
    v_cvt_pk_bf16_f32 v223, v198, v199
    buffer_store_dwordx4 v[220:223], v246, s[20:23], s38 offen
    s_lshl_b32 s12, s5, 3
    s_add_u32 s12, s12, s3
    s_lshl_b32 s12, s12, 2
    v_mov_b32 v6, s12
    v_mov_b32 v5, v7
    v_mov_b32 v7, s59
    v_bfe_u32 v16, v2, 4, 1
    v_lshlrev_b32 v12, 16, v16
    v_lshrrev_b32 v17, 5, v2
    v_lshl_add_u32 v12, v17, 10, v12
    v_bfe_u32 v17, v2, 2, 2
    v_lshl_add_u32 v12, v17, 7, v12
    v_bfe_u32 v13, v2, 1, 1
    v_lshl_add_u32 v12, v13, 3, v12
    v_and_b32 v13, 1, v2
    v_and_b32 v17, 2, v17
    v_xor_b32 v13, v13, v17
    v_lshlrev_b32 v16, 2, v16
    v_xor_b32 v13, v13, v16
    v_lshl_add_u32 v8, v13, 4, v12
    v_xor_b32 v9, 32, v8
    v_xor_b32 v10, 64, v8
    v_xor_b32 v11, 0x60, v8
    s_lshl_b32 s11, s4, 3
    s_add_u32 s11, s11, s3
    s_mul_i32 s14, s11, 0x1c000
    s_lshl_b32 s11, s11, 15
    s_lshl_b32 s13, s5, 12
    s_add_u32 s14, s14, s13
    v_and_b32 v12, 31, v2
    s_lshl_b32 s13, s3, 7
    v_lshl_add_u32 v12, v12, 2, s13
    v_mov_b32 v15, 0xbdd2d3e8
    s_mov_b32 s42, 0xbdd2d3e8
    s_mov_b32 s43, 0xc0135761
    s_add_u32 s11, s11, 2097152
    s_add_u32 s14, s14, 12582912
    s_waitcnt vmcnt(0)
    s_mov_b64 exec, 1
    s_cmp_lg_u32 s60, 0
    s_cbranch_scc1 M_PF1
    buffer_wbl2 sc1
    s_waitcnt vmcnt(0)
    buffer_store_dword v7, v6, s[20:23], s61 offen sc0 sc1
    s_branch M_PX1
M_PF1:
    buffer_store_dword v7, v6, s[20:23], s61 offen
M_PX1:
    s_mov_b64 exec, -1
    s_and_b32 s15, s5, 7
    s_lshl_b32 s17, s15, 1
    s_and_b32 s6, s3, 1
    s_add_u32 s17, s17, s6
    s_lshl_b32 s17, s17, 2
    s_lshr_b32 s8, s3, 2
    s_add_u32 s17, s17, s8
    s_lshl_b32 s17, s17, 4
    s_lshl_b32 s38, s17, 1
    v_lshrrev_b32 v16, 5, v2
    s_add_u32 s38, s38, 161792
    v_lshl_add_u32 v16, v16, 6, s38
    ds_read_b128 v[56:59], v16
    ds_read_b128 v[60:63], v16 offset:16
    v_lshrrev_b32 v16, 3, v2
    v_and_b32 v17, 7, v2
    v_and_b32 v18, 2, v16
    v_lshlrev_b32 v18, 1, v18
    v_xor_b32 v17, v17, v18
    v_lshlrev_b32 v14, 10, v16
    v_lshl_add_u32 v14, v17, 4, v14
    s_lshl_b32 s10, s15, 7
    s_lshr_b32 s9, s5, 3
    s_mul_i32 s13, s9, 7
    s_mul_i32 s16, s15, 3
    s_add_u32 s13, s13, s16
    s_add_u32 s13, s13, s3
    s_cmp_ge_u32 s13, 28
    s_cselect_b32 s38, 28, 0
    s_sub_u32 s13, s13, s38
    s_mov_b32 s39, s13
    s_lshl_b32 s41, s3, 11
    s_lshl_b32 s12, s3, 5
    s_add_u32 s12, s12, s5
    s_lshl_b32 s12, s12, 2
    s_add_u32 s12, s12, 1024
    v_mov_b32 v6, s12
    s_cmp_ge_u32 s5, 28
    s_cbranch_scc1 M_SPARE
    s_mov_b32 s36, 0x80000
M_W1:
    buffer_load_dword v13, v12, s[20:23], s61 offen offset:0 sc1
    s_waitcnt vmcnt(0)
    v_cmp_eq_u32 vcc, s59, v13
    s_nop 0
    s_cmp_eq_u64 vcc, -1
    s_cbranch_scc1 M_G1
    s_sleep 2
    s_sub_u32 s36, s36, 1
    s_cmp_lg_u32 s36, 0
    s_cbranch_scc1 M_W1
M_G1:
    s_cmp_lg_u32 s60, 0
    s_cbranch_scc1 M_A1
    buffer_inv sc1
    s_waitcnt vmcnt(0)
M_A1:
    s_cmp_ge_u32 s3, 4
    s_cbranch_scc1 M_F1Y
    buffer_load_dwordx4 v[128:131], v3, s[20:23], s11 offen offset:0 sc1
    buffer_load_dwordx4 v[132:135], v3, s[20:23], s11 offen offset:1024 sc1
    buffer_load_dwordx4 v[136:139], v3, s[20:23], s11 offen offset:2048 sc1
    buffer_load_dwordx4 v[140:143], v3, s[20:23], s11 offen offset:3072 sc1
    s_add_u32 s11, s11, 4096
    buffer_load_dwordx4 v[144:147], v3, s[20:23], s11 offen offset:0 sc1
    buffer_load_dwordx4 v[148:151], v3, s[20:23], s11 offen offset:1024 sc1
    buffer_load_dwordx4 v[152:155], v3, s[20:23], s11 offen offset:2048 sc1
    buffer_load_dwordx4 v[156:159], v3, s[20:23], s11 offen offset:3072 sc1
    s_add_u32 s11, s11, 4096
    buffer_load_dwordx4 v[160:163], v3, s[20:23], s11 offen offset:0 sc1
    buffer_load_dwordx4 v[164:167], v3, s[20:23], s11 offen offset:1024 sc1
    s_waitcnt lgkmcnt(0)
    s_barrier
    ds_read_b64_tr_b16 v[32:33], v8 offset:0
    ds_read_b64_tr_b16 v[34:35], v8 offset:512
    ds_read_b64_tr_b16 v[36:37], v9 offset:0
    ds_read_b64_tr_b16 v[38:39], v9 offset:512
    ds_read_b64_tr_b16 v[40:41], v10 offset:0
    ds_read_b64_tr_b16 v[42:43], v10 offset:512
    ds_read_b64_tr_b16 v[44:45], v11 offset:0
    ds_read_b64_tr_b16 v[46:47], v11 offset:512
    buffer_load_dwordx4 v[168:171], v3, s[20:23], s11 offen offset:2048 sc1
    ds_read_b64_tr_b16 v[48:49], v8 offset:2048
    ds_read_b64_tr_b16 v[50:51], v8 offset:2560
    s_waitcnt lgkmcnt(8) vmcnt(10)
    v_mfma_f32_32x32x16_bf16 v[64:79], v[32:35], v[128:131], 0
    buffer_load_dwordx4 v[172:175], v3, s[20:23], s11 offen offset:3072 sc1
    ds_read_b64_tr_b16 v[52:53], v9 offset:2048
    ds_read_b64_tr_b16 v[54:55], v9 offset:2560
    s_waitcnt lgkmcnt(8)
    v_mfma_f32_32x32x16_bf16 v[80:95], v[36:39], v[128:131], 0
    s_add_u32 s11, s11, 4096
    buffer_load_dwordx4 v[176:179], v3, s[20:23], s11 offen offset:0 sc1
    ds_read_b64_tr_b16 v[32:33], v10 offset:2048
    ds_read_b64_tr_b16 v[34:35], v10 offset:2560
    s_waitcnt lgkmcnt(8)
    v_mfma_f32_32x32x16_bf16 v[96:111], v[40:43], v[128:131], 0
    buffer_load_dwordx4 v[180:183], v3, s[20:23], s11 offen offset:1024 sc1
    ds_read_b64_tr_b16 v[36:37], v11 offset:2048
    ds_read_b64_tr_b16 v[38:39], v11 offset:2560
    s_waitcnt lgkmcnt(8)
    v_mfma_f32_32x32x16_bf16 v[112:127], v[44:47], v[128:131], 0
    buffer_load_dwordx4 v[184:187], v3, s[20:23], s11 offen offset:2048 sc1
    ds_read_b64_tr_b16 v[40:41], v8 offset:4096
    ds_read_b64_tr_b16 v[42:43], v8 offset:4608
    s_waitcnt lgkmcnt(8) vmcnt(13)
    v_mfma_f32_32x32x16_bf16 v[64:79], v[48:51], v[132:135], v[64:79]
    buffer_load_dwordx4 v[188:191], v3, s[20:23], s11 offen offset:3072 sc1
    s_barrier
    ds_read_b64_tr_b16 v[44:45], v9 offset:4096
    ds_read_b64_tr_b16 v[46:47], v9 offset:4608
    s_waitcnt lgkmcnt(8)
    v_mfma_f32_32x32x16_bf16 v[80:95], v[52:55], v[132:135], v[80:95]
    ds_read_b64_tr_b16 v[48:49], v10 offset:4096
    ds_read_b64_tr_b16 v[50:51], v10 offset:4608
    s_waitcnt lgkmcnt(8)
    v_mfma_f32_32x32x16_bf16 v[96:111], v[32:35], v[132:135], v[96:111]
    ds_read_b64_tr_b16 v[52:53], v11 offset:4096
    ds_read_b64_tr_b16 v[54:55], v11 offset:4608
    s_waitcnt lgkmcnt(8)
    v_mfma_f32_32x32x16_bf16 v[112:127], v[36:39], v[132:135], v[112:127]
    ds_read_b64_tr_b16 v[32:33], v8 offset:6144
    ds_read_b64_tr_b16 v[34:35], v8 offset:6656
    s_waitcnt lgkmcnt(8) vmcnt(13)
    v_mfma_f32_32x32x16_bf16 v[64:79], v[40:43], v[136:139], v[64:79]
    ds_read_b64_tr_b16 v[36:37], v9 offset:6144
    ds_read_b64_tr_b16 v[38:39], v9 offset:6656
    s_waitcnt lgkmcnt(8)
    v_mfma_f32_32x32x16_bf16 v[80:95], v[44:47], v[136:139], v[80:95]
    ds_read_b64_tr_b16 v[40:41], v10 offset:6144
    ds_read_b64_tr_b16 v[42:43], v10 offset:6656
    s_waitcnt lgkmcnt(8)
    v_mfma_f32_32x32x16_bf16 v[96:111], v[48:51], v[136:139], v[96:111]
    ds_read_b64_tr_b16 v[44:45], v11 offset:6144
    ds_read_b64_tr_b16 v[46:47], v11 offset:6656
    s_waitcnt lgkmcnt(8)
    v_mfma_f32_32x32x16_bf16 v[112:127], v[52:55], v[136:139], v[112:127]
    ds_read_b64_tr_b16 v[48:49], v8 offset:8192
    ds_read_b64_tr_b16 v[50:51], v8 offset:8704
    s_waitcnt lgkmcnt(8) vmcnt(12)
    v_mfma_f32_32x32x16_bf16 v[64:79], v[32:35], v[140:143], v[64:79]
    ds_read_b64_tr_b16 v[52:53], v9 offset:8192
    ds_read_b64_tr_b16 v[54:55], v9 offset:8704
    s_waitcnt lgkmcnt(8)
    v_mfma_f32_32x32x16_bf16 v[80:95], v[36:39], v[140:143], v[80:95]
    ds_read_b64_tr_b16 v[32:33], v10 offset:8192
    ds_read_b64_tr_b16 v[34:35], v10 offset:8704
    s_waitcnt lgkmcnt(8)
    v_mfma_f32_32x32x16_bf16 v[96:111], v[40:43], v[140:143], v[96:111]
    ds_read_b64_tr_b16 v[36:37], v11 offset:8192
    ds_read_b64_tr_b16 v[38:39], v11 offset:8704
    s_waitcnt lgkmcnt(8)
    v_mfma_f32_32x32x16_bf16 v[112:127], v[44:47], v[140:143], v[112:127]
    ds_read_b64_tr_b16 v[40:41], v8 offset:10240
    ds_read_b64_tr_b16 v[42:43], v8 offset:10752
    s_waitcnt lgkmcnt(8) vmcnt(11)
    v_mfma_f32_32x32x16_bf16 v[64:79], v[48:51], v[144:147], v[64:79]
    ds_read_b64_tr_b16 v[44:45], v9 offset:10240
    ds_read_b64_tr_b16 v[46:47], v9 offset:10752
    s_waitcnt lgkmcnt(8)
    v_mfma_f32_32x32x16_bf16 v[80:95], v[52:55], v[144:147], v[80:95]
    ds_read_b64_tr_b16 v[48:49], v10 offset:10240
    ds_read_b64_tr_b16 v[50:51], v10 offset:10752
    s_waitcnt lgkmcnt(8)
    v_mfma_f32_32x32x16_bf16 v[96:111], v[32:35], v[144:147], v[96:111]
    ds_read_b64_tr_b16 v[52:53], v11 offset:10240
    ds_read_b64_tr_b16 v[54:55], v11 offset:10752
    s_waitcnt lgkmcnt(8)
    v_mfma_f32_32x32x16_bf16 v[112:127], v[36:39], v[144:147], v[112:127]
    ds_read_b64_tr_b16 v[32:33], v8 offset:12288
    ds_read_b64_tr_b16 v[34:35], v8 offset:12800
    s_waitcnt lgkmcnt(8) vmcnt(10)
    v_mfma_f32_32x32x16_bf16 v[64:79], v[40:43], v[148:151], v[64:79]
    ds_read_b64_tr_b16 v[36:37], v9 offset:12288
    ds_read_b64_tr_b16 v[38:39], v9 offset:12800
    s_waitcnt lgkmcnt(8)
    v_mfma_f32_32x32x16_bf16 v[80:95], v[44:47], v[148:151], v[80:95]
    ds_read_b64_tr_b16 v[40:41], v10 offset:12288
    ds_read_b64_tr_b16 v[42:43], v10 offset:12800
    s_waitcnt lgkmcnt(8)
    v_mfma_f32_32x32x16_bf16 v[96:111], v[48:51], v[148:151], v[96:111]
    ds_read_b64_tr_b16 v[44:45], v11 offset:12288
    ds_read_b64_tr_b16 v[46:47], v11 offset:12800
    s_waitcnt lgkmcnt(8)
    v_mfma_f32_32x32x16_bf16 v[112:127], v[52:55], v[148:151], v[112:127]
    ds_read_b64_tr_b16 v[48:49], v8 offset:14336
    ds_read_b64_tr_b16 v[50:51], v8 offset:14848
    s_waitcnt lgkmcnt(8) vmcnt(9)
    v_mfma_f32_32x32x16_bf16 v[64:79], v[32:35], v[152:155], v[64:79]
    ds_read_b64_tr_b16 v[52:53], v9 offset:14336
    ds_read_b64_tr_b16 v[54:55], v9 offset:14848
    s_waitcnt lgkmcnt(8)
    v_mfma_f32_32x32x16_bf16 v[80:95], v[36:39], v[152:155], v[80:95]
    ds_read_b64_tr_b16 v[32:33], v10 offset:14336
    ds_read_b64_tr_b16 v[34:35], v10 offset:14848
    s_waitcnt lgkmcnt(8)
    v_mfma_f32_32x32x16_bf16 v[96:111], v[40:43], v[152:155], v[96:111]
    ds_read_b64_tr_b16 v[36:37], v11 offset:14336
    ds_read_b64_tr_b16 v[38:39], v11 offset:14848
    s_waitcnt lgkmcnt(8)
    v_mfma_f32_32x32x16_bf16 v[112:127], v[44:47], v[152:155], v[112:127]
    ds_read_b64_tr_b16 v[40:41], v8 offset:16384
    ds_read_b64_tr_b16 v[42:43], v8 offset:16896
    s_waitcnt lgkmcnt(8) vmcnt(8)
    v_mfma_f32_32x32x16_bf16 v[64:79], v[48:51], v[156:159], v[64:79]
    ds_read_b64_tr_b16 v[44:45], v9 offset:16384
    ds_read_b64_tr_b16 v[46:47], v9 offset:16896
    s_waitcnt lgkmcnt(8)
    v_mfma_f32_32x32x16_bf16 v[80:95], v[52:55], v[156:159], v[80:95]
    ds_read_b64_tr_b16 v[48:49], v10 offset:16384
    ds_read_b64_tr_b16 v[50:51], v10 offset:16896
    s_waitcnt lgkmcnt(8)
    v_mfma_f32_32x32x16_bf16 v[96:111], v[32:35], v[156:159], v[96:111]
    ds_read_b64_tr_b16 v[52:53], v11 offset:16384
    ds_read_b64_tr_b16 v[54:55], v11 offset:16896
    s_waitcnt lgkmcnt(8)
    v_mfma_f32_32x32x16_bf16 v[112:127], v[36:39], v[156:159], v[112:127]
    ds_read_b64_tr_b16 v[32:33], v8 offset:18432
    ds_read_b64_tr_b16 v[34:35], v8 offset:18944
    s_waitcnt lgkmcnt(8) vmcnt(7)
    v_mfma_f32_32x32x16_bf16 v[64:79], v[40:43], v[160:163], v[64:79]
    ds_read_b64_tr_b16 v[36:37], v9 offset:18432
    ds_read_b64_tr_b16 v[38:39], v9 offset:18944
    s_waitcnt lgkmcnt(8)
    v_mfma_f32_32x32x16_bf16 v[80:95], v[44:47], v[160:163], v[80:95]
    ds_read_b64_tr_b16 v[40:41], v10 offset:18432
    ds_read_b64_tr_b16 v[42:43], v10 offset:18944
    s_waitcnt lgkmcnt(8)
    v_mfma_f32_32x32x16_bf16 v[96:111], v[48:51], v[160:163], v[96:111]
    ds_read_b64_tr_b16 v[44:45], v11 offset:18432
    ds_read_b64_tr_b16 v[46:47], v11 offset:18944
    s_waitcnt lgkmcnt(8)
    v_mfma_f32_32x32x16_bf16 v[112:127], v[52:55], v[160:163], v[112:127]
    ds_read_b64_tr_b16 v[48:49], v8 offset:20480
    ds_read_b64_tr_b16 v[50:51], v8 offset:20992
    s_waitcnt lgkmcnt(8) vmcnt(6)
    v_mfma_f32_32x32x16_bf16 v[64:79], v[32:35], v[164:167], v[64:79]
    ds_read_b64_tr_b16 v[52:53], v9 offset:20480
    ds_read_b64_tr_b16 v[54:55], v9 offset:20992
    s_waitcnt lgkmcnt(8)
    v_mfma_f32_32x32x16_bf16 v[80:95], v[36:39], v[164:167], v[80:95]
    ds_read_b64_tr_b16 v[32:33], v10 offset:20480
    ds_read_b64_tr_b16 v[34:35], v10 offset:20992
    s_waitcnt lgkmcnt(8)
    v_mfma_f32_32x32x16_bf16 v[96:111], v[40:43], v[164:167], v[96:111]
    ds_read_b64_tr_b16 v[36:37], v11 offset:20480
    ds_read_b64_tr_b16 v[38:39], v11 offset:20992
    s_waitcnt lgkmcnt(8)
    v_mfma_f32_32x32x16_bf16 v[112:127], v[44:47], v[164:167], v[112:127]
    ds_read_b64_tr_b16 v[40:41], v8 offset:22528
    ds_read_b64_tr_b16 v[42:43], v8 offset:23040
    s_waitcnt lgkmcnt(8) vmcnt(5)
    v_mfma_f32_32x32x16_bf16 v[64:79], v[48:51], v[168:171], v[64:79]
    ds_read_b64_tr_b16 v[44:45], v9 offset:22528
    ds_read_b64_tr_b16 v[46:47], v9 offset:23040
    s_waitcnt lgkmcnt(8)
    v_mfma_f32_32x32x16_bf16 v[80:95], v[52:55], v[168:171], v[80:95]
    s_add_u32 s11, s11, 4096
    buffer_load_dwordx4 v[192:195], v3, s[20:23], s11 offen offset:0 sc1
    ds_read_b64_tr_b16 v[48:49], v10 offset:22528
    ds_read_b64_tr_b16 v[50:51], v10 offset:23040
    s_waitcnt lgkmcnt(8)
    v_mfma_f32_32x32x16_bf16 v[96:111], v[32:35], v[168:171], v[96:111]
    ds_read_b64_tr_b16 v[52:53], v11 offset:22528
    ds_read_b64_tr_b16 v[54:55], v11 offset:23040
    s_waitcnt lgkmcnt(8)
    v_mfma_f32_32x32x16_bf16 v[112:127], v[36:39], v[168:171], v[112:127]
    ds_read_b64_tr_b16 v[32:33], v8 offset:24576
    ds_read_b64_tr_b16 v[34:35], v8 offset:25088
    s_waitcnt lgkmcnt(8) vmcnt(5)
    v_mfma_f32_32x32x16_bf16 v[64:79], v[40:43], v[172:175], v[64:79]
    ds_read_b64_tr_b16 v[36:37], v9 offset:24576
    ds_read_b64_tr_b16 v[38:39], v9 offset:25088
    s_waitcnt lgkmcnt(8)
    v_mfma_f32_32x32x16_bf16 v[80:95], v[44:47], v[172:175], v[80:95]
    buffer_load_dwordx4 v[196:199], v3, s[20:23], s11 offen offset:1024 sc1
    ds_read_b64_tr_b16 v[40:41], v10 offset:24576
    ds_read_b64_tr_b16 v[42:43], v10 offset:25088
    s_waitcnt lgkmcnt(8)
    v_mfma_f32_32x32x16_bf16 v[96:111], v[48:51], v[172:175], v[96:111]
    ds_read_b64_tr_b16 v[44:45], v11 offset:24576
    ds_read_b64_tr_b16 v[46:47], v11 offset:25088
    s_waitcnt lgkmcnt(8)
    v_mfma_f32_32x32x16_bf16 v[112:127], v[52:55], v[172:175], v[112:127]
    ds_read_b64_tr_b16 v[48:49], v8 offset:26624
    ds_read_b64_tr_b16 v[50:51], v8 offset:27136
    s_waitcnt lgkmcnt(8) vmcnt(5)
    v_mfma_f32_32x32x16_bf16 v[64:79], v[32:35], v[176:179], v[64:79]
    ds_read_b64_tr_b16 v[52:53], v9 offset:26624
    ds_read_b64_tr_b16 v[54:55], v9 offset:27136
    s_waitcnt lgkmcnt(8)
    v_mfma_f32_32x32x16_bf16 v[80:95], v[36:39], v[176:179], v[80:95]
    buffer_load_dwordx4 v[200:203], v3, s[20:23], s11 offen offset:2048 sc1
    ds_read_b64_tr_b16 v[32:33], v10 offset:26624
    ds_read_b64_tr_b16 v[34:35], v10 offset:27136
    s_waitcnt lgkmcnt(8)
    v_mfma_f32_32x32x16_bf16 v[96:111], v[40:43], v[176:179], v[96:111]
    ds_read_b64_tr_b16 v[36:37], v11 offset:26624
    ds_read_b64_tr_b16 v[38:39], v11 offset:27136
    s_waitcnt lgkmcnt(8)
    v_mfma_f32_32x32x16_bf16 v[112:127], v[44:47], v[176:179], v[112:127]
    ds_read_b64_tr_b16 v[40:41], v8 offset:28672
    ds_read_b64_tr_b16 v[42:43], v8 offset:29184
    s_waitcnt lgkmcnt(8) vmcnt(5)
    v_mfma_f32_32x32x16_bf16 v[64:79], v[48:51], v[180:183], v[64:79]
    ds_read_b64_tr_b16 v[44:45], v9 offset:28672
    ds_read_b64_tr_b16 v[46:47], v9 offset:29184
    s_waitcnt lgkmcnt(8)
    v_mfma_f32_32x32x16_bf16 v[80:95], v[52:55], v[180:183], v[80:95]
    buffer_load_dwordx4 v[204:207], v3, s[20:23], s11 offen offset:3072 sc1
    ds_read_b64_tr_b16 v[48:49], v10 offset:28672
    ds_read_b64_tr_b16 v[50:51], v10 offset:29184
    s_waitcnt lgkmcnt(8)
    v_mfma_f32_32x32x16_bf16 v[96:111], v[32:35], v[180:183], v[96:111]
    ds_read_b64_tr_b16 v[52:53], v11 offset:28672
    ds_read_b64_tr_b16 v[54:55], v11 offset:29184
    s_waitcnt lgkmcnt(8)
    v_mfma_f32_32x32x16_bf16 v[112:127], v[36:39], v[180:183], v[112:127]
    ds_read_b64_tr_b16 v[32:33], v8 offset:30720
    ds_read_b64_tr_b16 v[34:35], v8 offset:31232
    s_waitcnt lgkmcnt(8) vmcnt(5)
    v_mfma_f32_32x32x16_bf16 v[64:79], v[40:43], v[184:187], v[64:79]
    ds_read_b64_tr_b16 v[36:37], v9 offset:30720
    ds_read_b64_tr_b16 v[38:39], v9 offset:31232
    s_waitcnt lgkmcnt(8)
    v_mfma_f32_32x32x16_bf16 v[80:95], v[44:47], v[184:187], v[80:95]
    s_add_u32 s11, s11, 4096
    buffer_load_dwordx4 v[208:211], v3, s[20:23], s11 offen offset:0 sc1
    ds_read_b64_tr_b16 v[40:41], v10 offset:30720
    ds_read_b64_tr_b16 v[42:43], v10 offset:31232
    s_waitcnt lgkmcnt(8)
    v_mfma_f32_32x32x16_bf16 v[96:111], v[48:51], v[184:187], v[96:111]
    ds_read_b64_tr_b16 v[44:45], v11 offset:30720
    ds_read_b64_tr_b16 v[46:47], v11 offset:31232
    s_waitcnt lgkmcnt(8)
    v_mfma_f32_32x32x16_bf16 v[112:127], v[52:55], v[184:187], v[112:127]
    ds_read_b64_tr_b16 v[48:49], v8 offset:32768
    ds_read_b64_tr_b16 v[50:51], v8 offset:33280
    s_waitcnt lgkmcnt(8) vmcnt(5)
    v_mfma_f32_32x32x16_bf16 v[64:79], v[32:35], v[188:191], v[64:79]
    ds_read_b64_tr_b16 v[52:53], v8 offset:34816
    ds_read_b64_tr_b16 v[54:55], v8 offset:35328
    s_waitcnt lgkmcnt(8)
    v_mfma_f32_32x32x16_bf16 v[80:95], v[36:39], v[188:191], v[80:95]
    buffer_load_dwordx4 v[212:215], v3, s[20:23], s11 offen offset:1024 sc1
    ds_read_b64_tr_b16 v[32:33], v8 offset:36864
    ds_read_b64_tr_b16 v[34:35], v8 offset:37376
    s_waitcnt lgkmcnt(8)
    v_mfma_f32_32x32x16_bf16 v[96:111], v[40:43], v[188:191], v[96:111]
    ds_read_b64_tr_b16 v[36:37], v8 offset:38912
    ds_read_b64_tr_b16 v[38:39], v8 offset:39424
    s_waitcnt lgkmcnt(8)
    v_mfma_f32_32x32x16_bf16 v[112:127], v[44:47], v[188:191], v[112:127]
    buffer_load_dwordx4 v[216:219], v3, s[20:23], s11 offen offset:2048 sc1
    buffer_load_dwordx4 v[220:223], v3, s[20:23], s11 offen offset:3072 sc1
    s_add_u32 s11, s11, 4096
    buffer_load_dwordx4 v[224:227], v3, s[20:23], s11 offen offset:0 sc1
    buffer_load_dwordx4 v[228:231], v3, s[20:23], s11 offen offset:1024 sc1
    buffer_load_dwordx4 v[232:235], v3, s[20:23], s11 offen offset:2048 sc1
    buffer_load_dwordx4 v[236:239], v3, s[20:23], s11 offen offset:3072 sc1
    s_add_u32 s11, s11, 4096
    buffer_load_dwordx4 v[240:243], v3, s[20:23], s11 offen offset:0 sc1
    buffer_load_dwordx4 v[244:247], v3, s[20:23], s11 offen offset:1024 sc1
    buffer_load_dwordx4 v[248:251], v3, s[20:23], s11 offen offset:2048 sc1
    buffer_load_dwordx4 v[252:255], v3, s[20:23], s11 offen offset:3072 sc1
    s_branch M_F1J
M_F1Y:
    s_waitcnt lgkmcnt(0)
    s_barrier
    s_barrier
    buffer_load_dwordx4 v[128:131], v3, s[20:23], s11 offen offset:0 sc1
    buffer_load_dwordx4 v[132:135], v3, s[20:23], s11 offen offset:1024 sc1
    buffer_load_dwordx4 v[136:139], v3, s[20:23], s11 offen offset:2048 sc1
    buffer_load_dwordx4 v[140:143], v3, s[20:23], s11 offen offset:3072 sc1
    s_add_u32 s11, s11, 4096
    buffer_load_dwordx4 v[144:147], v3, s[20:23], s11 offen offset:0 sc1
    buffer_load_dwordx4 v[148:151], v3, s[20:23], s11 offen offset:1024 sc1
    buffer_load_dwordx4 v[152:155], v3, s[20:23], s11 offen offset:2048 sc1
    buffer_load_dwordx4 v[156:159], v3, s[20:23], s11 offen offset:3072 sc1
    s_add_u32 s11, s11, 4096
    buffer_load_dwordx4 v[160:163], v3, s[20:23], s11 offen offset:0 sc1
    buffer_load_dwordx4 v[164:167], v3, s[20:23], s11 offen offset:1024 sc1
    buffer_load_dwordx4 v[168:171], v3, s[20:23], s11 offen offset:2048 sc1
    buffer_load_dwordx4 v[172:175], v3, s[20:23], s11 offen offset:3072 sc1
    s_add_u32 s11, s11, 4096
    buffer_load_dwordx4 v[176:179], v3, s[20:23], s11 offen offset:0 sc1
    buffer_load_dwordx4 v[180:183], v3, s[20:23], s11 offen offset:1024 sc1
    buffer_load_dwordx4 v[184:187], v3, s[20:23], s11 offen offset:2048 sc1
    buffer_load_dwordx4 v[188:191], v3, s[20:23], s11 offen offset:3072 sc1
    ds_read_b64_tr_b16 v[32:33], v8 offset:0
    ds_read_b64_tr_b16 v[34:35], v8 offset:512
    ds_read_b64_tr_b16 v[36:37], v9 offset:0
    ds_read_b64_tr_b16 v[38:39], v9 offset:512
    ds_read_b64_tr_b16 v[40:41], v10 offset:0
    ds_read_b64_tr_b16 v[42:43], v10 offset:512
    ds_read_b64_tr_b16 v[44:45], v11 offset:0
    ds_read_b64_tr_b16 v[46:47], v11 offset:512
    ds_read_b64_tr_b16 v[48:49], v8 offset:2048
    ds_read_b64_tr_b16 v[50:51], v8 offset:2560
    s_waitcnt lgkmcnt(8) vmcnt(15)
    v_mfma_f32_32x32x16_bf16 v[64:79], v[32:35], v[128:131], 0
    ds_read_b64_tr_b16 v[52:53], v9 offset:2048
    ds_read_b64_tr_b16 v[54:55], v9 offset:2560
    s_waitcnt lgkmcnt(8)
    v_mfma_f32_32x32x16_bf16 v[80:95], v[36:39], v[128:131], 0
    ds_read_b64_tr_b16 v[32:33], v10 offset:2048
    ds_read_b64_tr_b16 v[34:35], v10 offset:2560
    s_waitcnt lgkmcnt(8)
    v_mfma_f32_32x32x16_bf16 v[96:111], v[40:43], v[128:131], 0
    ds_read_b64_tr_b16 v[36:37], v11 offset:2048
    ds_read_b64_tr_b16 v[38:39], v11 offset:2560
    s_waitcnt lgkmcnt(8)
    v_mfma_f32_32x32x16_bf16 v[112:127], v[44:47], v[128:131], 0
    ds_read_b64_tr_b16 v[40:41], v8 offset:4096
    ds_read_b64_tr_b16 v[42:43], v8 offset:4608
    s_waitcnt lgkmcnt(8) vmcnt(14)
    v_mfma_f32_32x32x16_bf16 v[64:79], v[48:51], v[132:135], v[64:79]
    ds_read_b64_tr_b16 v[44:45], v9 offset:4096
    ds_read_b64_tr_b16 v[46:47], v9 offset:4608
    s_waitcnt lgkmcnt(8)
    v_mfma_f32_32x32x16_bf16 v[80:95], v[52:55], v[132:135], v[80:95]
    ds_read_b64_tr_b16 v[48:49], v10 offset:4096
    ds_read_b64_tr_b16 v[50:51], v10 offset:4608
    s_waitcnt lgkmcnt(8)
    v_mfma_f32_32x32x16_bf16 v[96:111], v[32:35], v[132:135], v[96:111]
    ds_read_b64_tr_b16 v[52:53], v11 offset:4096
    ds_read_b64_tr_b16 v[54:55], v11 offset:4608
    s_waitcnt lgkmcnt(8)
    v_mfma_f32_32x32x16_bf16 v[112:127], v[36:39], v[132:135], v[112:127]
    ds_read_b64_tr_b16 v[32:33], v8 offset:6144
    ds_read_b64_tr_b16 v[34:35], v8 offset:6656
    s_waitcnt lgkmcnt(8) vmcnt(13)
    v_mfma_f32_32x32x16_bf16 v[64:79], v[40:43], v[136:139], v[64:79]
    ds_read_b64_tr_b16 v[36:37], v9 offset:6144
    ds_read_b64_tr_b16 v[38:39], v9 offset:6656
    s_waitcnt lgkmcnt(8)
    v_mfma_f32_32x32x16_bf16 v[80:95], v[44:47], v[136:139], v[80:95]
    ds_read_b64_tr_b16 v[40:41], v10 offset:6144
    ds_read_b64_tr_b16 v[42:43], v10 offset:6656
    s_waitcnt lgkmcnt(8)
    v_mfma_f32_32x32x16_bf16 v[96:111], v[48:51], v[136:139], v[96:111]
    ds_read_b64_tr_b16 v[44:45], v11 offset:6144
    ds_read_b64_tr_b16 v[46:47], v11 offset:6656
    s_waitcnt lgkmcnt(8)
    v_mfma_f32_32x32x16_bf16 v[112:127], v[52:55], v[136:139], v[112:127]
    ds_read_b64_tr_b16 v[48:49], v8 offset:8192
    ds_read_b64_tr_b16 v[50:51], v8 offset:8704
    s_waitcnt lgkmcnt(8) vmcnt(12)
    v_mfma_f32_32x32x16_bf16 v[64:79], v[32:35], v[140:143], v[64:79]
    ds_read_b64_tr_b16 v[52:53], v9 offset:8192
    ds_read_b64_tr_b16 v[54:55], v9 offset:8704
    s_waitcnt lgkmcnt(8)
    v_mfma_f32_32x32x16_bf16 v[80:95], v[36:39], v[140:143], v[80:95]
    ds_read_b64_tr_b16 v[32:33], v10 offset:8192
    ds_read_b64_tr_b16 v[34:35], v10 offset:8704
    s_waitcnt lgkmcnt(8)
    v_mfma_f32_32x32x16_bf16 v[96:111], v[40:43], v[140:143], v[96:111]
    ds_read_b64_tr_b16 v[36:37], v11 offset:8192
    ds_read_b64_tr_b16 v[38:39], v11 offset:8704
    s_waitcnt lgkmcnt(8)
    v_mfma_f32_32x32x16_bf16 v[112:127], v[44:47], v[140:143], v[112:127]
    ds_read_b64_tr_b16 v[40:41], v8 offset:10240
    ds_read_b64_tr_b16 v[42:43], v8 offset:10752
    s_waitcnt lgkmcnt(8) vmcnt(11)
    v_mfma_f32_32x32x16_bf16 v[64:79], v[48:51], v[144:147], v[64:79]
    ds_read_b64_tr_b16 v[44:45], v9 offset:10240
    ds_read_b64_tr_b16 v[46:47], v9 offset:10752
    s_waitcnt lgkmcnt(8)
    v_mfma_f32_32x32x16_bf16 v[80:95], v[52:55], v[144:147], v[80:95]
    ds_read_b64_tr_b16 v[48:49], v10 offset:10240
    ds_read_b64_tr_b16 v[50:51], v10 offset:10752
    s_waitcnt lgkmcnt(8)
    v_mfma_f32_32x32x16_bf16 v[96:111], v[32:35], v[144:147], v[96:111]
    ds_read_b64_tr_b16 v[52:53], v11 offset:10240
    ds_read_b64_tr_b16 v[54:55], v11 offset:10752
    s_waitcnt lgkmcnt(8)
    v_mfma_f32_32x32x16_bf16 v[112:127], v[36:39], v[144:147], v[112:127]
    ds_read_b64_tr_b16 v[32:33], v8 offset:12288
    ds_read_b64_tr_b16 v[34:35], v8 offset:12800
    s_waitcnt lgkmcnt(8) vmcnt(10)
    v_mfma_f32_32x32x16_bf16 v[64:79], v[40:43], v[148:151], v[64:79]
    ds_read_b64_tr_b16 v[36:37], v9 offset:12288
    ds_read_b64_tr_b16 v[38:39], v9 offset:12800
    s_waitcnt lgkmcnt(8)
    v_mfma_f32_32x32x16_bf16 v[80:95], v[44:47], v[148:151], v[80:95]
    ds_read_b64_tr_b16 v[40:41], v10 offset:12288
    ds_read_b64_tr_b16 v[42:43], v10 offset:12800
    s_waitcnt lgkmcnt(8)
    v_mfma_f32_32x32x16_bf16 v[96:111], v[48:51], v[148:151], v[96:111]
    ds_read_b64_tr_b16 v[44:45], v11 offset:12288
    ds_read_b64_tr_b16 v[46:47], v11 offset:12800
    s_waitcnt lgkmcnt(8)
    v_mfma_f32_32x32x16_bf16 v[112:127], v[52:55], v[148:151], v[112:127]
    ds_read_b64_tr_b16 v[48:49], v8 offset:14336
    ds_read_b64_tr_b16 v[50:51], v8 offset:14848
    s_waitcnt lgkmcnt(8) vmcnt(9)
    v_mfma_f32_32x32x16_bf16 v[64:79], v[32:35], v[152:155], v[64:79]
    ds_read_b64_tr_b16 v[52:53], v9 offset:14336
    ds_read_b64_tr_b16 v[54:55], v9 offset:14848
    s_waitcnt lgkmcnt(8)
    v_mfma_f32_32x32x16_bf16 v[80:95], v[36:39], v[152:155], v[80:95]
    ds_read_b64_tr_b16 v[32:33], v10 offset:14336
    ds_read_b64_tr_b16 v[34:35], v10 offset:14848
    s_waitcnt lgkmcnt(8)
    v_mfma_f32_32x32x16_bf16 v[96:111], v[40:43], v[152:155], v[96:111]
    ds_read_b64_tr_b16 v[36:37], v11 offset:14336
    ds_read_b64_tr_b16 v[38:39], v11 offset:14848
    s_waitcnt lgkmcnt(8)
    v_mfma_f32_32x32x16_bf16 v[112:127], v[44:47], v[152:155], v[112:127]
    ds_read_b64_tr_b16 v[40:41], v8 offset:16384
    ds_read_b64_tr_b16 v[42:43], v8 offset:16896
    s_waitcnt lgkmcnt(8) vmcnt(8)
    v_mfma_f32_32x32x16_bf16 v[64:79], v[48:51], v[156:159], v[64:79]
    ds_read_b64_tr_b16 v[44:45], v9 offset:16384
    ds_read_b64_tr_b16 v[46:47], v9 offset:16896
    s_waitcnt lgkmcnt(8)
    v_mfma_f32_32x32x16_bf16 v[80:95], v[52:55], v[156:159], v[80:95]
    ds_read_b64_tr_b16 v[48:49], v10 offset:16384
    ds_read_b64_tr_b16 v[50:51], v10 offset:16896
    s_waitcnt lgkmcnt(8)
    v_mfma_f32_32x32x16_bf16 v[96:111], v[32:35], v[156:159], v[96:111]
    ds_read_b64_tr_b16 v[52:53], v11 offset:16384
    ds_read_b64_tr_b16 v[54:55], v11 offset:16896
    s_waitcnt lgkmcnt(8)
    v_mfma_f32_32x32x16_bf16 v[112:127], v[36:39], v[156:159], v[112:127]
    s_add_u32 s11, s11, 4096
    buffer_load_dwordx4 v[192:195], v3, s[20:23], s11 offen offset:0 sc1
    ds_read_b64_tr_b16 v[32:33], v8 offset:18432
    ds_read_b64_tr_b16 v[34:35], v8 offset:18944
    s_waitcnt lgkmcnt(8) vmcnt(8)
    v_mfma_f32_32x32x16_bf16 v[64:79], v[40:43], v[160:163], v[64:79]
    ds_read_b64_tr_b16 v[36:37], v9 offset:18432
    ds_read_b64_tr_b16 v[38:39], v9 offset:18944
    s_waitcnt lgkmcnt(8)
    v_mfma_f32_32x32x16_bf16 v[80:95], v[44:47], v[160:163], v[80:95]
    buffer_load_dwordx4 v[196:199], v3, s[20:23], s11 offen offset:1024 sc1
    ds_read_b64_tr_b16 v[40:41], v10 offset:18432
    ds_read_b64_tr_b16 v[42:43], v10 offset:18944
    s_waitcnt lgkmcnt(8)
    v_mfma_f32_32x32x16_bf16 v[96:111], v[48:51], v[160:163], v[96:111]
    ds_read_b64_tr_b16 v[44:45], v11 offset:18432
    ds_read_b64_tr_b16 v[46:47], v11 offset:18944
    s_waitcnt lgkmcnt(8)
    v_mfma_f32_32x32x16_bf16 v[112:127], v[52:55], v[160:163], v[112:127]
    buffer_load_dwordx4 v[200:203], v3, s[20:23], s11 offen offset:2048 sc1
    ds_read_b64_tr_b16 v[48:49], v8 offset:20480
    ds_read_b64_tr_b16 v[50:51], v8 offset:20992
    s_waitcnt lgkmcnt(8) vmcnt(9)
    v_mfma_f32_32x32x16_bf16 v[64:79], v[32:35], v[164:167], v[64:79]
    ds_read_b64_tr_b16 v[52:53], v9 offset:20480
    ds_read_b64_tr_b16 v[54:55], v9 offset:20992
    s_waitcnt lgkmcnt(8)
    v_mfma_f32_32x32x16_bf16 v[80:95], v[36:39], v[164:167], v[80:95]
    buffer_load_dwordx4 v[204:207], v3, s[20:23], s11 offen offset:3072 sc1
    ds_read_b64_tr_b16 v[32:33], v10 offset:20480
    ds_read_b64_tr_b16 v[34:35], v10 offset:20992
    s_waitcnt lgkmcnt(8)
    v_mfma_f32_32x32x16_bf16 v[96:111], v[40:43], v[164:167], v[96:111]
    ds_read_b64_tr_b16 v[36:37], v11 offset:20480
    ds_read_b64_tr_b16 v[38:39], v11 offset:20992
    s_waitcnt lgkmcnt(8)
    v_mfma_f32_32x32x16_bf16 v[112:127], v[44:47], v[164:167], v[112:127]
    s_add_u32 s11, s11, 4096
    buffer_load_dwordx4 v[208:211], v3, s[20:23], s11 offen offset:0 sc1
    ds_read_b64_tr_b16 v[40:41], v8 offset:22528
    ds_read_b64_tr_b16 v[42:43], v8 offset:23040
    s_waitcnt lgkmcnt(8) vmcnt(10)
    v_mfma_f32_32x32x16_bf16 v[64:79], v[48:51], v[168:171], v[64:79]
    ds_read_b64_tr_b16 v[44:45], v9 offset:22528
    ds_read_b64_tr_b16 v[46:47], v9 offset:23040
    s_waitcnt lgkmcnt(8)
    v_mfma_f32_32x32x16_bf16 v[80:95], v[52:55], v[168:171], v[80:95]
    buffer_load_dwordx4 v[212:215], v3, s[20:23], s11 offen offset:1024 sc1
    ds_read_b64_tr_b16 v[48:49], v10 offset:22528
    ds_read_b64_tr_b16 v[50:51], v10 offset:23040
    s_waitcnt lgkmcnt(8)
    v_mfma_f32_32x32x16_bf16 v[96:111], v[32:35], v[168:171], v[96:111]
    ds_read_b64_tr_b16 v[52:53], v11 offset:22528
    ds_read_b64_tr_b16 v[54:55], v11 offset:23040
    s_waitcnt lgkmcnt(8)
    v_mfma_f32_32x32x16_bf16 v[112:127], v[36:39], v[168:171], v[112:127]
    buffer_load_dwordx4 v[216:219], v3, s[20:23], s11 offen offset:2048 sc1
    ds_read_b64_tr_b16 v[32:33], v8 offset:24576
    ds_read_b64_tr_b16 v[34:35], v8 offset:25088
    s_waitcnt lgkmcnt(8) vmcnt(11)
    v_mfma_f32_32x32x16_bf16 v[64:79], v[40:43], v[172:175], v[64:79]
    ds_read_b64_tr_b16 v[36:37], v9 offset:24576
    ds_read_b64_tr_b16 v[38:39], v9 offset:25088
    s_waitcnt lgkmcnt(8)
    v_mfma_f32_32x32x16_bf16 v[80:95], v[44:47], v[172:175], v[80:95]
    buffer_load_dwordx4 v[220:223], v3, s[20:23], s11 offen offset:3072 sc1
    ds_read_b64_tr_b16 v[40:41], v10 offset:24576
    ds_read_b64_tr_b16 v[42:43], v10 offset:25088
    s_waitcnt lgkmcnt(8)
    v_mfma_f32_32x32x16_bf16 v[96:111], v[48:51], v[172:175], v[96:111]
    ds_read_b64_tr_b16 v[44:45], v11 offset:24576
    ds_read_b64_tr_b16 v[46:47], v11 offset:25088
    s_waitcnt lgkmcnt(8)
    v_mfma_f32_32x32x16_bf16 v[112:127], v[52:55], v[172:175], v[112:127]
    s_add_u32 s11, s11, 4096
    buffer_load_dwordx4 v[224:227], v3, s[20:23], s11 offen offset:0 sc1
    ds_read_b64_tr_b16 v[48:49], v8 offset:26624
    ds_read_b64_tr_b16 v[50:51], v8 offset:27136
    s_waitcnt lgkmcnt(8) vmcnt(12)
    v_mfma_f32_32x32x16_bf16 v[64:79], v[32:35], v[176:179], v[64:79]
    ds_read_b64_tr_b16 v[52:53], v9 offset:26624
    ds_read_b64_tr_b16 v[54:55], v9 offset:27136
    s_waitcnt lgkmcnt(8)
    v_mfma_f32_32x32x16_bf16 v[80:95], v[36:39], v[176:179], v[80:95]
    buffer_load_dwordx4 v[228:231], v3, s[20:23], s11 offen offset:1024 sc1
    ds_read_b64_tr_b16 v[32:33], v10 offset:26624
    ds_read_b64_tr_b16 v[34:35], v10 offset:27136
    s_waitcnt lgkmcnt(8)
    v_mfma_f32_32x32x16_bf16 v[96:111], v[40:43], v[176:179], v[96:111]
    ds_read_b64_tr_b16 v[36:37], v11 offset:26624
    ds_read_b64_tr_b16 v[38:39], v11 offset:27136
    s_waitcnt lgkmcnt(8)
    v_mfma_f32_32x32x16_bf16 v[112:127], v[44:47], v[176:179], v[112:127]
    buffer_load_dwordx4 v[232:235], v3, s[20:23], s11 offen offset:2048 sc1
    ds_read_b64_tr_b16 v[40:41], v8 offset:28672
    ds_read_b64_tr_b16 v[42:43], v8 offset:29184
    s_waitcnt lgkmcnt(8) vmcnt(13)
    v_mfma_f32_32x32x16_bf16 v[64:79], v[48:51], v[180:183], v[64:79]
    ds_read_b64_tr_b16 v[44:45], v9 offset:28672
    ds_read_b64_tr_b16 v[46:47], v9 offset:29184
    s_waitcnt lgkmcnt(8)
    v_mfma_f32_32x32x16_bf16 v[80:95], v[52:55], v[180:183], v[80:95]
    buffer_load_dwordx4 v[236:239], v3, s[20:23], s11 offen offset:3072 sc1
    ds_read_b64_tr_b16 v[48:49], v10 offset:28672
    ds_read_b64_tr_b16 v[50:51], v10 offset:29184
    s_waitcnt lgkmcnt(8)
    v_mfma_f32_32x32x16_bf16 v[96:111], v[32:35], v[180:183], v[96:111]
    ds_read_b64_tr_b16 v[52:53], v11 offset:28672
    ds_read_b64_tr_b16 v[54:55], v11 offset:29184
    s_waitcnt lgkmcnt(8)
    v_mfma_f32_32x32x16_bf16 v[112:127], v[36:39], v[180:183], v[112:127]
    s_add_u32 s11, s11, 4096
    buffer_load_dwordx4 v[240:243], v3, s[20:23], s11 offen offset:0 sc1
    ds_read_b64_tr_b16 v[32:33], v8 offset:30720
    ds_read_b64_tr_b16 v[34:35], v8 offset:31232
    s_waitcnt lgkmcnt(8) vmcnt(14)
    v_mfma_f32_32x32x16_bf16 v[64:79], v[40:43], v[184:187], v[64:79]
    ds_read_b64_tr_b16 v[36:37], v9 offset:30720
    ds_read_b64_tr_b16 v[38:39], v9 offset:31232
    s_waitcnt lgkmcnt(8)
    v_mfma_f32_32x32x16_bf16 v[80:95], v[44:47], v[184:187], v[80:95]
    buffer_load_dwordx4 v[244:247], v3, s[20:23], s11 offen offset:1024 sc1
    ds_read_b64_tr_b16 v[40:41], v10 offset:30720
    ds_read_b64_tr_b16 v[42:43], v10 offset:31232
    s_waitcnt lgkmcnt(8)
    v_mfma_f32_32x32x16_bf16 v[96:111], v[48:51], v[184:187], v[96:111]
    ds_read_b64_tr_b16 v[44:45], v11 offset:30720
    ds_read_b64_tr_b16 v[46:47], v11 offset:31232
    s_waitcnt lgkmcnt(8)
    v_mfma_f32_32x32x16_bf16 v[112:127], v[52:55], v[184:187], v[112:127]
    buffer_load_dwordx4 v[248:251], v3, s[20:23], s11 offen offset:2048 sc1
    ds_read_b64_tr_b16 v[48:49], v8 offset:32768
    ds_read_b64_tr_b16 v[50:51], v8 offset:33280
    s_waitcnt lgkmcnt(8) vmcnt(15)
    v_mfma_f32_32x32x16_bf16 v[64:79], v[32:35], v[188:191], v[64:79]
    ds_read_b64_tr_b16 v[52:53], v8 offset:34816
    ds_read_b64_tr_b16 v[54:55], v8 offset:35328
    s_waitcnt lgkmcnt(8)
    v_mfma_f32_32x32x16_bf16 v[80:95], v[36:39], v[188:191], v[80:95]
    buffer_load_dwordx4 v[252:255], v3, s[20:23], s11 offen offset:3072 sc1
    ds_read_b64_tr_b16 v[32:33], v8 offset:36864
    ds_read_b64_tr_b16 v[34:35], v8 offset:37376
    s_waitcnt lgkmcnt(8)
    v_mfma_f32_32x32x16_bf16 v[96:111], v[40:43], v[188:191], v[96:111]
    ds_read_b64_tr_b16 v[36:37], v8 offset:38912
    ds_read_b64_tr_b16 v[38:39], v8 offset:39424
    s_waitcnt lgkmcnt(8)
    v_mfma_f32_32x32x16_bf16 v[112:127], v[44:47], v[188:191], v[112:127]
M_F1J:
    s_barrier
    ds_read_b64_tr_b16 v[40:41], v8 offset:40960
    ds_read_b64_tr_b16 v[42:43], v8 offset:41472
    s_waitcnt lgkmcnt(8) vmcnt(15)
    v_mfma_f32_32x32x16_bf16 v[64:79], v[48:51], v[192:195], v[64:79]
    ds_read_b64_tr_b16 v[44:45], v8 offset:43008
    ds_read_b64_tr_b16 v[46:47], v8 offset:43520
    s_waitcnt lgkmcnt(8) vmcnt(14)
    v_mfma_f32_32x32x16_bf16 v[64:79], v[52:55], v[196:199], v[64:79]
    ds_read_b64_tr_b16 v[48:49], v8 offset:45056
    ds_read_b64_tr_b16 v[50:51], v8 offset:45568
    s_waitcnt lgkmcnt(8) vmcnt(13)
    v_mfma_f32_32x32x16_bf16 v[64:79], v[32:35], v[200:203], v[64:79]
    ds_read_b64_tr_b16 v[52:53], v8 offset:47104
    ds_read_b64_tr_b16 v[54:55], v8 offset:47616
    s_waitcnt lgkmcnt(8) vmcnt(12)
    v_mfma_f32_32x32x16_bf16 v[64:79], v[36:39], v[204:207], v[64:79]
    ds_read_b64_tr_b16 v[32:33], v8 offset:49152
    ds_read_b64_tr_b16 v[34:35], v8 offset:49664
    s_waitcnt lgkmcnt(8) vmcnt(11)
    v_mfma_f32_32x32x16_bf16 v[64:79], v[40:43], v[208:211], v[64:79]
    ds_read_b64_tr_b16 v[36:37], v8 offset:51200
    ds_read_b64_tr_b16 v[38:39], v8 offset:51712
    s_waitcnt lgkmcnt(8) vmcnt(10)
    v_mfma_f32_32x32x16_bf16 v[64:79], v[44:47], v[212:215], v[64:79]
    ds_read_b64_tr_b16 v[40:41], v8 offset:53248
    ds_read_b64_tr_b16 v[42:43], v8 offset:53760
    s_waitcnt lgkmcnt(8) vmcnt(9)
    v_mfma_f32_32x32x16_bf16 v[64:79], v[48:51], v[216:219], v[64:79]
    s_lshl_b32 s18, s13, 2
    s_lshl_b32 s18, s18, 14
    s_add_u32 s18, s18, s10
    s_add_u32 s16, s41, 131072
    s_mov_b32 m0, s16
    s_nop 0
    buffer_load_dwordx4 v14, s[72:75], s18 offen lds
    ds_read_b64_tr_b16 v[44:45], v8 offset:55296
    ds_read_b64_tr_b16 v[46:47], v8 offset:55808
    s_waitcnt lgkmcnt(8) vmcnt(9)
    v_mfma_f32_32x32x16_bf16 v[64:79], v[52:55], v[220:223], v[64:79]
    ds_read_b64_tr_b16 v[48:49], v8 offset:57344
    ds_read_b64_tr_b16 v[50:51], v8 offset:57856
    s_waitcnt lgkmcnt(8) vmcnt(8)
    v_mfma_f32_32x32x16_bf16 v[64:79], v[32:35], v[224:227], v[64:79]
    ds_read_b64_tr_b16 v[52:53], v8 offset:59392
    ds_read_b64_tr_b16 v[54:55], v8 offset:59904
    s_waitcnt lgkmcnt(8) vmcnt(7)
    v_mfma_f32_32x32x16_bf16 v[64:79], v[36:39], v[228:231], v[64:79]
    s_add_u32 s16, s41, 132096
    s_mov_b32 m0, s16
    s_add_u32 s18, s18, 0x2000
    buffer_load_dwordx4 v14, s[72:75], s18 offen lds
    s_add_u32 s13, s13, 8
    s_sub_u32 s38, s13, 28
    s_cmp_ge_u32 s13, 28
    s_cselect_b32 s13, s38, s13
    ds_read_b64_tr_b16 v[32:33], v8 offset:61440
    ds_read_b64_tr_b16 v[34:35], v8 offset:61952
    s_waitcnt lgkmcnt(8) vmcnt(7)
    v_mfma_f32_32x32x16_bf16 v[64:79], v[40:43], v[232:235], v[64:79]
    ds_read_b64_tr_b16 v[36:37], v8 offset:63488
    ds_read_b64_tr_b16 v[38:39], v8 offset:64000
    s_waitcnt lgkmcnt(8) vmcnt(6)
    v_mfma_f32_32x32x16_bf16 v[64:79], v[44:47], v[236:239], v[64:79]
    ds_read_b64_tr_b16 v[40:41], v9 offset:32768
    ds_read_b64_tr_b16 v[42:43], v9 offset:33280
    s_waitcnt lgkmcnt(8) vmcnt(5)
    v_mfma_f32_32x32x16_bf16 v[64:79], v[48:51], v[240:243], v[64:79]
    s_lshl_b32 s18, s13, 2
    s_lshl_b32 s18, s18, 14
    s_add_u32 s18, s18, s10
    s_add_u32 s16, s41, 147456
    s_mov_b32 m0, s16
    s_nop 0
    buffer_load_dwordx4 v14, s[72:75], s18 offen lds
    ds_read_b64_tr_b16 v[44:45], v9 offset:34816
    ds_read_b64_tr_b16 v[46:47], v9 offset:35328
    s_waitcnt lgkmcnt(8) vmcnt(5)
    v_mfma_f32_32x32x16_bf16 v[64:79], v[52:55], v[244:247], v[64:79]
    ds_read_b64_tr_b16 v[48:49], v9 offset:36864
    ds_read_b64_tr_b16 v[50:51], v9 offset:37376
    s_waitcnt lgkmcnt(8) vmcnt(4)
    v_mfma_f32_32x32x16_bf16 v[64:79], v[32:35], v[248:251], v[64:79]
    ds_read_b64_tr_b16 v[52:53], v9 offset:38912
    ds_read_b64_tr_b16 v[54:55], v9 offset:39424
    s_waitcnt lgkmcnt(8) vmcnt(3)
    v_mfma_f32_32x32x16_bf16 v[64:79], v[36:39], v[252:255], v[64:79]
    s_add_u32 s16, s41, 148480
    s_mov_b32 m0, s16
    s_add_u32 s18, s18, 0x2000
    buffer_load_dwordx4 v14, s[72:75], s18 offen lds
    s_add_u32 s13, s13, 8
    s_sub_u32 s38, s13, 28
    s_cmp_ge_u32 s13, 28
    s_cselect_b32 s13, s38, s13
    s_nop 3
    v_mul_f32 v16, v64, v64
    v_mul_f32 v17, v65, v65
    v_mul_f32 v18, v66, v66
    v_mul_f32 v19, v67, v67
    v_mul_f32 v20, v68, v68
    v_mul_f32 v21, v69, v69
    v_mul_f32 v22, v70, v70
    v_mul_f32 v23, v71, v71
    v_fmaak_f32 v16, v16, v15, 0xc0135761
    v_fmaak_f32 v17, v17, v15, 0xc0135761
    v_fmaak_f32 v18, v18, v15, 0xc0135761
    v_fmaak_f32 v19, v19, v15, 0xc0135761
    v_fmaak_f32 v20, v20, v15, 0xc0135761
    v_fmaak_f32 v21, v21, v15, 0xc0135761
    v_fmaak_f32 v22, v22, v15, 0xc0135761
    v_fmaak_f32 v23, v23, v15, 0xc0135761
    v_mul_f32 v16, v16, v64
    v_mul_f32 v17, v17, v65
    v_mul_f32 v18, v18, v66
    v_mul_f32 v19, v19, v67
    v_mul_f32 v20, v20, v68
    v_mul_f32 v21, v21, v69
    v_mul_f32 v22, v22, v70
    v_mul_f32 v23, v23, v71
    v_exp_f32 v16, v16
    v_exp_f32 v17, v17
    v_exp_f32 v18, v18
    v_exp_f32 v19, v19
    v_exp_f32 v20, v20
    v_exp_f32 v21, v21
    v_exp_f32 v22, v22
    v_exp_f32 v23, v23
    v_mul_f32 v64, v64, v72
    v_mul_f32 v65, v65, v73
    v_mul_f32 v66, v66, v74
    v_mul_f32 v67, v67, v75
    v_mul_f32 v68, v68, v76
    v_mul_f32 v69, v69, v77
    v_mul_f32 v70, v70, v78
    v_mul_f32 v71, v71, v79
    v_add_f32 v16, 1.0, v16
    v_add_f32 v17, 1.0, v17
    v_add_f32 v18, 1.0, v18
    v_add_f32 v19, 1.0, v19
    v_add_f32 v20, 1.0, v20
    v_add_f32 v21, 1.0, v21
    v_add_f32 v22, 1.0, v22
    v_add_f32 v23, 1.0, v23
    v_rcp_f32 v16, v16
    v_rcp_f32 v17, v17
    v_rcp_f32 v18, v18
    v_rcp_f32 v19, v19
    v_rcp_f32 v20, v20
    v_rcp_f32 v21, v21
    v_rcp_f32 v22, v22
    v_rcp_f32 v23, v23
    v_mul_f32 v64, v64, v16
    v_mul_f32 v65, v65, v17
    v_mul_f32 v66, v66, v18
    v_mul_f32 v67, v67, v19
    v_mul_f32 v68, v68, v20
    v_mul_f32 v69, v69, v21
    v_mul_f32 v70, v70, v22
    v_mul_f32 v71, v71, v23
    v_cvt_pk_bf16_f32 v24, v64, v65
    v_cvt_pk_bf16_f32 v25, v66, v67
    v_cvt_pk_bf16_f32 v26, v68, v69
    v_cvt_pk_bf16_f32 v27, v70, v71
    buffer_store_dwordx4 v[24:27], v3, s[20:23], s14 offen offset:0 sc0 sc1
    ds_read_b64_tr_b16 v[32:33], v9 offset:40960
    ds_read_b64_tr_b16 v[34:35], v9 offset:41472
    s_waitcnt lgkmcnt(8)
    v_mfma_f32_32x32x16_bf16 v[80:95], v[40:43], v[192:195], v[80:95]
    ds_read_b64_tr_b16 v[36:37], v9 offset:43008
    ds_read_b64_tr_b16 v[38:39], v9 offset:43520
    s_waitcnt lgkmcnt(8)
    v_mfma_f32_32x32x16_bf16 v[80:95], v[44:47], v[196:199], v[80:95]
    ds_read_b64_tr_b16 v[40:41], v9 offset:45056
    ds_read_b64_tr_b16 v[42:43], v9 offset:45568
    s_waitcnt lgkmcnt(8)
    v_mfma_f32_32x32x16_bf16 v[80:95], v[48:51], v[200:203], v[80:95]
    s_lshl_b32 s18, s13, 2
    s_lshl_b32 s18, s18, 14
    s_add_u32 s18, s18, s10
    s_add_u32 s16, s41, 0
    s_mov_b32 m0, s16
    s_nop 0
    buffer_load_dwordx4 v14, s[72:75], s18 offen lds
    ds_read_b64_tr_b16 v[44:45], v9 offset:47104
    ds_read_b64_tr_b16 v[46:47], v9 offset:47616
    s_waitcnt lgkmcnt(8)
    v_mfma_f32_32x32x16_bf16 v[80:95], v[52:55], v[204:207], v[80:95]
    ds_read_b64_tr_b16 v[48:49], v9 offset:49152
    ds_read_b64_tr_b16 v[50:51], v9 offset:49664
    s_waitcnt lgkmcnt(8)
    v_mfma_f32_32x32x16_bf16 v[80:95], v[32:35], v[208:211], v[80:95]
    ds_read_b64_tr_b16 v[52:53], v9 offset:51200
    ds_read_b64_tr_b16 v[54:55], v9 offset:51712
    s_waitcnt lgkmcnt(8)
    v_mfma_f32_32x32x16_bf16 v[80:95], v[36:39], v[212:215], v[80:95]
    s_add_u32 s16, s41, 1024
    s_mov_b32 m0, s16
    s_add_u32 s18, s18, 0x2000
    buffer_load_dwordx4 v14, s[72:75], s18 offen lds
    s_add_u32 s13, s13, 8
    s_sub_u32 s38, s13, 28
    s_cmp_ge_u32 s13, 28
    s_cselect_b32 s13, s38, s13
    ds_read_b64_tr_b16 v[32:33], v9 offset:53248
    ds_read_b64_tr_b16 v[34:35], v9 offset:53760
    s_waitcnt lgkmcnt(8)
    v_mfma_f32_32x32x16_bf16 v[80:95], v[40:43], v[216:219], v[80:95]
    ds_read_b64_tr_b16 v[36:37], v9 offset:55296
    ds_read_b64_tr_b16 v[38:39], v9 offset:55808
    s_waitcnt lgkmcnt(8)
    v_mfma_f32_32x32x16_bf16 v[80:95], v[44:47], v[220:223], v[80:95]
    ds_read_b64_tr_b16 v[40:41], v9 offset:57344
    ds_read_b64_tr_b16 v[42:43], v9 offset:57856
    s_waitcnt lgkmcnt(8)
    v_mfma_f32_32x32x16_bf16 v[80:95], v[48:51], v[224:227], v[80:95]
    s_lshl_b32 s18, s13, 2
    s_add_u32 s18, s18, s8
    s_lshl_b32 s18, s18, 14
    s_add_u32 s18, s18, s10
    s_add_u32 s16, s41, 16384
    s_mov_b32 m0, s16
    s_nop 0
    buffer_load_dwordx4 v14, s[72:75], s18 offen lds
    ds_read_b64_tr_b16 v[44:45], v9 offset:59392
    ds_read_b64_tr_b16 v[46:47], v9 offset:59904
    s_waitcnt lgkmcnt(8)
    v_mfma_f32_32x32x16_bf16 v[80:95], v[52:55], v[228:231], v[80:95]
    ds_read_b64_tr_b16 v[48:49], v9 offset:61440
    ds_read_b64_tr_b16 v[50:51], v9 offset:61952
    s_waitcnt lgkmcnt(8)
    v_mfma_f32_32x32x16_bf16 v[80:95], v[32:35], v[232:235], v[80:95]
    ds_read_b64_tr_b16 v[52:53], v9 offset:63488
    ds_read_b64_tr_b16 v[54:55], v9 offset:64000
    s_waitcnt lgkmcnt(8)
    v_mfma_f32_32x32x16_bf16 v[80:95], v[36:39], v[236:239], v[80:95]
    s_add_u32 s16, s41, 17408
    s_mov_b32 m0, s16
    s_add_u32 s18, s18, 0x2000
    buffer_load_dwordx4 v14, s[72:75], s18 offen lds
    s_add_u32 s13, s13, 8
    s_sub_u32 s38, s13, 28
    s_cmp_ge_u32 s13, 28
    s_cselect_b32 s13, s38, s13
    ds_read_b64_tr_b16 v[32:33], v10 offset:32768
    ds_read_b64_tr_b16 v[34:35], v10 offset:33280
    s_waitcnt lgkmcnt(8)
    v_mfma_f32_32x32x16_bf16 v[80:95], v[40:43], v[240:243], v[80:95]
    ds_read_b64_tr_b16 v[36:37], v10 offset:34816
    ds_read_b64_tr_b16 v[38:39], v10 offset:35328
    s_waitcnt lgkmcnt(8)
    v_mfma_f32_32x32x16_bf16 v[80:95], v[44:47], v[244:247], v[80:95]
    ds_read_b64_tr_b16 v[40:41], v10 offset:36864
    ds_read_b64_tr_b16 v[42:43], v10 offset:37376
    s_waitcnt lgkmcnt(8)
    v_mfma_f32_32x32x16_bf16 v[80:95], v[48:51], v[248:251], v[80:95]
    s_lshl_b32 s18, s13, 2
    s_add_u32 s18, s18, 1
    s_lshl_b32 s18, s18, 14
    s_add_u32 s18, s18, s10
    s_add_u32 s16, s41, 65536
    s_mov_b32 m0, s16
    s_nop 0
    buffer_load_dwordx4 v14, s[72:75], s18 offen lds
    ds_read_b64_tr_b16 v[44:45], v10 offset:38912
    ds_read_b64_tr_b16 v[46:47], v10 offset:39424
    s_waitcnt lgkmcnt(8)
    v_mfma_f32_32x32x16_bf16 v[80:95], v[52:55], v[252:255], v[80:95]
    s_nop 11
    v_mul_f32 v16, v80, v80
    v_mul_f32 v17, v81, v81
    v_mul_f32 v18, v82, v82
    v_mul_f32 v19, v83, v83
    v_mul_f32 v20, v84, v84
    v_mul_f32 v21, v85, v85
    v_mul_f32 v22, v86, v86
    v_mul_f32 v23, v87, v87
    v_fmaak_f32 v16, v16, v15, 0xc0135761
    v_fmaak_f32 v17, v17, v15, 0xc0135761
    v_fmaak_f32 v18, v18, v15, 0xc0135761
    v_fmaak_f32 v19, v19, v15, 0xc0135761
    v_fmaak_f32 v20, v20, v15, 0xc0135761
    v_fmaak_f32 v21, v21, v15, 0xc0135761
    v_fmaak_f32 v22, v22, v15, 0xc0135761
    v_fmaak_f32 v23, v23, v15, 0xc0135761
    v_mul_f32 v16, v16, v80
    v_mul_f32 v17, v17, v81
    v_mul_f32 v18, v18, v82
    v_mul_f32 v19, v19, v83
    v_mul_f32 v20, v20, v84
    v_mul_f32 v21, v21, v85
    v_mul_f32 v22, v22, v86
    v_mul_f32 v23, v23, v87
    v_exp_f32 v16, v16
    v_exp_f32 v17, v17
    v_exp_f32 v18, v18
    v_exp_f32 v19, v19
    v_exp_f32 v20, v20
    v_exp_f32 v21, v21
    v_exp_f32 v22, v22
    v_exp_f32 v23, v23
    v_mul_f32 v80, v80, v88
    v_mul_f32 v81, v81, v89
    v_mul_f32 v82, v82, v90
    v_mul_f32 v83, v83, v91
    v_mul_f32 v84, v84, v92
    v_mul_f32 v85, v85, v93
    v_mul_f32 v86, v86, v94
    v_mul_f32 v87, v87, v95
    v_add_f32 v16, 1.0, v16
    v_add_f32 v17, 1.0, v17
    v_add_f32 v18, 1.0, v18
    v_add_f32 v19, 1.0, v19
    v_add_f32 v20, 1.0, v20
    v_add_f32 v21, 1.0, v21
    v_add_f32 v22, 1.0, v22
    v_add_f32 v23, 1.0, v23
    v_rcp_f32 v16, v16
    v_rcp_f32 v17, v17
    v_rcp_f32 v18, v18
    v_rcp_f32 v19, v19
    v_rcp_f32 v20, v20
    v_rcp_f32 v21, v21
    v_rcp_f32 v22, v22
    v_rcp_f32 v23, v23
    v_mul_f32 v80, v80, v16
    v_mul_f32 v81, v81, v17
    v_mul_f32 v82, v82, v18
    v_mul_f32 v83, v83, v19
    v_mul_f32 v84, v84, v20
    v_mul_f32 v85, v85, v21
    v_mul_f32 v86, v86, v22
    v_mul_f32 v87, v87, v23
    v_cvt_pk_bf16_f32 v28, v80, v81
    v_cvt_pk_bf16_f32 v29, v82, v83
    v_cvt_pk_bf16_f32 v30, v84, v85
    v_cvt_pk_bf16_f32 v31, v86, v87
    buffer_store_dwordx4 v[28:31], v3, s[20:23], s14 offen offset:1024 sc0 sc1
    ds_read_b64_tr_b16 v[48:49], v10 offset:40960
    ds_read_b64_tr_b16 v[50:51], v10 offset:41472
    s_waitcnt lgkmcnt(8)
    v_mfma_f32_32x32x16_bf16 v[96:111], v[32:35], v[192:195], v[96:111]
    ds_read_b64_tr_b16 v[52:53], v10 offset:43008
    ds_read_b64_tr_b16 v[54:55], v10 offset:43520
    s_waitcnt lgkmcnt(8)
    v_mfma_f32_32x32x16_bf16 v[96:111], v[36:39], v[196:199], v[96:111]
    s_add_u32 s16, s41, 66560
    s_mov_b32 m0, s16
    s_add_u32 s18, s18, 0x2000
    buffer_load_dwordx4 v14, s[72:75], s18 offen lds
    s_add_u32 s13, s13, 8
    s_sub_u32 s38, s13, 28
    s_cmp_ge_u32 s13, 28
    s_cselect_b32 s13, s38, s13
    ds_read_b64_tr_b16 v[32:33], v10 offset:45056
    ds_read_b64_tr_b16 v[34:35], v10 offset:45568
    s_waitcnt lgkmcnt(8)
    v_mfma_f32_32x32x16_bf16 v[96:111], v[40:43], v[200:203], v[96:111]
    ds_read_b64_tr_b16 v[36:37], v10 offset:47104
    ds_read_b64_tr_b16 v[38:39], v10 offset:47616
    s_waitcnt lgkmcnt(8)
    v_mfma_f32_32x32x16_bf16 v[96:111], v[44:47], v[204:207], v[96:111]
    ds_read_b64_tr_b16 v[40:41], v10 offset:49152
    ds_read_b64_tr_b16 v[42:43], v10 offset:49664
    s_waitcnt lgkmcnt(8)
    v_mfma_f32_32x32x16_bf16 v[96:111], v[48:51], v[208:211], v[96:111]
    s_lshl_b32 s18, s13, 2
    s_add_u32 s18, s18, 1
    s_lshl_b32 s18, s18, 14
    s_add_u32 s18, s18, s10
    s_add_u32 s16, s41, 81920
    s_mov_b32 m0, s16
    s_nop 0
    buffer_load_dwordx4 v14, s[72:75], s18 offen lds
    ds_read_b64_tr_b16 v[44:45], v10 offset:51200
    ds_read_b64_tr_b16 v[46:47], v10 offset:51712
    s_waitcnt lgkmcnt(8)
    v_mfma_f32_32x32x16_bf16 v[96:111], v[52:55], v[212:215], v[96:111]
    ds_read_b64_tr_b16 v[48:49], v10 offset:53248
    ds_read_b64_tr_b16 v[50:51], v10 offset:53760
    s_waitcnt lgkmcnt(8)
    v_mfma_f32_32x32x16_bf16 v[96:111], v[32:35], v[216:219], v[96:111]
    ds_read_b64_tr_b16 v[52:53], v10 offset:55296
    ds_read_b64_tr_b16 v[54:55], v10 offset:55808
    s_waitcnt lgkmcnt(8)
    v_mfma_f32_32x32x16_bf16 v[96:111], v[36:39], v[220:223], v[96:111]
    s_add_u32 s16, s41, 82944
    s_mov_b32 m0, s16
    s_add_u32 s18, s18, 0x2000
    buffer_load_dwordx4 v14, s[72:75], s18 offen lds
    s_add_u32 s13, s13, 8
    s_sub_u32 s38, s13, 28
    s_cmp_ge_u32 s13, 28
    s_cselect_b32 s13, s38, s13
    ds_read_b64_tr_b16 v[32:33], v10 offset:57344
    ds_read_b64_tr_b16 v[34:35], v10 offset:57856
    s_waitcnt lgkmcnt(8)
    v_mfma_f32_32x32x16_bf16 v[96:111], v[40:43], v[224:227], v[96:111]
    ds_read_b64_tr_b16 v[36:37], v10 offset:59392
    ds_read_b64_tr_b16 v[38:39], v10 offset:59904
    s_waitcnt lgkmcnt(8)
    v_mfma_f32_32x32x16_bf16 v[96:111], v[44:47], v[228:231], v[96:111]
    ds_read_b64_tr_b16 v[40:41], v10 offset:61440
    ds_read_b64_tr_b16 v[42:43], v10 offset:61952
    s_waitcnt lgkmcnt(8)
    v_mfma_f32_32x32x16_bf16 v[96:111], v[48:51], v[232:235], v[96:111]
    ds_read_b64_tr_b16 v[44:45], v10 offset:63488
    ds_read_b64_tr_b16 v[46:47], v10 offset:64000
    s_waitcnt lgkmcnt(8)
    v_mfma_f32_32x32x16_bf16 v[96:111], v[52:55], v[236:239], v[96:111]
    ds_read_b64_tr_b16 v[48:49], v11 offset:32768
    ds_read_b64_tr_b16 v[50:51], v11 offset:33280
    s_waitcnt lgkmcnt(8)
    v_mfma_f32_32x32x16_bf16 v[96:111], v[32:35], v[240:243], v[96:111]
    ds_read_b64_tr_b16 v[52:53], v11 offset:34816
    ds_read_b64_tr_b16 v[54:55], v11 offset:35328
    s_waitcnt lgkmcnt(8)
    v_mfma_f32_32x32x16_bf16 v[96:111], v[36:39], v[244:247], v[96:111]
    s_waitcnt vmcnt(3)
    s_mov_b64 exec, 1
    s_cmp_lg_u32 s60, 0
    s_cbranch_scc1 M_PF2e
    buffer_store_dword v7, v6, s[20:23], s61 offen offset:1024 sc0 sc1
    s_branch M_PX2e
M_PF2e:
    buffer_store_dword v7, v6, s[20:23], s61 offen offset:1024
M_PX2e:
    s_mov_b64 exec, -1
    ds_read_b64_tr_b16 v[32:33], v11 offset:36864
    ds_read_b64_tr_b16 v[34:35], v11 offset:37376
    s_waitcnt lgkmcnt(8)
    v_mfma_f32_32x32x16_bf16 v[96:111], v[40:43], v[248:251], v[96:111]
    ds_read_b64_tr_b16 v[36:37], v11 offset:38912
    ds_read_b64_tr_b16 v[38:39], v11 offset:39424
    s_waitcnt lgkmcnt(8)
    v_mfma_f32_32x32x16_bf16 v[96:111], v[44:47], v[252:255], v[96:111]
    s_nop 11
    v_mul_f32 v16, v96, v96
    v_mul_f32 v17, v97, v97
    v_mul_f32 v18, v98, v98
    v_mul_f32 v19, v99, v99
    v_mul_f32 v20, v100, v100
    v_mul_f32 v21, v101, v101
    v_mul_f32 v22, v102, v102
    v_mul_f32 v23, v103, v103
    v_fmaak_f32 v16, v16, v15, 0xc0135761
    v_fmaak_f32 v17, v17, v15, 0xc0135761
    v_fmaak_f32 v18, v18, v15, 0xc0135761
    v_fmaak_f32 v19, v19, v15, 0xc0135761
    v_fmaak_f32 v20, v20, v15, 0xc0135761
    v_fmaak_f32 v21, v21, v15, 0xc0135761
    v_fmaak_f32 v22, v22, v15, 0xc0135761
    v_fmaak_f32 v23, v23, v15, 0xc0135761
    v_mul_f32 v16, v16, v96
    v_mul_f32 v17, v17, v97
    v_mul_f32 v18, v18, v98
    v_mul_f32 v19, v19, v99
    v_mul_f32 v20, v20, v100
    v_mul_f32 v21, v21, v101
    v_mul_f32 v22, v22, v102
    v_mul_f32 v23, v23, v103
    v_exp_f32 v16, v16
    v_exp_f32 v17, v17
    v_exp_f32 v18, v18
    v_exp_f32 v19, v19
    v_exp_f32 v20, v20
    v_exp_f32 v21, v21
    v_exp_f32 v22, v22
    v_exp_f32 v23, v23
    v_mul_f32 v96, v96, v104
    v_mul_f32 v97, v97, v105
    v_mul_f32 v98, v98, v106
    v_mul_f32 v99, v99, v107
    v_mul_f32 v100, v100, v108
    v_mul_f32 v101, v101, v109
    v_mul_f32 v102, v102, v110
    v_mul_f32 v103, v103, v111
    v_add_f32 v16, 1.0, v16
    v_add_f32 v17, 1.0, v17
    v_add_f32 v18, 1.0, v18
    v_add_f32 v19, 1.0, v19
    v_add_f32 v20, 1.0, v20
    v_add_f32 v21, 1.0, v21
    v_add_f32 v22, 1.0, v22
    v_add_f32 v23, 1.0, v23
    v_rcp_f32 v16, v16
    v_rcp_f32 v17, v17
    v_rcp_f32 v18, v18
    v_rcp_f32 v19, v19
    v_rcp_f32 v20, v20
    v_rcp_f32 v21, v21
    v_rcp_f32 v22, v22
    v_rcp_f32 v23, v23
    v_mul_f32 v96, v96, v16
    v_mul_f32 v97, v97, v17
    v_mul_f32 v98, v98, v18
    v_mul_f32 v99, v99, v19
    v_mul_f32 v100, v100, v20
    v_mul_f32 v101, v101, v21
    v_mul_f32 v102, v102, v22
    v_mul_f32 v103, v103, v23
    v_cvt_pk_bf16_f32 v24, v96, v97
    v_cvt_pk_bf16_f32 v25, v98, v99
    v_cvt_pk_bf16_f32 v26, v100, v101
    v_cvt_pk_bf16_f32 v27, v102, v103
    buffer_store_dwordx4 v[24:27], v3, s[20:23], s14 offen offset:2048 sc0 sc1
    ds_read_b64_tr_b16 v[40:41], v11 offset:40960
    ds_read_b64_tr_b16 v[42:43], v11 offset:41472
    s_waitcnt lgkmcnt(8)
    v_mfma_f32_32x32x16_bf16 v[112:127], v[48:51], v[192:195], v[112:127]
    ds_read_b64_tr_b16 v[44:45], v11 offset:43008
    ds_read_b64_tr_b16 v[46:47], v11 offset:43520
    s_waitcnt lgkmcnt(8)
    v_mfma_f32_32x32x16_bf16 v[112:127], v[52:55], v[196:199], v[112:127]
    ds_read_b64_tr_b16 v[48:49], v11 offset:45056
    ds_read_b64_tr_b16 v[50:51], v11 offset:45568
    s_waitcnt lgkmcnt(8)
    v_mfma_f32_32x32x16_bf16 v[112:127], v[32:35], v[200:203], v[112:127]
    ds_read_b64_tr_b16 v[52:53], v11 offset:47104
    ds_read_b64_tr_b16 v[54:55], v11 offset:47616
    s_waitcnt lgkmcnt(8)
    v_mfma_f32_32x32x16_bf16 v[112:127], v[36:39], v[204:207], v[112:127]
    ds_read_b64_tr_b16 v[32:33], v11 offset:49152
    ds_read_b64_tr_b16 v[34:35], v11 offset:49664
    s_waitcnt lgkmcnt(8)
    v_mfma_f32_32x32x16_bf16 v[112:127], v[40:43], v[208:211], v[112:127]
    ds_read_b64_tr_b16 v[36:37], v11 offset:51200
    ds_read_b64_tr_b16 v[38:39], v11 offset:51712
    s_waitcnt lgkmcnt(8)
    v_mfma_f32_32x32x16_bf16 v[112:127], v[44:47], v[212:215], v[112:127]
    ds_read_b64_tr_b16 v[40:41], v11 offset:53248
    ds_read_b64_tr_b16 v[42:43], v11 offset:53760
    s_waitcnt lgkmcnt(8)
    v_mfma_f32_32x32x16_bf16 v[112:127], v[48:51], v[216:219], v[112:127]
    ds_read_b64_tr_b16 v[44:45], v11 offset:55296
    ds_read_b64_tr_b16 v[46:47], v11 offset:55808
    s_waitcnt lgkmcnt(8)
    v_mfma_f32_32x32x16_bf16 v[112:127], v[52:55], v[220:223], v[112:127]
    ds_read_b64_tr_b16 v[48:49], v11 offset:57344
    ds_read_b64_tr_b16 v[50:51], v11 offset:57856
    s_waitcnt lgkmcnt(8)
    v_mfma_f32_32x32x16_bf16 v[112:127], v[32:35], v[224:227], v[112:127]
    ds_read_b64_tr_b16 v[52:53], v11 offset:59392
    ds_read_b64_tr_b16 v[54:55], v11 offset:59904
    s_waitcnt lgkmcnt(8)
    v_mfma_f32_32x32x16_bf16 v[112:127], v[36:39], v[228:231], v[112:127]
    ds_read_b64_tr_b16 v[32:33], v11 offset:61440
    ds_read_b64_tr_b16 v[34:35], v11 offset:61952
    s_waitcnt lgkmcnt(8)
    v_mfma_f32_32x32x16_bf16 v[112:127], v[40:43], v[232:235], v[112:127]
    ds_read_b64_tr_b16 v[36:37], v11 offset:63488
    ds_read_b64_tr_b16 v[38:39], v11 offset:64000
    s_waitcnt lgkmcnt(8)
    v_mfma_f32_32x32x16_bf16 v[112:127], v[44:47], v[236:239], v[112:127]
    s_waitcnt lgkmcnt(6)
    v_mfma_f32_32x32x16_bf16 v[112:127], v[48:51], v[240:243], v[112:127]
    s_waitcnt lgkmcnt(4)
    v_mfma_f32_32x32x16_bf16 v[112:127], v[52:55], v[244:247], v[112:127]
    s_waitcnt lgkmcnt(2)
    v_mfma_f32_32x32x16_bf16 v[112:127], v[32:35], v[248:251], v[112:127]
    s_waitcnt lgkmcnt(0)
    v_mfma_f32_32x32x16_bf16 v[112:127], v[36:39], v[252:255], v[112:127]
    s_nop 11
    v_mul_f32 v16, v112, v112
    v_mul_f32 v17, v113, v113
    v_mul_f32 v18, v114, v114
    v_mul_f32 v19, v115, v115
    v_mul_f32 v20, v116, v116
    v_mul_f32 v21, v117, v117
    v_mul_f32 v22, v118, v118
    v_mul_f32 v23, v119, v119
    v_fmaak_f32 v16, v16, v15, 0xc0135761
    v_fmaak_f32 v17, v17, v15, 0xc0135761
    v_fmaak_f32 v18, v18, v15, 0xc0135761
    v_fmaak_f32 v19, v19, v15, 0xc0135761
    v_fmaak_f32 v20, v20, v15, 0xc0135761
    v_fmaak_f32 v21, v21, v15, 0xc0135761
    v_fmaak_f32 v22, v22, v15, 0xc0135761
    v_fmaak_f32 v23, v23, v15, 0xc0135761
    v_mul_f32 v16, v16, v112
    v_mul_f32 v17, v17, v113
    v_mul_f32 v18, v18, v114
    v_mul_f32 v19, v19, v115
    v_mul_f32 v20, v20, v116
    v_mul_f32 v21, v21, v117
    v_mul_f32 v22, v22, v118
    v_mul_f32 v23, v23, v119
    v_exp_f32 v16, v16
    v_exp_f32 v17, v17
    v_exp_f32 v18, v18
    v_exp_f32 v19, v19
    v_exp_f32 v20, v20
    v_exp_f32 v21, v21
    v_exp_f32 v22, v22
    v_exp_f32 v23, v23
    v_mul_f32 v112, v112, v120
    v_mul_f32 v113, v113, v121
    v_mul_f32 v114, v114, v122
    v_mul_f32 v115, v115, v123
    v_mul_f32 v116, v116, v124
    v_mul_f32 v117, v117, v125
    v_mul_f32 v118, v118, v126
    v_mul_f32 v119, v119, v127
    v_add_f32 v16, 1.0, v16
    v_add_f32 v17, 1.0, v17
    v_add_f32 v18, 1.0, v18
    v_add_f32 v19, 1.0, v19
    v_add_f32 v20, 1.0, v20
    v_add_f32 v21, 1.0, v21
    v_add_f32 v22, 1.0, v22
    v_add_f32 v23, 1.0, v23
    v_rcp_f32 v16, v16
    v_rcp_f32 v17, v17
    v_rcp_f32 v18, v18
    v_rcp_f32 v19, v19
    v_rcp_f32 v20, v20
    v_rcp_f32 v21, v21
    v_rcp_f32 v22, v22
    v_rcp_f32 v23, v23
    v_mul_f32 v112, v112, v16
    v_mul_f32 v113, v113, v17
    v_mul_f32 v114, v114, v18
    v_mul_f32 v115, v115, v19
    v_mul_f32 v116, v116, v20
    v_mul_f32 v117, v117, v21
    v_mul_f32 v118, v118, v22
    v_mul_f32 v119, v119, v23
    v_cvt_pk_bf16_f32 v28, v112, v113
    v_cvt_pk_bf16_f32 v29, v114, v115
    v_cvt_pk_bf16_f32 v30, v116, v117
    v_cvt_pk_bf16_f32 v31, v118, v119
    buffer_store_dwordx4 v[28:31], v3, s[20:23], s14 offen offset:3072 sc0 sc1
    s_bfe_u32 s7, s3, 0x10001
    v_lshrrev_b32 v16, 5, v2
    v_lshlrev_b32 v8, 10, v16
    v_bfe_u32 v17, v2, 2, 2
    v_lshl_add_u32 v8, v17, 7, v8
    v_bfe_u32 v5, v2, 1, 1
    v_lshl_add_u32 v8, v5, 3, v8
    v_and_b32 v5, 1, v2
    v_lshlrev_b32 v5, 1, v5
    v_bfe_u32 v9, v2, 4, 1
    v_add_u32 v5, v5, v9
    v_and_b32 v17, 2, v17
    v_lshl_add_u32 v5, v17, 1, v5
    s_lshl_b32 s38, s6, 2
    v_xor_b32 v5, s38, v5
    v_lshl_add_u32 v8, v5, 4, v8
    s_lshl_b32 s38, s8, 13
    v_add_u32 v8, s38, v8
    v_add_u32 v9, 0x10000, v8
    v_add_u32 v13, 0x20000, v8
    s_lshl_b32 s38, s7, 13
    s_lshl_b32 s40, s8, 12
    s_add_u32 s38, s38, s40
    v_add_u32 v10, s38, v3
    v_add_u32 v11, 0x10000, v10
    v_add_u32 v0, 0x20000, v10
    s_lshl_b32 s40, s4, 2
    s_add_u32 s40, s40, s9
    s_mul_i32 s11, s40, 0x38000
    s_add_u32 s11, s11, 12582912
    s_lshl_b32 s40, s40, 1
    s_add_u32 s40, s40, s7
    s_lshl_b32 s40, s40, 15
    s_add_u32 s40, s40, s17
    v_and_b32 v12, 31, v2
    v_min_u32 v5, 27, v12
    v_lshlrev_b32 v12, 10, v12
    v_lshl_add_u32 v12, v16, 5, v12
    v_add_u32 v12, s40, v12
    v_lshl_add_u32 v5, v16, 5, v5
    s_lshl_b32 s38, s9, 8
    s_add_u32 s38, s38, 1024
    v_lshl_add_u32 v5, v5, 2, s38
    s_waitcnt vmcnt(2)
    s_branch M_F2
M_SPARE:
    s_waitcnt vmcnt(0) lgkmcnt(0)
    s_barrier
    s_sub_u32 s7, s5, 28
    s_lshl_b32 s7, s7, 3
    s_add_u32 s7, s7, s3
    s_lshr_b32 s36, s7, 2
    s_lshl_b32 s36, s36, 16
    s_and_b32 s37, s7, 3
    s_lshl_b32 s37, s37, 13
    s_add_u32 s36, s36, s37
    s_add_u32 s36, s36, 0x8000
    v_lshlrev_b32 v4, 7, v2
    s_lshr_b32 s37, s7, 1
    s_lshl_b32 s37, s37, 16
    s_and_b32 s7, s7, 1
    s_lshl_b32 s7, s7, 13
    s_add_u32 s37, s37, s7
    buffer_load_dword v16, v4, s[72:75], s36 offen
    s_add_u32 s36, s36, 0x80000
    buffer_load_dword v17, v4, s[72:75], s36 offen
    s_add_u32 s36, s36, 0x80000
    buffer_load_dword v18, v4, s[72:75], s36 offen
    s_add_u32 s36, s36, 0x80000
    buffer_load_dword v19, v4, s[72:75], s36 offen
    s_add_u32 s7, s37, 16384
    buffer_load_dword v22, v4, s[72:75], s7 offen
    s_add_u32 s7, s7, 0x100000
    buffer_load_dword v23, v4, s[72:75], s7 offen
    s_lshl_b32 s18, s13, 2
    s_lshl_b32 s18, s18, 14
    s_add_u32 s18, s18, s10
    s_add_u32 s16, s41, 131072
    s_mov_b32 m0, s16
    s_nop 0
    buffer_load_dwordx4 v14, s[72:75], s18 offen lds
    s_add_u32 s16, s41, 132096
    s_mov_b32 m0, s16
    s_add_u32 s18, s18, 0x2000
    buffer_load_dwordx4 v14, s[72:75], s18 offen lds
    s_add_u32 s13, s13, 8
    s_sub_u32 s38, s13, 28
    s_cmp_ge_u32 s13, 28
    s_cselect_b32 s13, s38, s13
    s_lshl_b32 s18, s13, 2
    s_lshl_b32 s18, s18, 14
    s_add_u32 s18, s18, s10
    s_add_u32 s16, s41, 147456
    s_mov_b32 m0, s16
    s_nop 0
    buffer_load_dwordx4 v14, s[72:75], s18 offen lds
    s_add_u32 s16, s41, 148480
    s_mov_b32 m0, s16
    s_add_u32 s18, s18, 0x2000
    buffer_load_dwordx4 v14, s[72:75], s18 offen lds
    s_add_u32 s13, s13, 8
    s_sub_u32 s38, s13, 28
    s_cmp_ge_u32 s13, 28
    s_cselect_b32 s13, s38, s13
    s_lshl_b32 s18, s13, 2
    s_lshl_b32 s18, s18, 14
    s_add_u32 s18, s18, s10
    s_add_u32 s16, s41, 0
    s_mov_b32 m0, s16
    s_nop 0
    buffer_load_dwordx4 v14, s[72:75], s18 offen lds
    s_add_u32 s16, s41, 1024
    s_mov_b32 m0, s16
    s_add_u32 s18, s18, 0x2000
    buffer_load_dwordx4 v14, s[72:75], s18 offen lds
    s_add_u32 s13, s13, 8
    s_sub_u32 s38, s13, 28
    s_cmp_ge_u32 s13, 28
    s_cselect_b32 s13, s38, s13
    s_lshl_b32 s18, s13, 2
    s_add_u32 s18, s18, s8
    s_lshl_b32 s18, s18, 14
    s_add_u32 s18, s18, s10
    s_add_u32 s16, s41, 16384
    s_mov_b32 m0, s16
    s_nop 0
    buffer_load_dwordx4 v14, s[72:75], s18 offen lds
    s_add_u32 s16, s41, 17408
    s_mov_b32 m0, s16
    s_add_u32 s18, s18, 0x2000
    buffer_load_dwordx4 v14, s[72:75], s18 offen lds
    s_add_u32 s13, s13, 8
    s_sub_u32 s38, s13, 28
    s_cmp_ge_u32 s13, 28
    s_cselect_b32 s13, s38, s13
    s_lshl_b32 s18, s13, 2
    s_add_u32 s18, s18, 1
    s_lshl_b32 s18, s18, 14
    s_add_u32 s18, s18, s10
    s_add_u32 s16, s41, 65536
    s_mov_b32 m0, s16
    s_nop 0
    buffer_load_dwordx4 v14, s[72:75], s18 offen lds
    s_add_u32 s16, s41, 66560
    s_mov_b32 m0, s16
    s_add_u32 s18, s18, 0x2000
    buffer_load_dwordx4 v14, s[72:75], s18 offen lds
    s_add_u32 s13, s13, 8
    s_sub_u32 s38, s13, 28
    s_cmp_ge_u32 s13, 28
    s_cselect_b32 s13, s38, s13
    s_lshl_b32 s18, s13, 2
    s_add_u32 s18, s18, 1
    s_lshl_b32 s18, s18, 14
    s_add_u32 s18, s18, s10
    s_add_u32 s16, s41, 81920
    s_mov_b32 m0, s16
    s_nop 0
    buffer_load_dwordx4 v14, s[72:75], s18 offen lds
    s_add_u32 s16, s41, 82944
    s_mov_b32 m0, s16
    s_add_u32 s18, s18, 0x2000
    buffer_load_dwordx4 v14, s[72:75], s18 offen lds
    s_add_u32 s13, s13, 8
    s_sub_u32 s38, s13, 28
    s_cmp_ge_u32 s13, 28
    s_cselect_b32 s13, s38, s13
    s_bfe_u32 s7, s3, 0x10001
    v_lshrrev_b32 v16, 5, v2
    v_lshlrev_b32 v8, 10, v16
    v_bfe_u32 v17, v2, 2, 2
    v_lshl_add_u32 v8, v17, 7, v8
    v_bfe_u32 v5, v2, 1, 1
    v_lshl_add_u32 v8, v5, 3, v8
    v_and_b32 v5, 1, v2
    v_lshlrev_b32 v5, 1, v5
    v_bfe_u32 v9, v2, 4, 1
    v_add_u32 v5, v5, v9
    v_and_b32 v17, 2, v17
    v_lshl_add_u32 v5, v17, 1, v5
    s_lshl_b32 s38, s6, 2
    v_xor_b32 v5, s38, v5
    v_lshl_add_u32 v8, v5, 4, v8
    s_lshl_b32 s38, s8, 13
    v_add_u32 v8, s38, v8
    v_add_u32 v9, 0x10000, v8
    v_add_u32 v13, 0x20000, v8
    s_lshl_b32 s38, s7, 13
    s_lshl_b32 s40, s8, 12
    s_add_u32 s38, s38, s40
    v_add_u32 v10, s38, v3
    v_add_u32 v11, 0x10000, v10
    v_add_u32 v0, 0x20000, v10
    s_lshl_b32 s40, s4, 2
    s_add_u32 s40, s40, s9
    s_mul_i32 s11, s40, 0x38000
    s_add_u32 s11, s11, 12582912
    s_lshl_b32 s40, s40, 1
    s_add_u32 s40, s40, s7
    s_lshl_b32 s40, s40, 15
    s_add_u32 s40, s40, s17
    v_and_b32 v12, 31, v2
    v_min_u32 v5, 27, v12
    v_lshlrev_b32 v12, 10, v12
    v_lshl_add_u32 v12, v16, 5, v12
    v_add_u32 v12, s40, v12
    v_lshl_add_u32 v5, v16, 5, v5
    s_lshl_b32 s38, s9, 8
    s_add_u32 s38, s38, 1024
    v_lshl_add_u32 v5, v5, 2, s38
    s_waitcnt vmcnt(0)
M_F2:
    s_cmp_lg_u32 s3, 0
    s_cbranch_scc1 M_NP2
    s_mov_b32 s36, 0x80000
M_W2:
    buffer_load_dword v16, v5, s[20:23], s61 offen offset:1024 sc1
    s_waitcnt vmcnt(0)
    v_cmp_eq_u32 vcc, s59, v16
    s_nop 0
    s_cmp_eq_u64 vcc, -1
    s_cbranch_scc1 M_G2
    s_sleep 2
    s_sub_u32 s36, s36, 1
    s_cmp_lg_u32 s36, 0
    s_cbranch_scc1 M_W2
M_G2:
    s_cmp_lg_u32 s60, 0
    s_cbranch_scc1 M_A2
    buffer_inv sc1
    s_waitcnt vmcnt(0)
M_A2:
M_NP2:
    s_barrier
    s_lshl_b32 s19, s39, 2
    s_lshl_b32 s19, s19, 10
    s_add_u32 s19, s19, s11
    s_add_u32 s16, s63, 32768
    s_mov_b32 m0, s16
    s_nop 0
    buffer_load_dwordx4 v3, s[20:23], s19 offen sc1 lds
    s_add_u32 s16, s63, 40960
    s_mov_b32 m0, s16
    s_add_u32 s19, s19, 0x1c000
    buffer_load_dwordx4 v3, s[20:23], s19 offen sc1 lds
    s_add_u32 s39, s39, 8
    s_sub_u32 s38, s39, 28
    s_cmp_ge_u32 s39, 28
    s_cselect_b32 s39, s38, s39
    s_lshl_b32 s19, s39, 2
    s_lshl_b32 s19, s19, 10
    s_add_u32 s19, s19, s11
    s_add_u32 s16, s63, 49152
    s_mov_b32 m0, s16
    s_nop 0
    buffer_load_dwordx4 v3, s[20:23], s19 offen sc1 lds
    s_add_u32 s16, s63, 57344
    s_mov_b32 m0, s16
    s_add_u32 s19, s19, 0x1c000
    buffer_load_dwordx4 v3, s[20:23], s19 offen sc1 lds
    s_add_u32 s39, s39, 8
    s_sub_u32 s38, s39, 28
    s_cmp_ge_u32 s39, 28
    s_cselect_b32 s39, s38, s39
    s_lshl_b32 s19, s39, 2
    s_lshl_b32 s19, s19, 10
    s_add_u32 s19, s19, s11
    s_add_u32 s16, s63, 98304
    s_mov_b32 m0, s16
    s_nop 0
    buffer_load_dwordx4 v3, s[20:23], s19 offen sc1 lds
    s_add_u32 s16, s63, 106496
    s_mov_b32 m0, s16
    s_add_u32 s19, s19, 0x1c000
    buffer_load_dwordx4 v3, s[20:23], s19 offen sc1 lds
    s_add_u32 s39, s39, 8
    s_sub_u32 s38, s39, 28
    s_cmp_ge_u32 s39, 28
    s_cselect_b32 s39, s38, s39
    s_lshl_b32 s19, s39, 2
    s_add_u32 s19, s19, s8
    s_lshl_b32 s19, s19, 10
    s_add_u32 s19, s19, s11
    s_add_u32 s16, s63, 114688
    s_mov_b32 m0, s16
    s_nop 0
    buffer_load_dwordx4 v3, s[20:23], s19 offen sc1 lds
    s_add_u32 s16, s63, 122880
    s_mov_b32 m0, s16
    s_add_u32 s19, s19, 0x1c000
    buffer_load_dwordx4 v3, s[20:23], s19 offen sc1 lds
    s_add_u32 s39, s39, 8
    s_sub_u32 s38, s39, 28
    s_cmp_ge_u32 s39, 28
    s_cselect_b32 s39, s38, s39
    global_load_dwordx4 v[80:83], v12, s[56:57] sc1
    s_waitcnt vmcnt(9)
    s_mov_b64 exec, 1
    s_cmp_lg_u32 s60, 0
    s_cbranch_scc1 M_PF2
    buffer_store_dword v7, v6, s[20:23], s61 offen offset:0 sc0 sc1
    s_branch M_PX2
M_PF2:
    buffer_store_dword v7, v6, s[20:23], s61 offen offset:0
M_PX2:
    s_mov_b64 exec, -1
    s_waitcnt vmcnt(8)
    s_barrier
    ds_read_b128 v[112:115], v10 offset:32768
    ds_read_b64_tr_b16 v[96:97], v13 offset:0
    ds_read_b64_tr_b16 v[98:99], v13 offset:512
    ds_read_b128 v[116:119], v10 offset:33792
    ds_read_b64_tr_b16 v[100:101], v13 offset:2048
    ds_read_b64_tr_b16 v[102:103], v13 offset:2560
    ds_read_b128 v[120:123], v10 offset:34816
    ds_read_b64_tr_b16 v[104:105], v13 offset:4096
    ds_read_b64_tr_b16 v[106:107], v13 offset:4608
    ds_read_b128 v[124:127], v10 offset:35840
    ds_read_b64_tr_b16 v[108:109], v13 offset:6144
    ds_read_b64_tr_b16 v[110:111], v13 offset:6656
    s_waitcnt vmcnt(6) lgkmcnt(0)
    s_barrier
    v_mfma_f32_32x32x16_bf16 v[16:31], v[96:99], v[112:115], 0
    ds_read_b128 v[144:147], v10 offset:49152
    ds_read_b64_tr_b16 v[128:129], v13 offset:16384
    ds_read_b64_tr_b16 v[130:131], v13 offset:16896
    v_mfma_f32_32x32x16_bf16 v[16:31], v[100:103], v[116:119], v[16:31]
    ds_read_b128 v[148:151], v10 offset:50176
    ds_read_b64_tr_b16 v[132:133], v13 offset:18432
    ds_read_b64_tr_b16 v[134:135], v13 offset:18944
    v_mfma_f32_32x32x16_bf16 v[16:31], v[104:107], v[120:123], v[16:31]
    ds_read_b128 v[152:155], v10 offset:51200
    ds_read_b64_tr_b16 v[136:137], v13 offset:20480
    ds_read_b64_tr_b16 v[138:139], v13 offset:20992
    v_mfma_f32_32x32x16_bf16 v[16:31], v[108:111], v[124:127], v[16:31]
    ds_read_b128 v[156:159], v10 offset:52224
    ds_read_b64_tr_b16 v[140:141], v13 offset:22528
    ds_read_b64_tr_b16 v[142:143], v13 offset:23040
    buffer_load_dword v6, v5, s[20:23], s61 offen sc1
    s_lshl_b32 s19, s39, 2
    s_add_u32 s19, s19, 1
    s_lshl_b32 s19, s19, 10
    s_add_u32 s19, s19, s11
    s_add_u32 s16, s63, 32768
    s_mov_b32 m0, s16
    s_nop 0
    buffer_load_dwordx4 v3, s[20:23], s19 offen sc1 lds
    s_add_u32 s16, s63, 40960
    s_mov_b32 m0, s16
    s_add_u32 s19, s19, 0x1c000
    buffer_load_dwordx4 v3, s[20:23], s19 offen sc1 lds
    s_add_u32 s39, s39, 8
    s_sub_u32 s38, s39, 28
    s_cmp_ge_u32 s39, 28
    s_cselect_b32 s39, s38, s39
    s_lshl_b32 s19, s39, 2
    s_add_u32 s19, s19, 1
    s_lshl_b32 s19, s19, 10
    s_add_u32 s19, s19, s11
    s_add_u32 s16, s63, 131072
    s_mov_b32 m0, s16
    s_nop 0
    buffer_load_dwordx4 v3, s[20:23], s19 offen sc1 lds
    s_add_u32 s16, s63, 139264
    s_mov_b32 m0, s16
    s_add_u32 s19, s19, 0x1c000
    buffer_load_dwordx4 v3, s[20:23], s19 offen sc1 lds
    s_add_u32 s39, s39, 8
    s_sub_u32 s38, s39, 28
    s_cmp_ge_u32 s39, 28
    s_cselect_b32 s39, s38, s39
    s_waitcnt vmcnt(9) lgkmcnt(0)
    s_barrier
    v_mfma_f32_32x32x16_bf16 v[16:31], v[128:131], v[144:147], v[16:31]
    ds_read_b128 v[112:115], v11 offset:32768
    ds_read_b64_tr_b16 v[96:97], v8 offset:0
    ds_read_b64_tr_b16 v[98:99], v8 offset:512
    v_mfma_f32_32x32x16_bf16 v[16:31], v[132:135], v[148:151], v[16:31]
    ds_read_b128 v[116:119], v11 offset:33792
    ds_read_b64_tr_b16 v[100:101], v8 offset:2048
    ds_read_b64_tr_b16 v[102:103], v8 offset:2560
    v_mfma_f32_32x32x16_bf16 v[16:31], v[136:139], v[152:155], v[16:31]
    ds_read_b128 v[120:123], v11 offset:34816
    ds_read_b64_tr_b16 v[104:105], v8 offset:4096
    ds_read_b64_tr_b16 v[106:107], v8 offset:4608
    v_mfma_f32_32x32x16_bf16 v[16:31], v[140:143], v[156:159], v[16:31]
    ds_read_b128 v[124:127], v11 offset:35840
    ds_read_b64_tr_b16 v[108:109], v8 offset:6144
    ds_read_b64_tr_b16 v[110:111], v8 offset:6656
    s_lshl_b32 s18, s13, 2
    s_add_u32 s18, s18, 1
    s_lshl_b32 s18, s18, 14
    s_add_u32 s18, s18, s10
    s_add_u32 s16, s41, 49152
    s_mov_b32 m0, s16
    s_nop 0
    buffer_load_dwordx4 v14, s[72:75], s18 offen lds
    s_add_u32 s16, s41, 50176
    s_mov_b32 m0, s16
    s_add_u32 s18, s18, 0x2000
    buffer_load_dwordx4 v14, s[72:75], s18 offen lds
    s_add_u32 s13, s13, 8
    s_sub_u32 s38, s13, 28
    s_cmp_ge_u32 s13, 28
    s_cselect_b32 s13, s38, s13
    s_lshl_b32 s19, s39, 2
    s_add_u32 s19, s19, 1
    s_lshl_b32 s19, s19, 10
    s_add_u32 s19, s19, s11
    s_add_u32 s16, s63, 147456
    s_mov_b32 m0, s16
    s_nop 0
    buffer_load_dwordx4 v3, s[20:23], s19 offen sc1 lds
    s_add_u32 s16, s63, 155648
    s_mov_b32 m0, s16
    s_add_u32 s19, s19, 0x1c000
    buffer_load_dwordx4 v3, s[20:23], s19 offen sc1 lds
    s_add_u32 s39, s39, 8
    s_sub_u32 s38, s39, 28
    s_cmp_ge_u32 s39, 28
    s_cselect_b32 s39, s38, s39
    s_cmp_lg_u32 s3, 0
    s_cbranch_scc1 M_NP3
    s_waitcnt vmcnt(8)
    v_cmp_eq_u32 vcc, s59, v6
    s_nop 0
    s_cmp_eq_u64 vcc, -1
    s_cbranch_scc1 M_G3
    s_mov_b32 s36, 0x80000
M_W3:
    buffer_load_dword v6, v5, s[20:23], s61 offen offset:0 sc1
    s_waitcnt vmcnt(0)
    v_cmp_eq_u32 vcc, s59, v6
    s_nop 0
    s_cmp_eq_u64 vcc, -1
    s_cbranch_scc1 M_G3
    s_sleep 2
    s_sub_u32 s36, s36, 1
    s_cmp_lg_u32 s36, 0
    s_cbranch_scc1 M_W3
M_G3:
    s_cmp_lg_u32 s60, 0
    s_cbranch_scc1 M_A3
    buffer_inv sc1
    s_waitcnt vmcnt(0)
M_A3:
M_NP3:
    s_waitcnt vmcnt(10) lgkmcnt(0)
    s_barrier
    v_mfma_f32_32x32x16_bf16 v[16:31], v[96:99], v[112:115], v[16:31]
    ds_read_b128 v[144:147], v11 offset:49152
    ds_read_b64_tr_b16 v[128:129], v8 offset:16384
    ds_read_b64_tr_b16 v[130:131], v8 offset:16896
    v_mfma_f32_32x32x16_bf16 v[16:31], v[100:103], v[116:119], v[16:31]
    ds_read_b128 v[148:151], v11 offset:50176
    ds_read_b64_tr_b16 v[132:133], v8 offset:18432
    ds_read_b64_tr_b16 v[134:135], v8 offset:18944
    v_mfma_f32_32x32x16_bf16 v[16:31], v[104:107], v[120:123], v[16:31]
    ds_read_b128 v[152:155], v11 offset:51200
    ds_read_b64_tr_b16 v[136:137], v8 offset:20480
    ds_read_b64_tr_b16 v[138:139], v8 offset:20992
    v_mfma_f32_32x32x16_bf16 v[16:31], v[108:111], v[124:127], v[16:31]
    ds_read_b128 v[156:159], v11 offset:52224
    ds_read_b64_tr_b16 v[140:141], v8 offset:22528
    ds_read_b64_tr_b16 v[142:143], v8 offset:23040
    s_lshl_b32 s18, s13, 2
    s_add_u32 s18, s18, 2
    s_lshl_b32 s18, s18, 14
    s_add_u32 s18, s18, s10
    s_add_u32 s16, s41, 98304
    s_mov_b32 m0, s16
    s_nop 0
    buffer_load_dwordx4 v14, s[72:75], s18 offen lds
    s_add_u32 s16, s41, 99328
    s_mov_b32 m0, s16
    s_add_u32 s18, s18, 0x2000
    buffer_load_dwordx4 v14, s[72:75], s18 offen lds
    s_add_u32 s13, s13, 8
    s_sub_u32 s38, s13, 28
    s_cmp_ge_u32 s13, 28
    s_cselect_b32 s13, s38, s13
    s_lshl_b32 s19, s39, 2
    s_add_u32 s19, s19, 2
    s_lshl_b32 s19, s19, 10
    s_add_u32 s19, s19, s11
    s_add_u32 s16, s63, 0
    s_mov_b32 m0, s16
    s_nop 0
    buffer_load_dwordx4 v3, s[20:23], s19 offen sc1 lds
    s_add_u32 s16, s63, 8192
    s_mov_b32 m0, s16
    s_add_u32 s19, s19, 0x1c000
    buffer_load_dwordx4 v3, s[20:23], s19 offen sc1 lds
    s_add_u32 s39, s39, 8
    s_sub_u32 s38, s39, 28
    s_cmp_ge_u32 s39, 28
    s_cselect_b32 s39, s38, s39
    s_waitcnt vmcnt(10) lgkmcnt(0)
    s_barrier
    v_mfma_f32_32x32x16_bf16 v[16:31], v[128:131], v[144:147], v[16:31]
    ds_read_b128 v[112:115], v10 offset:32768
    ds_read_b64_tr_b16 v[96:97], v9 offset:0
    ds_read_b64_tr_b16 v[98:99], v9 offset:512
    v_mfma_f32_32x32x16_bf16 v[16:31], v[132:135], v[148:151], v[16:31]
    ds_read_b128 v[116:119], v10 offset:33792
    ds_read_b64_tr_b16 v[100:101], v9 offset:2048
    ds_read_b64_tr_b16 v[102:103], v9 offset:2560
    v_mfma_f32_32x32x16_bf16 v[16:31], v[136:139], v[152:155], v[16:31]
    ds_read_b128 v[120:123], v10 offset:34816
    ds_read_b64_tr_b16 v[104:105], v9 offset:4096
    ds_read_b64_tr_b16 v[106:107], v9 offset:4608
    v_mfma_f32_32x32x16_bf16 v[16:31], v[140:143], v[156:159], v[16:31]
    ds_read_b128 v[124:127], v10 offset:35840
    ds_read_b64_tr_b16 v[108:109], v9 offset:6144
    ds_read_b64_tr_b16 v[110:111], v9 offset:6656
    s_lshl_b32 s18, s13, 2
    s_add_u32 s18, s18, 2
    s_lshl_b32 s18, s18, 14
    s_add_u32 s18, s18, s10
    s_add_u32 s16, s41, 114688
    s_mov_b32 m0, s16
    s_nop 0
    buffer_load_dwordx4 v14, s[72:75], s18 offen lds
    s_add_u32 s16, s41, 115712
    s_mov_b32 m0, s16
    s_add_u32 s18, s18, 0x2000
    buffer_load_dwordx4 v14, s[72:75], s18 offen lds
    s_add_u32 s13, s13, 8
    s_sub_u32 s38, s13, 28
    s_cmp_ge_u32 s13, 28
    s_cselect_b32 s13, s38, s13
    s_lshl_b32 s19, s39, 2
    s_add_u32 s19, s19, 2
    s_lshl_b32 s19, s19, 10
    s_add_u32 s19, s19, s11
    s_add_u32 s16, s63, 16384
    s_mov_b32 m0, s16
    s_nop 0
    buffer_load_dwordx4 v3, s[20:23], s19 offen sc1 lds
    s_add_u32 s16, s63, 24576
    s_mov_b32 m0, s16
    s_add_u32 s19, s19, 0x1c000
    buffer_load_dwordx4 v3, s[20:23], s19 offen sc1 lds
    s_add_u32 s39, s39, 8
    s_sub_u32 s38, s39, 28
    s_cmp_ge_u32 s39, 28
    s_cselect_b32 s39, s38, s39
    s_waitcnt vmcnt(12) lgkmcnt(0)
    s_barrier
    v_mfma_f32_32x32x16_bf16 v[16:31], v[96:99], v[112:115], v[16:31]
    ds_read_b128 v[144:147], v0 offset:0
    ds_read_b64_tr_b16 v[128:129], v9 offset:16384
    ds_read_b64_tr_b16 v[130:131], v9 offset:16896
    v_mfma_f32_32x32x16_bf16 v[16:31], v[100:103], v[116:119], v[16:31]
    ds_read_b128 v[148:151], v0 offset:1024
    ds_read_b64_tr_b16 v[132:133], v9 offset:18432
    ds_read_b64_tr_b16 v[134:135], v9 offset:18944
    v_mfma_f32_32x32x16_bf16 v[16:31], v[104:107], v[120:123], v[16:31]
    ds_read_b128 v[152:155], v0 offset:2048
    ds_read_b64_tr_b16 v[136:137], v9 offset:20480
    ds_read_b64_tr_b16 v[138:139], v9 offset:20992
    v_mfma_f32_32x32x16_bf16 v[16:31], v[108:111], v[124:127], v[16:31]
    ds_read_b128 v[156:159], v0 offset:3072
    ds_read_b64_tr_b16 v[140:141], v9 offset:22528
    ds_read_b64_tr_b16 v[142:143], v9 offset:23040
    s_lshl_b32 s18, s13, 2
    s_add_u32 s18, s18, 2
    s_lshl_b32 s18, s18, 14
    s_add_u32 s18, s18, s10
    s_add_u32 s16, s41, 32768
    s_mov_b32 m0, s16
    s_nop 0
    buffer_load_dwordx4 v14, s[72:75], s18 offen lds
    s_add_u32 s16, s41, 33792
    s_mov_b32 m0, s16
    s_add_u32 s18, s18, 0x2000
    buffer_load_dwordx4 v14, s[72:75], s18 offen lds
    s_add_u32 s13, s13, 8
    s_sub_u32 s38, s13, 28
    s_cmp_ge_u32 s13, 28
    s_cselect_b32 s13, s38, s13
    s_lshl_b32 s19, s39, 2
    s_add_u32 s19, s19, 2
    s_lshl_b32 s19, s19, 10
    s_add_u32 s19, s19, s11
    s_add_u32 s16, s63, 65536
    s_mov_b32 m0, s16
    s_nop 0
    buffer_load_dwordx4 v3, s[20:23], s19 offen sc1 lds
    s_add_u32 s16, s63, 73728
    s_mov_b32 m0, s16
    s_add_u32 s19, s19, 0x1c000
    buffer_load_dwordx4 v3, s[20:23], s19 offen sc1 lds
    s_add_u32 s39, s39, 8
    s_sub_u32 s38, s39, 28
    s_cmp_ge_u32 s39, 28
    s_cselect_b32 s39, s38, s39
    s_waitcnt vmcnt(12) lgkmcnt(0)
    s_barrier
    v_mfma_f32_32x32x16_bf16 v[16:31], v[128:131], v[144:147], v[16:31]
    ds_read_b128 v[112:115], v0 offset:16384
    ds_read_b64_tr_b16 v[96:97], v8 offset:49152
    ds_read_b64_tr_b16 v[98:99], v8 offset:49664
    v_mfma_f32_32x32x16_bf16 v[16:31], v[132:135], v[148:151], v[16:31]
    ds_read_b128 v[116:119], v0 offset:17408
    ds_read_b64_tr_b16 v[100:101], v8 offset:51200
    ds_read_b64_tr_b16 v[102:103], v8 offset:51712
    v_mfma_f32_32x32x16_bf16 v[16:31], v[136:139], v[152:155], v[16:31]
    ds_read_b128 v[120:123], v0 offset:18432
    ds_read_b64_tr_b16 v[104:105], v8 offset:53248
    ds_read_b64_tr_b16 v[106:107], v8 offset:53760
    v_mfma_f32_32x32x16_bf16 v[16:31], v[140:143], v[156:159], v[16:31]
    ds_read_b128 v[124:127], v0 offset:19456
    ds_read_b64_tr_b16 v[108:109], v8 offset:55296
    ds_read_b64_tr_b16 v[110:111], v8 offset:55808
    s_lshl_b32 s18, s13, 2
    s_add_u32 s18, s18, 2
    s_add_u32 s18, s18, s8
    s_lshl_b32 s18, s18, 14
    s_add_u32 s18, s18, s10
    s_add_u32 s16, s41, 131072
    s_mov_b32 m0, s16
    s_nop 0
    buffer_load_dwordx4 v14, s[72:75], s18 offen lds
    s_add_u32 s16, s41, 132096
    s_mov_b32 m0, s16
    s_add_u32 s18, s18, 0x2000
    buffer_load_dwordx4 v14, s[72:75], s18 offen lds
    s_add_u32 s13, s13, 8
    s_sub_u32 s38, s13, 28
    s_cmp_ge_u32 s13, 28
    s_cselect_b32 s13, s38, s13
    s_lshl_b32 s19, s39, 2
    s_add_u32 s19, s19, 2
    s_add_u32 s19, s19, s8
    s_lshl_b32 s19, s19, 10
    s_add_u32 s19, s19, s11
    s_add_u32 s16, s63, 81920
    s_mov_b32 m0, s16
    s_nop 0
    buffer_load_dwordx4 v3, s[20:23], s19 offen sc1 lds
    s_add_u32 s16, s63, 90112
    s_mov_b32 m0, s16
    s_add_u32 s19, s19, 0x1c000
    buffer_load_dwordx4 v3, s[20:23], s19 offen sc1 lds
    s_add_u32 s39, s39, 8
    s_sub_u32 s38, s39, 28
    s_cmp_ge_u32 s39, 28
    s_cselect_b32 s39, s38, s39
    s_waitcnt vmcnt(12) lgkmcnt(0)
    s_barrier
    v_mfma_f32_32x32x16_bf16 v[16:31], v[96:99], v[112:115], v[16:31]
    ds_read_b128 v[144:147], v10 offset:0
    ds_read_b64_tr_b16 v[128:129], v9 offset:32768
    ds_read_b64_tr_b16 v[130:131], v9 offset:33280
    v_mfma_f32_32x32x16_bf16 v[16:31], v[100:103], v[116:119], v[16:31]
    ds_read_b128 v[148:151], v10 offset:1024
    ds_read_b64_tr_b16 v[132:133], v9 offset:34816
    ds_read_b64_tr_b16 v[134:135], v9 offset:35328
    v_mfma_f32_32x32x16_bf16 v[16:31], v[104:107], v[120:123], v[16:31]
    ds_read_b128 v[152:155], v10 offset:2048
    ds_read_b64_tr_b16 v[136:137], v9 offset:36864
    ds_read_b64_tr_b16 v[138:139], v9 offset:37376
    v_mfma_f32_32x32x16_bf16 v[16:31], v[108:111], v[124:127], v[16:31]
    ds_read_b128 v[156:159], v10 offset:3072
    ds_read_b64_tr_b16 v[140:141], v9 offset:38912
    ds_read_b64_tr_b16 v[142:143], v9 offset:39424
    s_lshl_b32 s18, s13, 2
    s_add_u32 s18, s18, 3
    s_lshl_b32 s18, s18, 14
    s_add_u32 s18, s18, s10
    s_add_u32 s16, s41, 147456
    s_mov_b32 m0, s16
    s_nop 0
    buffer_load_dwordx4 v14, s[72:75], s18 offen lds
    s_add_u32 s16, s41, 148480
    s_mov_b32 m0, s16
    s_add_u32 s18, s18, 0x2000
    buffer_load_dwordx4 v14, s[72:75], s18 offen lds
    s_add_u32 s13, s13, 8
    s_sub_u32 s38, s13, 28
    s_cmp_ge_u32 s13, 28
    s_cselect_b32 s13, s38, s13
    s_lshl_b32 s19, s39, 2
    s_add_u32 s19, s19, 3
    s_lshl_b32 s19, s19, 10
    s_add_u32 s19, s19, s11
    s_add_u32 s16, s63, 49152
    s_mov_b32 m0, s16
    s_nop 0
    buffer_load_dwordx4 v3, s[20:23], s19 offen sc1 lds
    s_add_u32 s16, s63, 57344
    s_mov_b32 m0, s16
    s_add_u32 s19, s19, 0x1c000
    buffer_load_dwordx4 v3, s[20:23], s19 offen sc1 lds
    s_add_u32 s39, s39, 8
    s_sub_u32 s38, s39, 28
    s_cmp_ge_u32 s39, 28
    s_cselect_b32 s39, s38, s39
    s_waitcnt vmcnt(12) lgkmcnt(0)
    s_barrier
    v_mfma_f32_32x32x16_bf16 v[16:31], v[128:131], v[144:147], v[16:31]
    ds_read_b128 v[112:115], v10 offset:16384
    ds_read_b64_tr_b16 v[96:97], v9 offset:49152
    ds_read_b64_tr_b16 v[98:99], v9 offset:49664
    v_mfma_f32_32x32x16_bf16 v[16:31], v[132:135], v[148:151], v[16:31]
    ds_read_b128 v[116:119], v10 offset:17408
    ds_read_b64_tr_b16 v[100:101], v9 offset:51200
    ds_read_b64_tr_b16 v[102:103], v9 offset:51712
    v_mfma_f32_32x32x16_bf16 v[16:31], v[136:139], v[152:155], v[16:31]
    ds_read_b128 v[120:123], v10 offset:18432
    ds_read_b64_tr_b16 v[104:105], v9 offset:53248
    ds_read_b64_tr_b16 v[106:107], v9 offset:53760
    v_mfma_f32_32x32x16_bf16 v[16:31], v[140:143], v[156:159], v[16:31]
    ds_read_b128 v[124:127], v10 offset:19456
    ds_read_b64_tr_b16 v[108:109], v9 offset:55296
    ds_read_b64_tr_b16 v[110:111], v9 offset:55808
    s_lshl_b32 s18, s13, 2
    s_add_u32 s18, s18, 3
    s_lshl_b32 s18, s18, 14
    s_add_u32 s18, s18, s10
    s_add_u32 s16, s41, 0
    s_mov_b32 m0, s16
    s_nop 0
    buffer_load_dwordx4 v14, s[72:75], s18 offen lds
    s_add_u32 s16, s41, 1024
    s_mov_b32 m0, s16
    s_add_u32 s18, s18, 0x2000
    buffer_load_dwordx4 v14, s[72:75], s18 offen lds
    s_add_u32 s13, s13, 8
    s_sub_u32 s38, s13, 28
    s_cmp_ge_u32 s13, 28
    s_cselect_b32 s13, s38, s13
    s_lshl_b32 s19, s39, 2
    s_add_u32 s19, s19, 3
    s_lshl_b32 s19, s19, 10
    s_add_u32 s19, s19, s11
    s_add_u32 s16, s63, 98304
    s_mov_b32 m0, s16
    s_nop 0
    buffer_load_dwordx4 v3, s[20:23], s19 offen sc1 lds
    s_add_u32 s16, s63, 106496
    s_mov_b32 m0, s16
    s_add_u32 s19, s19, 0x1c000
    buffer_load_dwordx4 v3, s[20:23], s19 offen sc1 lds
    s_add_u32 s39, s39, 8
    s_sub_u32 s38, s39, 28
    s_cmp_ge_u32 s39, 28
    s_cselect_b32 s39, s38, s39
    s_waitcnt vmcnt(12) lgkmcnt(0)
    s_barrier
    v_mfma_f32_32x32x16_bf16 v[16:31], v[96:99], v[112:115], v[16:31]
    ds_read_b128 v[144:147], v11 offset:0
    ds_read_b64_tr_b16 v[128:129], v8 offset:32768
    ds_read_b64_tr_b16 v[130:131], v8 offset:33280
    v_mfma_f32_32x32x16_bf16 v[16:31], v[100:103], v[116:119], v[16:31]
    ds_read_b128 v[148:151], v11 offset:1024
    ds_read_b64_tr_b16 v[132:133], v8 offset:34816
    ds_read_b64_tr_b16 v[134:135], v8 offset:35328
    v_mfma_f32_32x32x16_bf16 v[16:31], v[104:107], v[120:123], v[16:31]
    ds_read_b128 v[152:155], v11 offset:2048
    ds_read_b64_tr_b16 v[136:137], v8 offset:36864
    ds_read_b64_tr_b16 v[138:139], v8 offset:37376
    v_mfma_f32_32x32x16_bf16 v[16:31], v[108:111], v[124:127], v[16:31]
    ds_read_b128 v[156:159], v11 offset:3072
    ds_read_b64_tr_b16 v[140:141], v8 offset:38912
    ds_read_b64_tr_b16 v[142:143], v8 offset:39424
    s_lshl_b32 s18, s13, 2
    s_add_u32 s18, s18, 3
    s_lshl_b32 s18, s18, 14
    s_add_u32 s18, s18, s10
    s_add_u32 s16, s41, 16384
    s_mov_b32 m0, s16
    s_nop 0
    buffer_load_dwordx4 v14, s[72:75], s18 offen lds
    s_add_u32 s16, s41, 17408
    s_mov_b32 m0, s16
    s_add_u32 s18, s18, 0x2000
    buffer_load_dwordx4 v14, s[72:75], s18 offen lds
    s_lshl_b32 s19, s39, 2
    s_add_u32 s19, s19, 3
    s_lshl_b32 s19, s19, 10
    s_add_u32 s19, s19, s11
    s_add_u32 s16, s63, 114688
    s_mov_b32 m0, s16
    s_nop 0
    buffer_load_dwordx4 v3, s[20:23], s19 offen sc1 lds
    s_add_u32 s16, s63, 122880
    s_mov_b32 m0, s16
    s_add_u32 s19, s19, 0x1c000
    buffer_load_dwordx4 v3, s[20:23], s19 offen sc1 lds
    s_waitcnt vmcnt(12) lgkmcnt(0)
    s_barrier
    v_mfma_f32_32x32x16_bf16 v[16:31], v[128:131], v[144:147], v[16:31]
    ds_read_b128 v[112:115], v11 offset:16384
    ds_read_b64_tr_b16 v[96:97], v13 offset:0
    ds_read_b64_tr_b16 v[98:99], v13 offset:512
    v_mfma_f32_32x32x16_bf16 v[16:31], v[132:135], v[148:151], v[16:31]
    ds_read_b128 v[116:119], v11 offset:17408
    ds_read_b64_tr_b16 v[100:101], v13 offset:2048
    ds_read_b64_tr_b16 v[102:103], v13 offset:2560
    v_mfma_f32_32x32x16_bf16 v[16:31], v[136:139], v[152:155], v[16:31]
    ds_read_b128 v[120:123], v11 offset:18432
    ds_read_b64_tr_b16 v[104:105], v13 offset:4096
    ds_read_b64_tr_b16 v[106:107], v13 offset:4608
    v_mfma_f32_32x32x16_bf16 v[16:31], v[140:143], v[156:159], v[16:31]
    ds_read_b128 v[124:127], v11 offset:19456
    ds_read_b64_tr_b16 v[108:109], v13 offset:6144
    ds_read_b64_tr_b16 v[110:111], v13 offset:6656
    s_waitcnt vmcnt(8) lgkmcnt(0)
    s_barrier
    v_mfma_f32_32x32x16_bf16 v[16:31], v[96:99], v[112:115], v[16:31]
    ds_read_b128 v[144:147], v10 offset:49152
    ds_read_b64_tr_b16 v[128:129], v13 offset:16384
    ds_read_b64_tr_b16 v[130:131], v13 offset:16896
    v_mfma_f32_32x32x16_bf16 v[16:31], v[100:103], v[116:119], v[16:31]
    ds_read_b128 v[148:151], v10 offset:50176
    ds_read_b64_tr_b16 v[132:133], v13 offset:18432
    ds_read_b64_tr_b16 v[134:135], v13 offset:18944
    v_mfma_f32_32x32x16_bf16 v[16:31], v[104:107], v[120:123], v[16:31]
    ds_read_b128 v[152:155], v10 offset:51200
    ds_read_b64_tr_b16 v[136:137], v13 offset:20480
    ds_read_b64_tr_b16 v[138:139], v13 offset:20992
    v_mfma_f32_32x32x16_bf16 v[16:31], v[108:111], v[124:127], v[16:31]
    ds_read_b128 v[156:159], v10 offset:52224
    ds_read_b64_tr_b16 v[140:141], v13 offset:22528
    ds_read_b64_tr_b16 v[142:143], v13 offset:23040
    s_waitcnt vmcnt(4) lgkmcnt(0)
    s_barrier
    v_mfma_f32_32x32x16_bf16 v[16:31], v[128:131], v[144:147], v[16:31]
    ds_read_b128 v[112:115], v11 offset:32768
    ds_read_b64_tr_b16 v[96:97], v8 offset:0
    ds_read_b64_tr_b16 v[98:99], v8 offset:512
    v_mfma_f32_32x32x16_bf16 v[16:31], v[132:135], v[148:151], v[16:31]
    ds_read_b128 v[116:119], v11 offset:33792
    ds_read_b64_tr_b16 v[100:101], v8 offset:2048
    ds_read_b64_tr_b16 v[102:103], v8 offset:2560
    v_mfma_f32_32x32x16_bf16 v[16:31], v[136:139], v[152:155], v[16:31]
    ds_read_b128 v[120:123], v11 offset:34816
    ds_read_b64_tr_b16 v[104:105], v8 offset:4096
    ds_read_b64_tr_b16 v[106:107], v8 offset:4608
    v_mfma_f32_32x32x16_bf16 v[16:31], v[140:143], v[156:159], v[16:31]
    ds_read_b128 v[124:127], v11 offset:35840
    ds_read_b64_tr_b16 v[108:109], v8 offset:6144
    ds_read_b64_tr_b16 v[110:111], v8 offset:6656
    s_waitcnt vmcnt(0) lgkmcnt(0)
    s_barrier
    v_mfma_f32_32x32x16_bf16 v[16:31], v[96:99], v[112:115], v[16:31]
    ds_read_b128 v[144:147], v11 offset:49152
    ds_read_b64_tr_b16 v[128:129], v8 offset:16384
    ds_read_b64_tr_b16 v[130:131], v8 offset:16896
    v_mfma_f32_32x32x16_bf16 v[16:31], v[100:103], v[116:119], v[16:31]
    ds_read_b128 v[148:151], v11 offset:50176
    ds_read_b64_tr_b16 v[132:133], v8 offset:18432
    ds_read_b64_tr_b16 v[134:135], v8 offset:18944
    v_mfma_f32_32x32x16_bf16 v[16:31], v[104:107], v[120:123], v[16:31]
    ds_read_b128 v[152:155], v11 offset:51200
    ds_read_b64_tr_b16 v[136:137], v8 offset:20480
    ds_read_b64_tr_b16 v[138:139], v8 offset:20992
    v_mfma_f32_32x32x16_bf16 v[16:31], v[108:111], v[124:127], v[16:31]
    ds_read_b128 v[156:159], v11 offset:52224
    ds_read_b64_tr_b16 v[140:141], v8 offset:22528
    ds_read_b64_tr_b16 v[142:143], v8 offset:23040
    s_waitcnt lgkmcnt(0)
    v_mfma_f32_32x32x16_bf16 v[16:31], v[128:131], v[144:147], v[16:31]
    v_mfma_f32_32x32x16_bf16 v[16:31], v[132:135], v[148:151], v[16:31]
    v_mfma_f32_32x32x16_bf16 v[16:31], v[136:139], v[152:155], v[16:31]
    v_mfma_f32_32x32x16_bf16 v[16:31], v[140:143], v[156:159], v[16:31]
    s_lshl_b32 s38, s3, 11
    s_add_u32 s40, s38, 49152
    v_add_u32 v4, s40, v3
    s_xor_b32 s38, s38, 0x2000
    s_add_u32 s40, s38, 49152
    v_add_u32 v15, s40, v3
    v_lshlrev_b32 v88, 16, v80
    v_and_b32 v89, 0xffff0000, v80
    v_lshlrev_b32 v90, 16, v81
    v_and_b32 v91, 0xffff0000, v81
    v_lshlrev_b32 v92, 16, v82
    v_and_b32 v93, 0xffff0000, v82
    v_lshlrev_b32 v94, 16, v83
    v_and_b32 v95, 0xffff0000, v83
    s_cmp_ge_u32 s3, 4
    s_cbranch_scc1 F2_HI
    ds_write_b128 v4, v[24:27]
    ds_write_b128 v4, v[28:31] offset:1024
    s_branch F2_X
F2_HI:
    s_nop 2
    ds_write_b128 v4, v[16:19]
    ds_write_b128 v4, v[20:23] offset:1024
    v_mov_b32 v16, v24
    v_mov_b32 v17, v25
    v_mov_b32 v18, v26
    v_mov_b32 v19, v27
    v_mov_b32 v20, v28
    v_mov_b32 v21, v29
    v_mov_b32 v22, v30
    v_mov_b32 v23, v31
F2_X:
    s_waitcnt lgkmcnt(0)
    s_barrier
    ds_read_b128 v[32:35], v15
    ds_read_b128 v[36:39], v15 offset:1024
    s_waitcnt lgkmcnt(0)
    v_add_f32 v16, v16, v32
    v_add_f32 v17, v17, v33
    v_add_f32 v18, v18, v34
    v_add_f32 v19, v19, v35
    v_add_f32 v20, v20, v36
    v_add_f32 v21, v21, v37
    v_add_f32 v22, v22, v38
    v_add_f32 v23, v23, v39
    v_fmac_f32 v88, v16, v56
    v_fmac_f32 v89, v17, v57
    v_fmac_f32 v90, v18, v58
    v_fmac_f32 v91, v19, v59
    v_fmac_f32 v92, v20, v60
    v_fmac_f32 v93, v21, v61
    v_fmac_f32 v94, v22, v62
    v_fmac_f32 v95, v23, v63
    v_cvt_pk_bf16_f32 v80, v88, v89
    v_cvt_pk_bf16_f32 v81, v90, v91
    v_cvt_pk_bf16_f32 v82, v92, v93
    v_cvt_pk_bf16_f32 v83, v94, v95
    global_store_dwordx4 v12, v[80:83], s[56:57]
M_END2:
    s_endpgm
M_SLOW:
    s_waitcnt vmcnt(0)
    v_mov_b32 v12, 0xff800000
    s_mov_b32 s12, 131072
M_SL1:
    buffer_load_dwordx4 v[92:95], v3, s[20:23], s12 offen sc1
    s_waitcnt vmcnt(0)
    v_mfma_f32_32x32x16_bf16 v[36:51], v[92:95], v[16:19], 0
    s_nop 11
    v_max3_f32 v12, v12, v36, v37
    v_max3_f32 v12, v12, v38, v39
    v_max3_f32 v12, v12, v40, v41
    v_max3_f32 v12, v12, v42, v43
    v_max3_f32 v12, v12, v44, v45
    v_max3_f32 v12, v12, v46, v47
    v_max3_f32 v12, v12, v48, v49
    v_max3_f32 v12, v12, v50, v51
    s_add_u32 s12, s12, 2048
    s_cmp_lt_u32 s12, 262144
    s_cbranch_scc1 M_SL1
    v_mov_b32 v13, v12
    s_nop 1
    v_permlane32_swap_b32 v12, v13
    v_max_f32 v12, v12, v13
    v_sub_f32 v20, 0, v12
    v_sub_f32 v21, 0, v12
    v_sub_f32 v22, 0, v12
    v_sub_f32 v23, 0, v12
    v_sub_f32 v24, 0, v12
    v_sub_f32 v25, 0, v12
    v_sub_f32 v26, 0, v12
    v_sub_f32 v27, 0, v12
    v_sub_f32 v28, 0, v12
    v_sub_f32 v29, 0, v12
    v_sub_f32 v30, 0, v12
    v_sub_f32 v31, 0, v12
    v_sub_f32 v32, 0, v12
    v_sub_f32 v33, 0, v12
    v_sub_f32 v34, 0, v12
    v_sub_f32 v35, 0, v12
    v_mov_b32 v76, 0
    v_mov_b32 v77, 0
    v_mov_b32 v78, 0
    v_mov_b32 v79, 0
    v_mov_b32 v80, 0
    v_mov_b32 v81, 0
    v_mov_b32 v82, 0
    v_mov_b32 v83, 0
    v_mov_b32 v84, 0
    v_mov_b32 v85, 0
    v_mov_b32 v86, 0
    v_mov_b32 v87, 0
    v_mov_b32 v88, 0
    v_mov_b32 v89, 0
    v_mov_b32 v90, 0
    v_mov_b32 v91, 0
    v_mov_b32 v96, 0x3f803f80
    v_mov_b32 v97, 0x3f803f80
    v_mov_b32 v98, 0x3f803f80
    v_mov_b32 v99, 0x3f803f80
    v_mov_b32 v100, 0x3f803f80
    v_mov_b32 v101, 0x3f803f80
    v_mov_b32 v102, 0x3f803f80
    v_mov_b32 v103, 0x3f803f80
    v_lshl_add_u32 v13, v5, 4, v4
    v_lshlrev_b32 v13, 4, v13
    s_mov_b32 s12, 131072
M_SL2:
    buffer_load_dwordx4 v[92:95], v3, s[20:23], s12 offen sc1
    s_mov_b64 exec, s[32:33]
    buffer_load_dwordx4 v[96:99], v13, s[20:23], s12 offen offset:1024 sc1
    buffer_load_dwordx4 v[100:103], v13, s[20:23], s12 offen offset:1536 sc1
    s_mov_b64 exec, -1
    s_waitcnt vmcnt(0)
    v_mfma_f32_32x32x16_bf16 v[36:51], v[92:95], v[16:19], v[20:35]
    s_nop 11
    v_exp_f32 v36, v36
    v_exp_f32 v37, v37
    v_exp_f32 v38, v38
    v_exp_f32 v39, v39
    v_exp_f32 v40, v40
    v_exp_f32 v41, v41
    v_exp_f32 v42, v42
    v_exp_f32 v43, v43
    v_exp_f32 v44, v44
    v_exp_f32 v45, v45
    v_exp_f32 v46, v46
    v_exp_f32 v47, v47
    v_exp_f32 v48, v48
    v_exp_f32 v49, v49
    v_exp_f32 v50, v50
    v_exp_f32 v51, v51
    v_cvt_pk_bf16_f32 v52, v36, v37
    v_cvt_pk_bf16_f32 v53, v38, v39
    v_cvt_pk_bf16_f32 v54, v40, v41
    v_cvt_pk_bf16_f32 v55, v42, v43
    v_cvt_pk_bf16_f32 v56, v44, v45
    v_cvt_pk_bf16_f32 v57, v46, v47
    v_cvt_pk_bf16_f32 v58, v48, v49
    v_cvt_pk_bf16_f32 v59, v50, v51
    v_mfma_f32_32x32x16_bf16 v[76:91], v[96:99], v[52:55], v[76:91]
    s_nop 0
    v_mfma_f32_32x32x16_bf16 v[76:91], v[100:103], v[56:59], v[76:91]
    s_add_u32 s12, s12, 2048
    s_cmp_lt_u32 s12, 262144
    s_cbranch_scc1 M_SL2
    s_nop 15
    s_add_u32 s12, s13, 59392
    buffer_load_dwordx4 v[20:23], v3, s[20:23], s12 offen sc1
    s_add_u32 s12, s13, 11264
    buffer_load_dwordx4 v[24:27], v3, s[20:23], s12 offen sc1
    s_add_u32 s12, s13, 27648
    buffer_load_dwordx4 v[28:31], v3, s[20:23], s12 offen sc1
    s_add_u32 s12, s13, 44032
    buffer_load_dwordx4 v[32:35], v3, s[20:23], s12 offen sc1
    s_add_u32 s12, s13, 60416
    buffer_load_dwordx4 v[36:39], v3, s[20:23], s12 offen sc1
    s_add_u32 s12, s13, 12288
    buffer_load_dwordx4 v[40:43], v3, s[20:23], s12 offen sc1
    s_add_u32 s12, s13, 28672
    buffer_load_dwordx4 v[44:47], v3, s[20:23], s12 offen sc1
    s_add_u32 s12, s13, 45056
    buffer_load_dwordx4 v[48:51], v3, s[20:23], s12 offen sc1
    s_branch M_FIN
CODE_END:
    s_endpgm
.section .rodata,"a"
.p2align 6
.amdhsa_kernel adaLN_cond__grouped_kv_mqa__geglu_ffn__prompt_kernel
  .amdhsa_next_free_vgpr 256
  .amdhsa_next_free_sgpr 76
  .amdhsa_accum_offset 256
  .amdhsa_group_segment_fixed_size 0
  .amdhsa_kernarg_size 112
  .amdhsa_user_sgpr_count 2
  .amdhsa_user_sgpr_kernarg_segment_ptr 1
  .amdhsa_system_sgpr_workgroup_id_x 1
.end_amdhsa_kernel
```
